```python
import torch

def _softmax(x, axis=-1):
    return torch.softmax(x, dim=axis)
def _gelu(x):
    return torch.nn.functional.gelu(x, approximate="tanh")
def _silu(x):
    return torch.nn.functional.silu(x)
def _sigmoid(x):
    return torch.sigmoid(x)
def _layernorm(x, axis=-1, eps=1e-5):
    m = x.mean(dim=axis, keepdim=True)
    v = x.var(dim=axis, keepdim=True, unbiased=False)
    return (x - m) / torch.sqrt(v + eps)
def _scatter_add(tgt, idx, src, axis=0):
    return tgt.clone().index_add_(axis, idx, src)
def _segment_sum(src, seg, n):
    out = torch.zeros((n,) + src.shape[1:], dtype=src.dtype)
    return out.index_add_(0, seg, src)
def _pad(x, pw):
    flat = tuple(v for pair in reversed(pw) for v in pair)
    return torch.nn.functional.pad(x, flat)

kernel_name = 'gated_mix__compressed_kv_cla__glu_gated_glu__prompt'

def setup_inputs():

    _w = (lambda a: (lambda t: t.to(torch.bfloat16) if t.is_floating_point() else t)(torch.as_tensor(a)))
    def _A_setup():
        B, H, Sq, Sk, D, M = 1, 32, 2048, 2048, 128, 512
        Dc = 4 * D
        return {
            "x": _w((lambda *s: torch.randn(*s, dtype=torch.bfloat16) * 0.05)(B, Sq, M)),
            "c_kv": _w((lambda *s: torch.randn(*s, dtype=torch.bfloat16) * 0.8)(B, Sk, Dc)),
            "w_q": _w((lambda *s: torch.randn(*s, dtype=torch.bfloat16) * 6.4)(M, H, D) * (M ** -0.5)),
            "w_uk": _w((lambda *s: torch.randn(*s, dtype=torch.bfloat16) * 6.4)(Dc, H, D) * (Dc ** -0.5)),
            "w_uv": _w((lambda *s: torch.randn(*s, dtype=torch.bfloat16) * 0.8)(Dc, H, D) * (Dc ** -0.5)),
            "w_o": _w((lambda *s: torch.randn(*s, dtype=torch.bfloat16) * 0.8)(H, D, M) * ((H * D) ** -0.5)),
        }
    _A_in = _A_setup()

    def _B_setup():
        B, S, D, F = 1, 2048, 512, 1792
        return {
            "x": _w((lambda *s: torch.randn(*s, dtype=torch.bfloat16) * 0.05)(B, S, D)),
            "w_gate": _w((lambda *s: torch.randn(*s, dtype=torch.bfloat16) * 1.6)(D, F)),
            "w_up": _w((lambda *s: torch.randn(*s, dtype=torch.bfloat16) * 0.05)(D, F)),
            "w_down": _w((lambda *s: torch.randn(*s, dtype=torch.bfloat16) * 0.05)(F, D)),
        }
    _B_in = _B_setup()

    return {
        "A_x": _A_in["x"],
        "A_c_kv": _A_in["c_kv"],
        "A_w_q": _A_in["w_q"],
        "A_w_uk": _A_in["w_uk"],
        "A_w_uv": _A_in["w_uv"],
        "A_w_o": _A_in["w_o"],
        "B_x": _B_in["x"],
        "B_w_gate": _B_in["w_gate"],
        "B_w_up": _B_in["w_up"],
        "B_w_down": _B_in["w_down"],
        "gate_w": _w((lambda *s: torch.randn(*s, dtype=torch.bfloat16) * 0.05)(512) * 16.0),
    }

def reference(A_x, A_c_kv, A_w_q, A_w_uk, A_w_uv, A_w_o, B_x, B_w_gate, B_w_up, B_w_down, gate_w):
    def _A_ref(x, c_kv, w_q, w_uk, w_uv, w_o):
        B, Sq, M = x.shape[0], x.shape[1], x.shape[2]
        Sk = c_kv.shape[1]
        H, D = w_q.shape[1], w_q.shape[2]
        q = torch.einsum("bqm,mhd->bhqd", x, w_q)
        k = torch.einsum("bkc,chd->bhkd", c_kv, w_uk)
        v = torch.einsum("bkc,chd->bhkd", c_kv, w_uv)
        scores = torch.einsum("bhqd,bhkd->bhqk", q, k) * (D ** -0.5)
        off = Sk - Sq
        qi = torch.arange(Sq)[:, None]
        kj = torch.arange(Sk)[None, :]
        cmask = kj <= (qi + off)
        scores = torch.where(cmask[None, None], scores, -1e9)
        p = _softmax(scores, axis=-1)
        ctx = torch.einsum("bhqk,bhkd->bhqd", p, v)
        return torch.einsum("bhqd,hdm->bqm", ctx, w_o)

    def _B_ref(x, w_gate, w_up, w_down):
        g = torch.einsum("bsd,df->bsf", x, w_gate)
        u = torch.einsum("bsd,df->bsf", x, w_up)
        h = _sigmoid(g) * u
        return torch.einsum("bsf,fd->bsd", h, w_down)

    x = A_x
    g = _sigmoid((x * gate_w).sum(-1, keepdims=True))
    a = _A_ref(x, A_c_kv, A_w_q, A_w_uk, A_w_uv, A_w_o)
    b = _B_ref(x, B_w_gate, B_w_up, B_w_down)
    return g * a + (1 - g) * b
```

```asm
; @launch grid=(256,1,1) block=(256,1,1) lds=163840
.amdgcn_target "amdgcn-amd-amdhsa--gfx950"

.macro mva d, a, b
v_mfma_f32_16x16x32_bf16 v[\d:\d+3], v[\a:\a+3], a[\b:\b+3], v[\d:\d+3]
.endm
.macro mav d, a, b
v_mfma_f32_16x16x32_bf16 v[\d:\d+3], a[\a:\a+3], v[\b:\b+3], v[\d:\d+3]
.endm
.macro maa d, a, b
v_mfma_f32_16x16x32_bf16 v[\d:\d+3], a[\a:\a+3], a[\b:\b+3], v[\d:\d+3]
.endm
.macro mvv d, a, b
v_mfma_f32_16x16x32_bf16 v[\d:\d+3], v[\a:\a+3], v[\b:\b+3], v[\d:\d+3]
.endm
.macro mva0 d, a, b
v_mfma_f32_16x16x32_bf16 v[\d:\d+3], v[\a:\a+3], a[\b:\b+3], 0
.endm
.macro mav0 d, a, b
v_mfma_f32_16x16x32_bf16 v[\d:\d+3], a[\a:\a+3], v[\b:\b+3], 0
.endm
.macro maa0 d, a, b
v_mfma_f32_16x16x32_bf16 v[\d:\d+3], a[\a:\a+3], a[\b:\b+3], 0
.endm
.macro mvv0 d, a, b
v_mfma_f32_16x16x32_bf16 v[\d:\d+3], v[\a:\a+3], v[\b:\b+3], 0
.endm
.macro trv d, a, o
ds_read_b64_tr_b16 v[\d:\d+1], v[\a] offset:\o
.endm
.macro tra d, a, o
ds_read_b64_tr_b16 a[\d:\d+1], v[\a] offset:\o
.endm
.macro rda d, a, o
ds_read_b128 a[\d:\d+3], v[\a] offset:\o
.endm

.text
.globl gated_mix__compressed_kv_cla__glu_gated_glu__prompt_kernel
.p2align 12
.p2align 8
.type gated_mix__compressed_kv_cla__glu_gated_glu__prompt_kernel,@function
gated_mix__compressed_kv_cla__glu_gated_glu__prompt_kernel:
s_cmp_ge_u32 s2, 256
s_cbranch_scc1 L_exit
s_load_dwordx2 s[8:9], s[0:1], 8
s_load_dwordx2 s[16:17], s[0:1], 24
v_lshrrev_b32 v1, 6, v0
v_and_b32 v0, 63, v0
v_readfirstlane_b32 s58, v1
v_lshlrev_b32 v1, 4, v0
v_lshrrev_b32 v24, 3, v0
v_and_b32 v25, 7, v0
v_lshrrev_b32 v26, 4, v0
s_lshr_b32 s66, s2, 3
s_getpc_b64 s[92:93]
s_and_b32 s92, s92, 0xffffff00
s_lshl_b32 s65, s66, 2
s_add_u32 s65, s65, s58
s_min_u32 s65, s65, (L_end-gated_mix__compressed_kv_cla__glu_gated_glu__prompt_kernel)/1024-2
s_lshl_b32 s65, s65, 10
v_add_u32 v27, s65, v1
global_load_dword v28, v27, s[92:93]
v_xor_b32 v25, v25, v26
v_lshlrev_b32 v25, 4, v25
v_lshl_add_u32 v10, v24, 10, v25
v_xor_b32 v11, 64, v10
v_add_u32 v11, 7168, v11
s_mov_b32 s10, 0x200000
s_mov_b32 s11, 0x20000
s_lshr_b32 s57, s2, 5
s_lshl_b32 s75, s57, 2
s_add_u32 s75, s75, s58
s_and_b32 s79, s57, 3
s_lshl_b32 s79, s79, 8
s_lshl_b32 s78, s75, 16
s_add_u32 s78, s78, s79
s_lshl_b32 s63, s58, 14
s_add_u32 s71, s63, 98304
s_lshl_b32 s95, s2, 2
s_add_u32 s95, s95, s58
s_lshl_b32 s95, s95, 10
s_waitcnt lgkmcnt(0)
s_add_u32 m0, s71, 0
s_add_u32 s69, s78, 0
buffer_load_dwordx4 v10, s[8:11], s69 offen offset:0 lds
s_mov_b32 s18, 0x400000
s_mov_b32 s19, 0x20000
s_and_b32 s65, s2, 7
buffer_load_dwordx4 v11, s[8:11], s69 offen offset:1024 lds
s_and_b32 s67, s66, 3
s_lshl_b32 s56, s65, 2
s_add_u32 s56, s56, s67
s_add_u32 m0, s71, 2048
s_add_u32 s69, s78, 16384
buffer_load_dwordx4 v10, s[8:11], s69 offen offset:0 lds
s_lshl_b32 s72, s56, 8
s_and_b32 s68, s57, 3
s_lshl_b32 s68, s68, 20
buffer_load_dwordx4 v11, s[8:11], s69 offen offset:1024 lds
s_add_u32 s72, s72, s68
s_lshl_b32 s70, s58, 12
s_lshl_b32 s68, s58, 5
s_add_u32 m0, s71, 4096
s_add_u32 s69, s78, 32768
buffer_load_dwordx4 v10, s[8:11], s69 offen offset:0 lds
v_add_u32 v24, s68, v24
v_bfe_u32 v25, v0, 1, 2
v_bfe_u32 v26, v0, 4, 1
buffer_load_dwordx4 v11, s[8:11], s69 offen offset:1024 lds
v_xor_b32 v26, v25, v26
v_and_b32 v27, 1, v0
v_lshlrev_b32 v27, 4, v27
s_add_u32 m0, s71, 6144
s_add_u32 s69, s78, 49152
buffer_load_dwordx4 v10, s[8:11], s69 offen offset:0 lds
v_lshl_add_u32 v25, v26, 5, v27
v_lshl_add_u32 v20, v24, 13, v25
v_xor_b32 v21, 64, v20
buffer_load_dwordx4 v11, s[8:11], s69 offen offset:1024 lds
v_add_u32 v21, 64512, v21
v_add_u32 v22, 129024, v20
v_add_u32 v23, 129024, v21
s_load_dwordx2 s[48:49], s[0:1], 104
s_load_dwordx2 s[4:5], s[0:1], 0
s_load_dwordx2 s[12:13], s[0:1], 16
s_load_dwordx2 s[20:21], s[0:1], 32
s_load_dwordx2 s[24:25], s[0:1], 40
s_load_dwordx2 s[28:29], s[0:1], 56
s_load_dwordx2 s[32:33], s[0:1], 64
s_load_dwordx2 s[36:37], s[0:1], 72
s_load_dwordx2 s[40:41], s[0:1], 80
s_load_dwordx2 s[44:45], s[0:1], 88
s_load_dwordx2 s[52:53], s[0:1], 96
s_add_u32 m0, s70, 0
s_add_u32 s69, s72, 0
buffer_load_dwordx4 v20, s[16:19], s69 offen offset:0 lds
v_mul_u32_u24 v24, 3584, v24
v_add_u32 v12, v24, v25
v_xor_b32 v13, 64, v12
buffer_load_dwordx4 v21, s[16:19], s69 offen offset:1024 lds
v_add_u32 v13, 27648, v13
v_add_u32 v14, 55296, v12
v_add_u32 v15, 55296, v13
s_mov_b32 s50, 0x7400000
buffer_load_dwordx4 v22, s[16:19], s69 offen offset:2048 lds
s_mov_b32 s51, 0x20000
s_mov_b32 s6, 0x200000
s_mov_b32 s7, 0x20000
buffer_load_dwordx4 v23, s[16:19], s69 offen offset:3072 lds
s_mov_b32 s14, 0x400000
s_mov_b32 s15, 0x20000
s_mov_b32 s22, 0x400000
s_mov_b32 s23, 0x20000
s_mov_b64 exec, 0
s_cmp_eq_u32 s58, 0
s_cbranch_scc1 L_stub0
s_cmp_eq_u32 s58, 1
s_cbranch_scc1 L_stub1
s_cmp_eq_u32 s58, 2
s_cbranch_scc1 L_stub2
s_cmp_eq_u32 s58, 3
s_cbranch_scc1 L_stub3
L_walk_a0:
s_mov_b64 exec, -1
s_add_u32 m0, s71, 8192
s_add_u32 s69, s78, 128
buffer_load_dwordx4 v10, s[8:11], s69 offen offset:0 lds
s_mov_b32 s26, 0x400000
s_mov_b32 s27, 0x20000
s_mov_b32 s30, 0x1c0000
buffer_load_dwordx4 v11, s[8:11], s69 offen offset:1024 lds
s_mov_b32 s31, 0x20000
s_mov_b32 s34, 0x1c0000
s_mov_b32 s35, 0x20000
s_mov_b32 s38, 0x1c0000
s_add_u32 m0, s71, 10240
s_add_u32 s69, s78, 16512
buffer_load_dwordx4 v10, s[8:11], s69 offen offset:0 lds
s_mov_b32 s39, 0x20000
s_mov_b32 s42, 0x400
s_mov_b32 s43, 0x20000
s_mov_b32 s46, 0x200000
buffer_load_dwordx4 v11, s[8:11], s69 offen offset:1024 lds
s_mov_b32 s47, 0x20000
s_mov_b32 s54, 0x100
s_mov_b32 s55, 0x20000
s_lshl_b32 s66, s66, 2
s_mov_b64 exec, 0
s_cmp_eq_u32 s58, 0
s_cbranch_scc1 L_stub4
s_cmp_eq_u32 s58, 1
s_cbranch_scc1 L_stub5
s_cmp_eq_u32 s58, 2
s_cbranch_scc1 L_stub6
s_cmp_eq_u32 s58, 3
s_cbranch_scc1 L_stub7
L_walk_a1:
s_mov_b64 exec, -1
s_add_u32 m0, s71, 12288
s_add_u32 s69, s78, 32896
buffer_load_dwordx4 v10, s[8:11], s69 offen offset:0 lds
s_add_u32 s66, s66, s58
s_lshl_b32 s66, s66, 13
s_lshl_b32 s68, s65, 10
buffer_load_dwordx4 v11, s[8:11], s69 offen offset:1024 lds
s_add_u32 s93, s66, s68
v_lshrrev_b32 v26, 4, v0
v_and_b32 v24, 15, v0
v_lshrrev_b32 v25, 1, v24
s_add_u32 m0, s71, 14336
s_add_u32 s69, s78, 49280
buffer_load_dwordx4 v10, s[8:11], s69 offen offset:0 lds
v_xor_b32 v25, v25, v26
v_lshlrev_b32 v25, 4, v25
v_lshl_add_u32 v25, v24, 7, v25
buffer_load_dwordx4 v11, s[8:11], s69 offen offset:1024 lds
v_add_u32 v6, s71, v25
v_xor_b32 v7, 64, v6
v_bfe_u32 v24, v0, 2, 2
v_lshl_add_u32 v25, v26, 3, v24
s_mov_b64 exec, 0
s_cmp_eq_u32 s58, 0
s_cbranch_scc1 L_stub8
s_cmp_eq_u32 s58, 1
s_cbranch_scc1 L_stub9
s_cmp_eq_u32 s58, 2
s_cbranch_scc1 L_stub10
s_cmp_eq_u32 s58, 3
s_cbranch_scc1 L_stub11
L_walk_a2:
s_mov_b64 exec, -1
s_add_u32 m0, s70, 16384
s_add_u32 s69, s72, 128
buffer_load_dwordx4 v20, s[16:19], s69 offen offset:0 lds
v_lshlrev_b32 v25, 7, v25
v_and_b32 v26, 3, v0
v_lshl_add_u32 v25, v26, 3, v25
buffer_load_dwordx4 v21, s[16:19], s69 offen offset:1024 lds
v_bfe_u32 v24, v0, 3, 2
v_lshl_add_u32 v2, v24, 5, v25
v_xor_b32 v3, 32, v2
v_xor_b32 v4, 64, v2
buffer_load_dwordx4 v22, s[16:19], s69 offen offset:2048 lds
v_xor_b32 v5, 96, v2
s_xor_b32 s66, s57, s56
s_and_b32 s66, s66, 4
s_or_b32 s66, s66, s67
buffer_load_dwordx4 v23, s[16:19], s69 offen offset:3072 lds
s_xor_b32 s66, s66, 2
s_add_u32 s66, s66, 1
s_lshr_b32 s66, s66, 3
s_lshl_b32 s92, s66, 28
s_mov_b64 exec, 0
s_cmp_eq_u32 s58, 0
s_cbranch_scc1 L_stub12
s_cmp_eq_u32 s58, 1
s_cbranch_scc1 L_stub13
s_cmp_eq_u32 s58, 2
s_cbranch_scc1 L_stub14
s_cmp_eq_u32 s58, 3
s_cbranch_scc1 L_stub15
L_walk_a3:
s_mov_b64 exec, -1
s_mov_b64 exec, 0
s_cmp_eq_u32 s58, 0
s_cbranch_scc1 L_stub16
s_cmp_eq_u32 s58, 1
s_cbranch_scc1 L_stub17
s_cmp_eq_u32 s58, 2
s_cbranch_scc1 L_walk_a4
s_cmp_eq_u32 s58, 3
s_cbranch_scc1 L_walk_a4
L_walk_a4:
s_mov_b64 exec, -1
s_waitcnt lgkmcnt(0)
s_add_u32 s69, s95, 0
buffer_load_dword v28, v1, s[8:11], s69 offen
s_add_u32 s69, s95, 1048576
buffer_load_dword v28, v1, s[8:11], s69 offen
s_mov_b32 s3, 0
s_or_b32 s68, s2, s58
s_cbranch_scc1 L_notag
s_memrealtime s[96:97]
s_waitcnt lgkmcnt(0)
s_bitset1_b32 s97, 31
v_mov_b32 v16, s96
v_mov_b32 v17, s97
v_lshlrev_b32 v18, 8, v0
buffer_store_dwordx2 v[16:17], v18, s[52:55], 0 offen sc1
L_notag:
s_branch L_main
L_exit:
s_endpgm
.p2align 12
L_stub0:
s_cbranch_execz L_walk_a0
s_nop 0
L_main:
s_waitcnt vmcnt(18)
rda 0,6,0
rda 16,7,0
rda 4,6,2048
rda 20,7,2048
rda 8,6,4096
rda 24,7,4096
rda 12,6,6144
rda 28,7,6144
s_waitcnt vmcnt(14)
s_barrier
trv 32,2,0
trv 34,2,512
trv 36,2,4096
trv 38,2,4608
trv 40,2,8192
trv 42,2,8704
trv 44,2,12288
trv 46,2,12800
s_waitcnt vmcnt(12)
rda 32,6,8192
rda 48,7,8192
s_waitcnt vmcnt(10)
rda 36,6,10240
rda 52,7,10240
s_waitcnt vmcnt(8)
rda 40,6,12288
rda 56,7,12288
s_waitcnt vmcnt(6)
rda 44,6,14336
rda 60,7,14336
s_waitcnt lgkmcnt(0)
mva0 128,32,0
trv 48,3,0
s_add_u32 s72, s72, 0x100000
mva 128,36,16
trv 50,3,512
s_bitset0_b32 s72, 22
mva 128,40,32
trv 52,3,4096
s_add_u32 m0, s70, 32768
mva 128,44,48
trv 54,3,4608
s_add_u32 s69, s72, 0
mva0 132,44,52
buffer_load_dwordx4 v20, s[16:19], s69 offen offset:0 lds
mva 132,40,36
trv 56,3,8192
s_lshr_b32 s66, s65, 1
mva 132,36,20
trv 58,3,8704
s_mul_i32 s66, s66, 7
mva 132,32,4
buffer_load_dwordx4 v21, s[16:19], s69 offen offset:1024 lds
mva0 136,32,8
trv 60,3,12288
s_and_b32 s68, s65, 1
mva 136,36,24
trv 62,3,12800
s_mul_i32 s68, s68, 3
mva 136,40,40
s_add_u32 s66, s66, s68
s_lshl_b32 s66, s66, 7
s_lshr_b32 s68, s93, 13
mva 136,44,56
buffer_load_dwordx4 v22, s[16:19], s69 offen offset:2048 lds
mva0 140,44,60
s_mul_i32 s68, s68, 7168
s_add_u32 s82, s66, s68
v_lshrrev_b32 v8, 5, v0
mva 140,40,44
v_mul_u32_u24 v8, 3072, v8
v_add_u32 v8, v8, v1
mva 140,36,28
s_mul_i32 s85, s56, 1049600
s_add_u32 s85, s85, 83886080
s_lshl_b32 s75, s75, 15
mva 140,32,12
s_waitcnt lgkmcnt(0)
s_add_u32 s75, s75, s85
s_add_u32 s96, s75, 0
mva0 156,48,12
buffer_load_dwordx4 v23, s[16:19], s69 offen offset:3072 lds
mva 156,52,28
trv 32,4,0
s_add_u32 m0, s70, 49152
mva 156,56,44
trv 34,4,512
s_add_u32 s69, s72, 128
mva 156,60,60
buffer_load_dwordx4 v20, s[16:19], s69 offen offset:0 lds
mva0 152,60,56
trv 36,4,4096
s_add_u32 s97, s75, 4096
mva 152,56,40
trv 38,4,4608
s_add_u32 s98, s75, 8192
mva 152,52,24
trv 40,4,8192
s_add_u32 s99, s75, 12288
mva 152,48,8
buffer_load_dwordx4 v21, s[16:19], s69 offen offset:1024 lds
mva0 148,48,4
trv 42,4,8704
s_bfe_i32 s68, s58, 0x10001
mva 148,52,20
trv 44,4,12288
s_andn2_b32 s68, 15, s68
mva 148,56,36
trv 46,4,12800
s_xor_b32 s68, s68, s57
mva 148,60,52
buffer_load_dwordx4 v22, s[16:19], s69 offen offset:2048 lds
mva0 144,60,48
s_lshl_b32 s68, s68, 1
s_and_b32 s60, s58, 1
s_add_u32 s60, s60, s68
mva 144,56,32
s_lshl_b32 s68, s60, 16
s_add_u32 s79, s79, s68
s_mov_b32 s76, 0x3e0293ee
mva 144,52,16
s_mov_b32 s77, 0xbfb8aa3b
s_lshr_b32 s66, s65, 1
s_mul_i32 s66, s66, 7
mva 144,48,0
s_waitcnt lgkmcnt(0)
s_and_b32 s68, s56, 7
s_lshl_b32 s68, s68, 2
mva0 160,32,0
buffer_load_dwordx4 v23, s[16:19], s69 offen offset:3072 lds
mva 160,36,16
trv 48,5,0
s_lshr_b32 s68, 0x65342130, s68
mva 160,40,32
trv 50,5,512
s_add_u32 s78, s78, 256
mva 160,44,48
trv 52,5,4096
s_bitset0_b32 s78, 10
mva0 164,44,52
trv 54,5,4608
s_add_u32 m0, s71, 0
mva 164,40,36
trv 56,5,8192
s_add_u32 s69, s78, 0
mva 164,36,20
buffer_load_dwordx4 v10, s[8:11], s69 offen offset:0 lds
mva 164,32,4
trv 58,5,8704
s_and_b32 s68, s68, 7
mva0 168,32,8
trv 60,5,12288
s_add_u32 s59, s66, s68
mva 168,36,24
buffer_load_dwordx4 v11, s[8:11], s69 offen offset:1024 lds
mva 168,40,40
trv 62,5,12800
v_add_u32 v12, s92, v12
mva 168,44,56
s_add_u32 m0, s71, 2048
s_add_u32 s69, s78, 16384
v_add_u32 v13, s92, v13
mva0 172,44,60
v_add_u32 v14, s92, v14
v_add_u32 v15, s92, v15
mva 172,40,44
buffer_load_dwordx4 v10, s[8:11], s69 offen offset:0 lds
mva 172,36,28
s_lshl_b32 s73, s59, 7
s_mul_i32 s0, s60, 230400
s_lshl_b32 s1, s59, 13
mva 172,32,12
s_waitcnt vmcnt(13) lgkmcnt(0)
s_barrier
s_add_u32 s0, s0, s1
mva0 188,48,12
trv 32,2,16384
s_add_u32 s0, s0, 50331648
mva 188,52,28
buffer_load_dwordx4 v11, s[8:11], s69 offen offset:1024 lds
mva 188,56,44
trv 34,2,16896
s_add_u32 s1, s0, 4096
mva 188,60,60
trv 36,2,20480
s_add_u32 m0, s71, 4096
mva0 184,60,56
trv 38,2,20992
s_add_u32 s69, s78, 32768
mva 184,56,40
buffer_load_dwordx4 v10, s[8:11], s69 offen offset:0 lds
mva 184,52,24
trv 40,2,24576
s_lshl_b32 s66, s57, 5
mva 184,48,8
trv 42,2,25088
s_add_u32 s66, s66, s56
mva0 180,48,4
trv 44,2,28672
s_lshl_b32 s66, s66, 10
mva 180,52,20
buffer_load_dwordx4 v11, s[8:11], s69 offen offset:1024 lds
mva 180,56,36
trv 46,2,29184
s_add_u32 s74, s66, 59768832
mva 180,60,52
s_xor_b32 s68, s58, 2
s_lshl_b32 s68, s68, 30
s_add_u32 s59, s68, s74
mva0 176,60,48
s_add_u32 m0, s71, 6144
s_add_u32 s69, s78, 49152
v_min_u32 v29, 1, v0
mva 176,56,32
buffer_load_dwordx4 v10, s[8:11], s69 offen offset:0 lds
mva 176,52,16
v_lshl_add_u32 v29, v29, 27, s59
s_lshl_b32 s62, s58, 13
mva 176,48,0
s_waitcnt lgkmcnt(0)
s_add_u32 s84, s85, s62
s_add_u32 s62, s62, 0x8000
mva0 192,32,0
trv 48,3,16384
mva 192,36,16
buffer_load_dwordx4 v11, s[8:11], s69 offen offset:1024 lds
mva 192,40,32
trv 50,3,16896
mva 192,44,48
trv 52,3,20480
mva0 196,44,52
trv 54,3,20992
mva 196,40,36
trv 56,3,24576
s_add_u32 m0, s71, 8192
mva 196,36,20
trv 58,3,25088
s_add_u32 s69, s78, 128
mva 196,32,4
buffer_load_dwordx4 v10, s[8:11], s69 offen offset:0 lds
mva0 200,32,8
trv 60,3,28672
mva 200,36,24
trv 62,3,29184
mva 200,40,40
buffer_load_dwordx4 v11, s[8:11], s69 offen offset:1024 lds
mva 200,44,56
s_add_u32 s88, s48, s84
s_addc_u32 s89, s49, 0
mva0 204,44,60
s_mul_i32 s64, s60, 525312
s_lshl_b32 s68, s56, 14
s_add_u32 s64, s64, s68
mva 204,40,44
s_add_u32 m0, s71, 10240
s_add_u32 s69, s78, 16512
mva 204,36,28
buffer_load_dwordx4 v10, s[8:11], s69 offen offset:0 lds
mva 204,32,12
s_waitcnt lgkmcnt(0)
mva0 220,48,12
trv 32,4,16384
mva 220,52,28
trv 34,4,16896
mva 220,56,44
buffer_load_dwordx4 v11, s[8:11], s69 offen offset:1024 lds
mva 220,60,60
trv 36,4,20480
mva0 216,60,56
trv 38,4,20992
mva 216,56,40
trv 40,4,24576
mva 216,52,24
trv 42,4,25088
s_add_u32 m0, s71, 12288
mva 216,48,8
trv 44,4,28672
s_add_u32 s69, s78, 32896
mva0 212,48,4
buffer_load_dwordx4 v10, s[8:11], s69 offen offset:0 lds
mva 212,52,20
trv 46,4,29184
mva 212,56,36
mva 212,60,52
buffer_load_dwordx4 v11, s[8:11], s69 offen offset:1024 lds
mva0 208,60,48
mva 208,56,32
mva 208,52,16
s_waitcnt vmcnt(12)
rda 64,6,0
mva 208,48,0
s_waitcnt lgkmcnt(1)
s_add_u32 m0, s71, 14336
s_add_u32 s69, s78, 49280
mva0 224,32,0
buffer_load_dwordx4 v10, s[8:11], s69 offen offset:0 lds
mva 224,36,16
rda 80,7,0
mva 224,40,32
trv 48,5,16384
mva 224,44,48
buffer_load_dwordx4 v11, s[8:11], s69 offen offset:1024 lds
mva0 228,44,52
trv 50,5,16896
s_add_u32 s72, s72, 0x100000
mva 228,40,36
trv 52,5,20480
s_bitset0_b32 s72, 22
mva 228,36,20
trv 54,5,20992
s_add_u32 m0, s70, 65536
mva 228,32,4
trv 56,5,24576
s_add_u32 s69, s72, 0
mva0 232,32,8
trv 58,5,25088
s_waitcnt vmcnt(12)
mva 232,36,24
trv 60,5,28672
mva 232,40,40
trv 62,5,29184
mva 232,44,56
buffer_load_dwordx4 v20, s[16:19], s69 offen offset:0 lds
mva0 236,44,60
rda 68,6,2048
mva 236,40,44
rda 84,7,2048
s_waitcnt vmcnt(11)
mva 236,36,28
buffer_load_dwordx4 v21, s[16:19], s69 offen offset:1024 lds
mva 236,32,12
s_waitcnt lgkmcnt(2)
s_barrier
mva0 252,48,12
rda 72,6,4096
rda 88,7,4096
mva 252,52,28
trv 32,2,32768
s_waitcnt vmcnt(10)
mva 252,56,44
rda 76,6,6144
rda 92,7,6144
mva 252,60,60
buffer_load_dwordx4 v22, s[16:19], s69 offen offset:2048 lds
mva0 248,60,56
trv 34,2,33280
s_waitcnt vmcnt(9)
rda 96,6,8192
rda 112,7,8192
mva 248,56,40
trv 36,2,36864
s_waitcnt vmcnt(7)
mva 248,52,24
rda 100,6,10240
rda 116,7,10240
trv 38,2,37376
mva 248,48,8
trv 40,2,40960
s_waitcnt vmcnt(5)
mva0 244,48,4
rda 104,6,12288
rda 120,7,12288
trv 42,2,41472
mva 244,52,20
trv 44,2,45056
s_waitcnt vmcnt(3)
mva 244,56,36
rda 108,6,14336
rda 124,7,14336
trv 46,2,45568
mva 244,60,52
buffer_load_dwordx4 v23, s[16:19], s69 offen offset:3072 lds
mva0 240,60,48
s_add_u32 m0, s70, 81920
s_add_u32 s69, s72, 128
mva 240,56,32
mva 240,52,16
buffer_load_dwordx4 v20, s[16:19], s69 offen offset:0 lds
mva 240,48,0
s_waitcnt lgkmcnt(0)
mva 128,32,64
trv 48,3,32768
mva 128,36,80
trv 50,3,33280
mva 128,40,96
buffer_load_dwordx4 v21, s[16:19], s69 offen offset:1024 lds
mva 128,44,112
trv 52,3,36864
mva 132,44,116
trv 54,3,37376
mva 132,40,100
trv 56,3,40960
mva 132,36,84
buffer_load_dwordx4 v22, s[16:19], s69 offen offset:2048 lds
mva 132,32,68
trv 58,3,41472
mva 136,32,72
trv 60,3,45056
mva 136,36,88
trv 62,3,45568
mva 136,40,104
buffer_load_dwordx4 v23, s[16:19], s69 offen offset:3072 lds
mva 136,44,120
s_add_u32 s78, s78, 256
s_bitset0_b32 s78, 10
s_add_u32 m0, s71, 0
mva 140,44,124
s_add_u32 s69, s78, 0
mva 140,40,108
mva 140,36,92
buffer_load_dwordx4 v10, s[8:11], s69 offen offset:0 lds
mva 140,32,76
s_waitcnt lgkmcnt(0)
mva 156,48,76
trv 32,4,32768
mva 156,52,92
trv 34,4,33280
mva 156,56,108
buffer_load_dwordx4 v11, s[8:11], s69 offen offset:1024 lds
mva 156,60,124
trv 36,4,36864
s_add_u32 m0, s71, 2048
mva 152,60,120
trv 38,4,37376
s_add_u32 s69, s78, 16384
mva 152,56,104
trv 40,4,40960
mva 152,52,88
buffer_load_dwordx4 v10, s[8:11], s69 offen offset:0 lds
mva 152,48,72
trv 42,4,41472
mva 148,48,68
trv 44,4,45056
mva 148,52,84
trv 46,4,45568
mva 148,56,100
buffer_load_dwordx4 v11, s[8:11], s69 offen offset:1024 lds
mva 148,60,116
s_add_u32 m0, s71, 4096
s_add_u32 s69, s78, 32768
mva 144,60,112
mva 144,56,96
mva 144,52,80
buffer_load_dwordx4 v10, s[8:11], s69 offen offset:0 lds
mva 144,48,64
s_waitcnt lgkmcnt(0)
mva 160,32,64
trv 48,5,32768
mva 160,36,80
trv 50,5,33280
mva 160,40,96
buffer_load_dwordx4 v11, s[8:11], s69 offen offset:1024 lds
mva 160,44,112
trv 52,5,36864
mva 164,44,116
trv 54,5,37376
s_add_u32 m0, s71, 6144
mva 164,40,100
trv 56,5,40960
s_add_u32 s69, s78, 49152
mva 164,36,84
buffer_load_dwordx4 v10, s[8:11], s69 offen offset:0 lds
mva 164,32,68
trv 58,5,41472
mva 168,32,72
trv 60,5,45056
mva 168,36,88
trv 62,5,45568
mva 168,40,104
buffer_load_dwordx4 v11, s[8:11], s69 offen offset:1024 lds
mva 168,44,120
mva 172,44,124
s_add_u32 m0, s71, 8192
s_add_u32 s69, s78, 128
mva 172,40,108
mva 172,36,92
buffer_load_dwordx4 v10, s[8:11], s69 offen offset:0 lds
mva 172,32,76
s_waitcnt lgkmcnt(0)
mva 188,48,76
trv 32,2,49152
mva 188,52,92
trv 34,2,49664
mva 188,56,108
buffer_load_dwordx4 v11, s[8:11], s69 offen offset:1024 lds
mva 188,60,124
trv 36,2,53248
mva 184,60,120
trv 38,2,53760
mva 184,56,104
trv 40,2,57344
s_add_u32 m0, s71, 10240
mva 184,52,88
trv 42,2,57856
s_add_u32 s69, s78, 16512
mva 184,48,72
buffer_load_dwordx4 v10, s[8:11], s69 offen offset:0 lds
mva 180,48,68
trv 44,2,61440
mva 180,52,84
trv 46,2,61952
mva 180,56,100
buffer_load_dwordx4 v11, s[8:11], s69 offen offset:1024 lds
mva 180,60,116
mva 176,60,112
mva 176,56,96
mva 176,52,80
s_add_u32 m0, s71, 12288
s_add_u32 s69, s78, 32896
mva 176,48,64
s_waitcnt lgkmcnt(0)
mva 192,32,64
buffer_load_dwordx4 v10, s[8:11], s69 offen offset:0 lds
mva 192,36,80
trv 48,3,49152
mva 192,40,96
trv 50,3,49664
mva 192,44,112
buffer_load_dwordx4 v11, s[8:11], s69 offen offset:1024 lds
mva 196,44,116
trv 52,3,53248
mva 196,40,100
trv 54,3,53760
mva 196,36,84
trv 56,3,57344
s_add_u32 m0, s71, 14336
mva 196,32,68
trv 58,3,57856
s_add_u32 s69, s78, 49280
mva 200,32,72
buffer_load_dwordx4 v10, s[8:11], s69 offen offset:0 lds
mva 200,36,88
trv 60,3,61440
s_waitcnt vmcnt(13)
mva 200,40,104
trv 62,3,61952
mva 200,44,120
buffer_load_dwordx4 v11, s[8:11], s69 offen offset:1024 lds
mva 204,44,124
rda 128,6,0
s_add_u32 s72, s72, 0x100000
mva 204,40,108
rda 144,7,0
s_bitset0_b32 s72, 22
mva 204,36,92
s_add_u32 m0, s70, 0
s_add_u32 s69, s72, 0
mva 204,32,76
s_waitcnt lgkmcnt(2)
s_waitcnt vmcnt(12)
mva 220,48,76
buffer_load_dwordx4 v20, s[16:19], s69 offen offset:0 lds
mva 220,52,92
rda 132,6,2048
mva 220,56,108
rda 148,7,2048
mva 220,60,124
trv 32,4,49152
mva 216,60,120
trv 34,4,49664
mva 216,56,104
trv 36,4,53248
mva 216,52,88
L_stub1:
s_cbranch_execz L_walk_a0
trv 38,4,53760
mva 216,48,72
trv 40,4,57344
s_waitcnt vmcnt(11)
mva 212,48,68
trv 42,4,57856
mva 212,52,84
trv 44,4,61440
mva 212,56,100
trv 46,4,61952
mva 212,60,116
buffer_load_dwordx4 v21, s[16:19], s69 offen offset:1024 lds
mva 208,60,112
rda 136,6,4096
mva 208,56,96
rda 152,7,4096
mva 208,52,80
buffer_load_dwordx4 v22, s[16:19], s69 offen offset:2048 lds
mva 208,48,64
s_waitcnt lgkmcnt(2)
mva 224,32,64
trv 48,5,49152
s_waitcnt vmcnt(11)
mva 224,36,80
rda 140,6,6144
mva 224,40,96
buffer_load_dwordx4 v23, s[16:19], s69 offen offset:3072 lds
mva 224,44,112
rda 156,7,6144
s_add_u32 m0, s70, 16384
mva 228,44,116
trv 50,5,49664
s_add_u32 s69, s72, 128
mva 228,40,100
trv 52,5,53248
mva 228,36,84
trv 54,5,53760
mva 228,32,68
trv 56,5,57344
mva 232,32,72
trv 58,5,57856
mva 232,36,88
trv 60,5,61440
s_waitcnt vmcnt(10)
mva 232,40,104
trv 62,5,61952
mva 232,44,120
buffer_load_dwordx4 v20, s[16:19], s69 offen offset:0 lds
mva 236,44,124
rda 160,6,8192
v_xor_b32 v2, 0x10000, v2
mva 236,40,108
rda 176,7,8192
v_xor_b32 v3, 0x10000, v3
mva 236,36,92
buffer_load_dwordx4 v21, s[16:19], s69 offen offset:1024 lds
mva 236,32,76
s_waitcnt lgkmcnt(2)
s_barrier
v_xor_b32 v4, 0x10000, v4
v_xor_b32 v5, 0x10000, v5
mva 252,48,76
trv 32,2,0
s_waitcnt vmcnt(10)
mva 252,52,92
rda 164,6,10240
mva 252,56,108
buffer_load_dwordx4 v22, s[16:19], s69 offen offset:2048 lds
mva 252,60,124
rda 180,7,10240
s_waitcnt vmcnt(9)
mva 248,60,120
trv 34,2,512
mva 248,56,104
trv 36,2,4096
mva 248,52,88
trv 38,2,4608
mva 248,48,72
trv 40,2,8192
mva 244,48,68
rda 168,6,12288
rda 184,7,12288
trv 42,2,8704
mva 244,52,84
trv 44,2,12288
s_waitcnt vmcnt(7)
mva 244,56,100
rda 172,6,14336
rda 188,7,14336
trv 46,2,12800
mva 244,60,116
buffer_load_dwordx4 v23, s[16:19], s69 offen offset:3072 lds
mva 240,60,112
s_add_u32 s78, s78, 256
s_bitset0_b32 s78, 10
s_add_u32 m0, s71, 0
mva 240,56,96
s_add_u32 s69, s78, 0
mva 240,52,80
buffer_load_dwordx4 v10, s[8:11], s69 offen offset:0 lds
mva 240,48,64
s_waitcnt lgkmcnt(0)
mva 128,32,128
trv 48,3,0
mva 128,36,144
trv 50,3,512
mva 128,40,160
buffer_load_dwordx4 v11, s[8:11], s69 offen offset:1024 lds
mva 128,44,176
trv 52,3,4096
s_add_u32 m0, s71, 2048
mva 132,44,180
trv 54,3,4608
s_add_u32 s69, s78, 16384
mva 132,40,164
trv 56,3,8192
mva 132,36,148
buffer_load_dwordx4 v10, s[8:11], s69 offen offset:0 lds
mva 132,32,132
trv 58,3,8704
mva 136,32,136
trv 60,3,12288
mva 136,36,152
trv 62,3,12800
mva 136,40,168
buffer_load_dwordx4 v11, s[8:11], s69 offen offset:1024 lds
mva 136,44,184
s_add_u32 m0, s71, 4096
s_add_u32 s69, s78, 32768
mva 140,44,188
mva 140,40,172
mva 140,36,156
buffer_load_dwordx4 v10, s[8:11], s69 offen offset:0 lds
mva 140,32,140
s_waitcnt lgkmcnt(0)
mva 156,48,140
trv 32,4,0
mva 156,52,156
trv 34,4,512
mva 156,56,172
buffer_load_dwordx4 v11, s[8:11], s69 offen offset:1024 lds
mva 156,60,188
trv 36,4,4096
s_add_u32 m0, s71, 6144
mva 152,60,184
trv 38,4,4608
s_add_u32 s69, s78, 49152
mva 152,56,168
trv 40,4,8192
mva 152,52,152
buffer_load_dwordx4 v10, s[8:11], s69 offen offset:0 lds
mva 152,48,136
trv 42,4,8704
mva 148,48,132
trv 44,4,12288
mva 148,52,148
trv 46,4,12800
mva 148,56,164
buffer_load_dwordx4 v11, s[8:11], s69 offen offset:1024 lds
mva 148,60,180
s_add_u32 m0, s71, 8192
s_add_u32 s69, s78, 128
mva 144,60,176
mva 144,56,160
mva 144,52,144
buffer_load_dwordx4 v10, s[8:11], s69 offen offset:0 lds
mva 144,48,128
s_waitcnt lgkmcnt(0)
mva 160,32,128
trv 48,5,0
mva 160,36,144
trv 50,5,512
mva 160,40,160
buffer_load_dwordx4 v11, s[8:11], s69 offen offset:1024 lds
mva 160,44,176
trv 52,5,4096
s_add_u32 m0, s71, 10240
mva 164,44,180
trv 54,5,4608
s_add_u32 s69, s78, 16512
mva 164,40,164
trv 56,5,8192
mva 164,36,148
buffer_load_dwordx4 v10, s[8:11], s69 offen offset:0 lds
mva 164,32,132
trv 58,5,8704
mva 168,32,136
trv 60,5,12288
mva 168,36,152
trv 62,5,12800
mva 168,40,168
buffer_load_dwordx4 v11, s[8:11], s69 offen offset:1024 lds
mva 168,44,184
s_add_u32 m0, s71, 12288
s_add_u32 s69, s78, 32896
mva 172,44,188
mva 172,40,172
mva 172,36,156
buffer_load_dwordx4 v10, s[8:11], s69 offen offset:0 lds
mva 172,32,140
s_waitcnt lgkmcnt(0)
s_waitcnt vmcnt(11)
mva 188,48,140
rda 192,6,0
mva 188,52,156
rda 208,7,0
mva 188,56,172
buffer_load_dwordx4 v11, s[8:11], s69 offen offset:1024 lds
mva 188,60,188
trv 32,2,16384
s_add_u32 m0, s71, 14336
mva 184,60,184
trv 34,2,16896
s_add_u32 s69, s78, 49280
mva 184,56,168
trv 36,2,20480
mva 184,52,152
trv 38,2,20992
s_waitcnt vmcnt(10)
mva 184,48,136
trv 40,2,24576
mva 180,48,132
trv 42,2,25088
mva 180,52,148
trv 44,2,28672
mva 180,56,164
trv 46,2,29184
mva 180,60,180
buffer_load_dwordx4 v10, s[8:11], s69 offen offset:0 lds
mva 176,60,176
rda 196,6,2048
mva 176,56,160
rda 212,7,2048
mva 176,52,144
buffer_load_dwordx4 v11, s[8:11], s69 offen offset:1024 lds
mva 176,48,128
s_waitcnt lgkmcnt(2)
s_add_u32 s72, s72, 0x100000
s_bitset0_b32 s72, 22
mva 192,32,128
trv 48,3,16384
s_add_u32 m0, s70, 32768
mva 192,36,144
trv 50,3,16896
s_add_u32 s69, s72, 0
mva 192,40,160
buffer_load_dwordx4 v20, s[20:23], s69 offen offset:0 lds
mva 192,44,176
trv 52,3,20480
s_waitcnt vmcnt(11)
mva 196,44,180
rda 200,6,4096
mva 196,40,164
rda 216,7,4096
mva 196,36,148
trv 54,3,20992
mva 196,32,132
trv 56,3,24576
mva 200,32,136
trv 58,3,25088
s_waitcnt vmcnt(9)
mva 200,36,152
trv 60,3,28672
mva 200,40,168
trv 62,3,29184
mva 200,44,184
buffer_load_dwordx4 v21, s[20:23], s69 offen offset:1024 lds
mva 204,44,188
rda 204,6,6144
mva 204,40,172
rda 220,7,6144
mva 204,36,156
buffer_load_dwordx4 v22, s[20:23], s69 offen offset:2048 lds
mva 204,32,140
s_waitcnt lgkmcnt(2)
mva 220,48,140
trv 32,4,16384
s_waitcnt vmcnt(9)
mva 220,52,156
rda 224,6,8192
mva 220,56,172
buffer_load_dwordx4 v23, s[20:23], s69 offen offset:3072 lds
mva 220,60,188
rda 240,7,8192
s_add_u32 m0, s70, 49152
mva 216,60,184
trv 34,4,16896
s_add_u32 s69, s72, 128
mva 216,56,168
trv 36,4,20480
mva 216,52,152
trv 38,4,20992
mva 216,48,136
trv 40,4,24576
mva 212,48,132
trv 42,4,25088
mva 212,52,148
trv 44,4,28672
s_waitcnt vmcnt(8)
mva 212,56,164
trv 46,4,29184
mva 212,60,180
buffer_load_dwordx4 v20, s[20:23], s69 offen offset:0 lds
mva 208,60,176
rda 228,6,10240
s_lshl_b32 s66, s60, 5
mva 208,56,160
rda 244,7,10240
s_add_u32 s66, s66, s56
mva 208,52,144
buffer_load_dwordx4 v21, s[20:23], s69 offen offset:1024 lds
mva 208,48,128
s_waitcnt lgkmcnt(2)
s_lshl_b32 s66, s66, 11
mva 224,32,128
trv 48,5,16384
mva 224,36,144
trv 50,5,16896
mva 224,40,160
buffer_load_dwordx4 v22, s[20:23], s69 offen offset:2048 lds
mva 224,44,176
trv 52,5,20480
s_waitcnt vmcnt(9)
mva 228,44,180
rda 232,6,12288
mva 228,40,164
rda 248,7,12288
mva 228,36,148
trv 54,5,20992
mva 228,32,132
trv 56,5,24576
mva 232,32,136
trv 58,5,25088
mva 232,36,152
trv 60,5,28672
mva 232,40,168
trv 62,5,29184
s_waitcnt vmcnt(7)
mva 232,44,184
buffer_load_dwordx4 v23, s[20:23], s69 offen offset:3072 lds
mva 236,44,188
rda 236,6,14336
s_add_u32 s72, s72, 0x100000
mva 236,40,172
rda 252,7,14336
s_bitset0_b32 s72, 22
mva 236,36,156
buffer_load_dwordx4 v[120:123], v1, s[40:43], 0 offen
mva 236,32,140
s_waitcnt lgkmcnt(2)
s_barrier
v_xor_b32 v2, 0x10000, v2
v_xor_b32 v3, 0x10000, v3
v_xor_b32 v4, 0x10000, v4
v_xor_b32 v5, 0x10000, v5
mva 252,48,140
trv 32,2,0
s_add_u32 m0, s70, 65536
mva 252,52,156
trv 34,2,512
s_add_u32 s69, s72, 0
mva 252,56,172
buffer_load_dwordx4 v20, s[20:23], s69 offen offset:0 lds
mva 252,60,188
trv 36,2,4096
mva 248,60,184
trv 38,2,4608
mva 248,56,168
trv 40,2,8192
mva 248,52,152
buffer_load_dwordx4 v21, s[20:23], s69 offen offset:1024 lds
mva 248,48,136
trv 42,2,8704
mva 244,48,132
trv 44,2,12288
mva 244,52,148
trv 46,2,12800
mva 244,56,164
buffer_load_dwordx4 v22, s[20:23], s69 offen offset:2048 lds
mva 244,60,180
mva 240,60,176
mva 240,56,160
mva 240,52,144
buffer_load_dwordx4 v23, s[20:23], s69 offen offset:3072 lds
mva 240,48,128
s_waitcnt lgkmcnt(0)
s_add_u32 s69, s82, 0
mva 128,32,192
trv 48,3,0
mva 128,36,208
trv 50,3,512
mva 128,40,224
trv 52,3,4096
mva 128,44,240
buffer_load_dwordx4 v[112:115], v1, s[4:7], s66 offen
buffer_load_dwordx4 v[116:119], v1, s[4:7], s66 offen offset:1024
mva 132,44,244
trv 54,3,4608
mva 132,40,228
trv 56,3,8192
s_nop 0
mva 132,36,212
trv 58,3,8704
v_mul_f32 v128, s76, v128
mva 132,32,196
trv 60,3,12288
v_mul_f32 v129, s76, v129
mva 136,32,200
trv 62,3,12800
v_mul_f32 v130, s76, v130
mva 136,36,216
v_mul_f32 v131, s76, v131
v_cvt_pk_bf16_f32 v64, v128, v129
mva 136,40,232
v_cvt_pk_bf16_f32 v65, v130, v131
v_mul_f32 v132, s76, v132
mva 136,44,248
v_mul_f32 v133, s76, v133
v_mul_f32 v134, s76, v134
mva 140,44,252
v_mul_f32 v135, s76, v135
v_cvt_pk_bf16_f32 v68, v132, v133
mva 140,40,236
v_cvt_pk_bf16_f32 v69, v134, v135
s_nop 0
mva 140,36,220
v_mul_f32 v136, s76, v136
v_mul_f32 v137, s76, v137
mva 140,32,204
s_waitcnt lgkmcnt(0)
v_mul_f32 v138, s76, v138
v_mul_f32 v139, s76, v139
mva 156,48,204
buffer_load_dword v28, v8, s[28:31], s69 offen
mva 156,52,220
trv 32,4,0
v_cvt_pk_bf16_f32 v72, v136, v137
mva 156,56,236
trv 34,4,512
v_cvt_pk_bf16_f32 v73, v138, v139
mva 156,60,252
trv 36,4,4096
v_mul_f32 v140, s76, v140
mva 152,60,248
trv 38,4,4608
v_mul_f32 v141, s76, v141
mva 152,56,232
trv 40,4,8192
v_mul_f32 v142, s76, v142
mva 152,52,216
trv 42,4,8704
v_mul_f32 v143, s76, v143
mva 152,48,200
trv 44,4,12288
v_cvt_pk_bf16_f32 v76, v140, v141
mva 148,48,196
trv 46,4,12800
v_cvt_pk_bf16_f32 v77, v142, v143
mva 148,52,212
v_mul_f32 v156, s76, v156
v_mul_f32 v157, s76, v157
mva 148,56,228
v_mul_f32 v152, s76, v152
v_mul_f32 v153, s76, v153
mva 148,60,244
v_mul_f32 v154, s76, v154
v_mul_f32 v155, s76, v155
mva 144,60,240
v_cvt_pk_bf16_f32 v74, v152, v153
v_cvt_pk_bf16_f32 v75, v154, v155
mva 144,56,224
v_mul_f32 v158, s76, v158
v_mul_f32 v159, s76, v159
mva 144,52,208
v_mul_f32 v148, s76, v148
v_mul_f32 v149, s76, v149
mva 144,48,192
s_waitcnt lgkmcnt(0)
v_mul_f32 v150, s76, v150
v_mul_f32 v151, s76, v151
mva 160,32,192
buffer_load_dword v28, v8, s[32:35], s69 offen
mva 160,36,208
trv 48,5,0
v_cvt_pk_bf16_f32 v70, v148, v149
mva 160,40,224
trv 50,5,512
v_mul_f32 v144, s76, v144
mva 160,44,240
buffer_load_dwordx2 v[16:17], off, s[52:55], 0 sc1
mva 164,44,244
trv 52,5,4096
s_add_u32 m0, s70, 81920
mva 164,40,228
trv 54,5,4608
s_add_u32 s69, s72, 128
mva 164,36,212
trv 56,5,8192
v_mul_f32 v145, s76, v145
mva 164,32,196
trv 58,5,8704
v_mul_f32 v146, s76, v146
mva 168,32,200
buffer_load_dwordx4 v20, s[20:23], s69 offen offset:0 lds
mva 168,36,216
trv 60,5,12288
v_mul_f32 v147, s76, v147
mva 168,40,232
trv 62,5,12800
v_cvt_pk_bf16_f32 v66, v144, v145
mva 168,44,248
buffer_load_dwordx4 v21, s[20:23], s69 offen offset:1024 lds
mva 172,44,252
v_cvt_pk_bf16_f32 v67, v146, v147
v_cvt_pk_bf16_f32 v71, v150, v151
mva 172,40,236
v_cvt_pk_bf16_f32 v78, v156, v157
v_cvt_pk_bf16_f32 v79, v158, v159
mva 172,36,220
v_mul_f32 v160, s76, v160
v_mul_f32 v161, s76, v161
mva 172,32,204
s_waitcnt lgkmcnt(0)
v_mul_f32 v162, s76, v162
v_mul_f32 v163, s76, v163
mva 188,48,204
buffer_load_dwordx4 v22, s[20:23], s69 offen offset:2048 lds
mva 188,52,220
trv 32,2,16384
v_cvt_pk_bf16_f32 v80, v160, v161
mva 188,56,236
trv 34,2,16896
v_cvt_pk_bf16_f32 v81, v162, v163
mva 188,60,252
buffer_load_dwordx4 v23, s[20:23], s69 offen offset:3072 lds
mva 184,60,248
trv 36,2,20480
s_add_u32 s69, s82, 917504
mva 184,56,232
trv 38,2,20992
v_mul_f32 v164, s76, v164
mva 184,52,216
trv 40,2,24576
v_mul_f32 v165, s76, v165
mva 184,48,200
buffer_load_dword v28, v8, s[28:31], s69 offen
mva 180,48,196
trv 42,2,25088
v_mul_f32 v166, s76, v166
mva 180,52,212
trv 44,2,28672
v_mul_f32 v167, s76, v167
mva 180,56,228
L_stub2:
s_cbranch_execz L_walk_a0
trv 46,2,29184
v_cvt_pk_bf16_f32 v84, v164, v165
mva 180,60,244
v_cvt_pk_bf16_f32 v85, v166, v167
v_mul_f32 v168, s76, v168
mva 176,60,240
v_mul_f32 v169, s76, v169
v_mul_f32 v170, s76, v170
mva 176,56,224
v_mul_f32 v171, s76, v171
v_cvt_pk_bf16_f32 v88, v168, v169
mva 176,52,208
v_mul_f32 v180, s76, v180
v_mul_f32 v181, s76, v181
mva 176,48,192
s_waitcnt lgkmcnt(0)
v_mul_f32 v182, s76, v182
v_mul_f32 v183, s76, v183
mva 192,32,192
buffer_load_dword v28, v8, s[32:35], s69 offen
mva 192,36,208
trv 48,3,16384
v_cvt_pk_bf16_f32 v86, v180, v181
mva 192,40,224
trv 50,3,16896
v_mul_f32 v176, s76, v176
mva 192,44,240
trv 52,3,20480
v_mul_f32 v177, s76, v177
mva 196,44,244
trv 54,3,20992
v_mul_f32 v178, s76, v178
mva 196,40,228
trv 56,3,24576
v_mul_f32 v179, s76, v179
mva 196,36,212
trv 58,3,25088
v_cvt_pk_bf16_f32 v82, v176, v177
mva 196,32,196
trv 60,3,28672
v_cvt_pk_bf16_f32 v83, v178, v179
mva 200,32,200
trv 62,3,29184
v_cvt_pk_bf16_f32 v87, v182, v183
mva 200,36,216
v_cvt_pk_bf16_f32 v89, v170, v171
v_mul_f32 v184, s76, v184
mva 200,40,232
v_mul_f32 v185, s76, v185
v_mul_f32 v186, s76, v186
mva 200,44,248
v_mul_f32 v187, s76, v187
v_cvt_pk_bf16_f32 v90, v184, v185
mva 204,44,252
v_cvt_pk_bf16_f32 v91, v186, v187
v_mul_f32 v172, s76, v172
mva 204,40,236
v_mul_f32 v173, s76, v173
v_mul_f32 v174, s76, v174
mva 204,36,220
v_mul_f32 v175, s76, v175
v_cvt_pk_bf16_f32 v92, v172, v173
mva 204,32,204
s_waitcnt lgkmcnt(0)
v_cvt_pk_bf16_f32 v93, v174, v175
v_mul_f32 v188, s76, v188
mva 220,48,204
trv 32,4,16384
v_mul_f32 v189, s76, v189
mva 220,52,220
trv 34,4,16896
v_mul_f32 v190, s76, v190
mva 220,56,236
trv 36,4,20480
v_mul_f32 v191, s76, v191
mva 220,60,252
trv 38,4,20992
v_cvt_pk_bf16_f32 v94, v188, v189
mva 216,60,248
trv 40,4,24576
v_cvt_pk_bf16_f32 v95, v190, v191
mva 216,56,232
trv 42,4,25088
v_mul_f32 v192, s76, v192
mva 216,52,216
trv 44,4,28672
v_mul_f32 v193, s76, v193
mva 216,48,200
trv 46,4,29184
v_mul_f32 v194, s76, v194
mva 212,48,196
v_mul_f32 v195, s76, v195
v_cvt_pk_bf16_f32 v96, v192, v193
mva 212,52,212
v_cvt_pk_bf16_f32 v97, v194, v195
v_mul_f32 v196, s76, v196
mva 212,56,228
v_mul_f32 v197, s76, v197
v_mul_f32 v198, s76, v198
mva 212,60,244
v_mul_f32 v199, s76, v199
v_cvt_pk_bf16_f32 v100, v196, v197
mva 208,60,240
v_cvt_pk_bf16_f32 v101, v198, v199
v_mul_f32 v200, s76, v200
mva 208,56,224
v_mul_f32 v201, s76, v201
v_mul_f32 v202, s76, v202
mva 208,52,208
v_mul_f32 v212, s76, v212
v_mul_f32 v213, s76, v213
mva 208,48,192
s_waitcnt lgkmcnt(0)
v_mul_f32 v214, s76, v214
v_mul_f32 v215, s76, v215
mva 224,32,192
trv 48,5,16384
s_add_u32 m0, s71, 0
mva 224,36,208
trv 50,5,16896
s_add_u32 s69, s79, 0
mva 224,40,224
buffer_load_dwordx4 v10, s[4:7], s69 offen offset:0 lds
mva 224,44,240
trv 52,5,20480
v_mul_f32 v208, s76, v208
mva 228,44,244
trv 54,5,20992
v_mul_f32 v209, s76, v209
mva 228,40,228
buffer_load_dwordx4 v11, s[4:7], s69 offen offset:1024 lds
mva 228,36,212
trv 56,5,24576
s_add_u32 s72, s72, 0x100000
mva 228,32,196
trv 58,5,25088
s_bitset0_b32 s72, 22
mva 232,32,200
trv 60,5,28672
s_add_u32 m0, s70, 0
mva 232,36,216
trv 62,5,29184
s_add_u32 s69, s72, 0
mva 232,40,232
v_mul_f32 v210, s76, v210
v_mul_f32 v211, s76, v211
mva 232,44,248
s_waitcnt vmcnt(11)
v_cvt_pk_bf16_f32 v98, v208, v209
v_cvt_pk_bf16_f32 v99, v210, v211
mva 236,44,252
v_cvt_pk_bf16_f32 v102, v212, v213
v_cvt_pk_bf16_f32 v103, v214, v215
mva 236,40,236
v_lshlrev_b32 v26, 16, v120
v_and_b32 v120, 0xffff0000, v120
mva 236,36,220
v_lshlrev_b32 v24, 16, v112
v_lshlrev_b32 v25, 16, v116
mva 236,32,204
s_waitcnt lgkmcnt(0)
s_barrier
v_and_b32 v112, 0xffff0000, v112
mva 252,48,204
buffer_load_dwordx4 v20, s[20:23], s69 offen offset:0 lds
mva 252,52,220
trv 32,2,32768
v_and_b32 v116, 0xffff0000, v116
mva 252,56,236
trv 34,2,33280
v_mul_f32 v124, v24, v26
mva 252,60,252
buffer_load_dwordx4 v21, s[20:23], s69 offen offset:1024 lds
mva 248,60,248
trv 36,2,36864
v_mul_f32 v125, v25, v26
mva 248,56,232
trv 38,2,37376
v_fmac_f32 v124, v112, v120
mva 248,52,216
trv 40,2,40960
v_fmac_f32 v125, v116, v120
mva 248,48,200
buffer_load_dwordx4 v22, s[20:23], s69 offen offset:2048 lds
mva 244,48,196
trv 42,2,41472
v_lshlrev_b32 v26, 16, v121
mva 244,52,212
trv 44,2,45056
v_and_b32 v121, 0xffff0000, v121
mva 244,56,228
trv 46,2,45568
v_lshlrev_b32 v24, 16, v113
mva 244,60,244
buffer_load_dwordx4 v23, s[20:23], s69 offen offset:3072 lds
mva 240,60,240
s_add_u32 m0, s71, 2048
s_add_u32 s69, s79, 16384
v_lshlrev_b32 v25, 16, v117
mva 240,56,224
v_and_b32 v113, 0xffff0000, v113
v_and_b32 v117, 0xffff0000, v117
mva 240,52,208
v_fmac_f32 v124, v24, v26
v_fmac_f32 v125, v25, v26
mva 240,48,192
s_waitcnt lgkmcnt(0)
v_fmac_f32 v124, v113, v121
v_fmac_f32 v125, v117, v121
mav0 128,0,32
buffer_load_dwordx4 v10, s[4:7], s69 offen offset:0 lds
mav 128,16,36
trv 48,3,32768
v_lshlrev_b32 v26, 16, v122
mav 128,32,40
trv 50,3,33280
v_and_b32 v122, 0xffff0000, v122
mav 128,48,44
buffer_load_dwordx4 v11, s[4:7], s69 offen offset:1024 lds
mav0 132,52,44
buffer_store_dwordx4 v[64:67], v1, s[48:51], s96 offen offset:0 sc1
mav 132,36,40
trv 52,3,36864
s_add_u32 m0, s71, 4096
mav 132,20,36
trv 54,3,37376
s_add_u32 s69, s79, 32768
mav 132,4,32
trv 56,3,40960
v_lshlrev_b32 v24, 16, v114
mav0 136,8,32
trv 58,3,41472
v_lshlrev_b32 v25, 16, v118
mav 136,24,36
trv 60,3,45056
v_and_b32 v114, 0xffff0000, v114
mav 136,40,40
trv 62,3,45568
v_and_b32 v118, 0xffff0000, v118
mav 136,56,44
v_fmac_f32 v124, v24, v26
v_fmac_f32 v125, v25, v26
mav0 140,60,44
v_fmac_f32 v124, v114, v122
v_fmac_f32 v125, v118, v122
mav 140,44,40
v_lshlrev_b32 v26, 16, v123
v_and_b32 v123, 0xffff0000, v123
mav 140,28,36
buffer_load_dwordx4 v10, s[4:7], s69 offen offset:0 lds
mav 140,12,32
s_waitcnt lgkmcnt(0)
v_lshlrev_b32 v24, 16, v115
v_lshlrev_b32 v25, 16, v119
mav0 156,12,48
trv 32,4,32768
v_and_b32 v115, 0xffff0000, v115
mav 156,28,52
trv 34,4,33280
v_and_b32 v119, 0xffff0000, v119
mav 156,44,56
buffer_load_dwordx4 v11, s[4:7], s69 offen offset:1024 lds
mav 156,60,60
trv 36,4,36864
v_fmac_f32 v124, v24, v26
mav0 152,56,60
trv 38,4,37376
s_add_u32 m0, s71, 6144
mav 152,40,56
trv 40,4,40960
s_add_u32 s69, s79, 49152
mav 152,24,52
buffer_load_dwordx4 v10, s[4:7], s69 offen offset:0 lds
mav 152,8,48
trv 42,4,41472
v_fmac_f32 v125, v25, v26
mav0 148,4,48
trv 44,4,45056
v_fmac_f32 v124, v115, v123
mav 148,20,52
trv 46,4,45568
v_fmac_f32 v125, v119, v123
mav 148,36,56
buffer_load_dwordx4 v11, s[4:7], s69 offen offset:1024 lds
mav 148,52,60
v_add_f32_dpp v124, v124, v124 row_ror:8 row_mask:0xf bank_mask:0xf
v_add_f32_dpp v125, v125, v125 row_ror:8 row_mask:0xf bank_mask:0xf
mav0 144,48,60
v_add_f32_dpp v124, v124, v124 row_ror:4 row_mask:0xf bank_mask:0xf
v_add_f32_dpp v125, v125, v125 row_ror:4 row_mask:0xf bank_mask:0xf
mav 144,32,56
v_add_f32_dpp v124, v124, v124 row_ror:2 row_mask:0xf bank_mask:0xf
v_add_f32_dpp v125, v125, v125 row_ror:2 row_mask:0xf bank_mask:0xf
mav 144,16,52
buffer_store_dwordx4 v[68:71], v1, s[48:51], s97 offen offset:0 sc1
mav 144,0,48
s_waitcnt lgkmcnt(0)
v_add_f32_dpp v124, v124, v124 row_ror:1 row_mask:0xf bank_mask:0xf
v_add_f32_dpp v125, v125, v125 row_ror:1 row_mask:0xf bank_mask:0xf
mav0 160,0,32
trv 48,5,32768
v_mov_b32 v24, v124
mav 160,16,36
trv 50,5,33280
v_mov_b32 v25, v125
mav 160,32,40
trv 52,5,36864
v_permlane32_swap_b32 v24, v124
mav 160,48,44
trv 54,5,37376
v_permlane32_swap_b32 v25, v125
mav0 164,52,44
trv 56,5,40960
v_add_f32 v124, v124, v24
mav 164,36,40
trv 58,5,41472
v_add_f32 v125, v125, v25
mav 164,20,36
trv 60,5,45056
s_add_u32 m0, s71, 8192
mav 164,4,32
trv 62,5,45568
s_add_u32 s69, s79, 128
mav0 168,8,32
buffer_load_dwordx4 v10, s[4:7], s69 offen offset:0 lds
mav 168,24,36
v_mov_b32 v24, v124
v_mov_b32 v25, v125
mav 168,40,40
v_permlane16_swap_b32 v24, v124
v_permlane16_swap_b32 v25, v125
mav 168,56,44
buffer_load_dwordx4 v11, s[4:7], s69 offen offset:1024 lds
mav0 172,60,44
s_add_u32 m0, s70, 16384
s_add_u32 s69, s72, 128
v_add_f32 v124, v124, v24
mav 172,44,40
v_add_f32 v125, v125, v25
v_mul_f32 v124, s77, v124
mav 172,28,36
v_mul_f32 v125, s77, v125
v_mul_f32 v203, s76, v203
mav 172,12,32
s_waitcnt lgkmcnt(0)
v_exp_f32 v124, v124
mav0 188,12,48
buffer_load_dwordx4 v20, s[20:23], s69 offen offset:0 lds
mav 188,28,52
trv 32,2,49152
v_cvt_pk_bf16_f32 v104, v200, v201
mav 188,44,56
trv 34,2,49664
v_cvt_pk_bf16_f32 v105, v202, v203
mav 188,60,60
buffer_load_dwordx4 v21, s[20:23], s69 offen offset:1024 lds
mav0 184,56,60
trv 36,2,53248
v_mul_f32 v216, s76, v216
mav 184,40,56
trv 38,2,53760
v_mul_f32 v217, s76, v217
mav 184,24,52
trv 40,2,57344
v_mul_f32 v218, s76, v218
mav 184,8,48
buffer_load_dwordx4 v22, s[20:23], s69 offen offset:2048 lds
mav0 180,4,48
trv 42,2,57856
v_mul_f32 v219, s76, v219
mav 180,20,52
trv 44,2,61440
v_cvt_pk_bf16_f32 v106, v216, v217
mav 180,36,56
trv 46,2,61952
v_cvt_pk_bf16_f32 v107, v218, v219
mav 180,52,60
buffer_load_dwordx4 v23, s[20:23], s69 offen offset:3072 lds
mav0 176,48,60
s_add_u32 m0, s71, 10240
v_exp_f32 v125, v125
mav 176,32,56
s_add_u32 s69, s79, 16512
v_add_f32 v124, 1.0, v124
v_add_f32 v125, 1.0, v125
mav 176,16,52
v_rcp_f32 v124, v124
mav 176,0,48
s_waitcnt lgkmcnt(0)
v_rcp_f32 v125, v125
mav0 192,0,32
buffer_load_dwordx4 v10, s[4:7], s69 offen offset:0 lds
mav 192,16,36
trv 48,3,49152
s_lshl_b32 s66, s60, 5
mav 192,32,40
buffer_store_dwordx4 v[72:75], v1, s[48:51], s98 offen offset:0 sc1
mav 192,48,44
trv 50,3,49664
s_add_u32 s66, s66, s56
mav0 196,52,44
s_lshl_b32 s66, s66, 3
s_add_u32 s66, s66, 58720256
v_min_u32 v24, 1, v0
v_lshlrev_b32 v24, 27, v24
buffer_store_dwordx2 v[124:125], v24, s[48:51], s66 offen sc1
mav 196,36,40
trv 52,3,53248
v_mul_f32 v204, s76, v204
mav 196,20,36
trv 54,3,53760
v_mul_f32 v205, s76, v205
mav 196,4,32
trv 56,3,57344
v_mul_f32 v206, s76, v206
mav0 200,8,32
trv 58,3,57856
v_mul_f32 v207, s76, v207
v_cvt_pk_bf16_f32 v108, v204, v205
v_cvt_pk_bf16_f32 v109, v206, v207
v_mul_f32 v220, s76, v220
v_mul_f32 v221, s76, v221
v_mul_f32 v222, s76, v222
v_mul_f32 v223, s76, v223
v_cvt_pk_bf16_f32 v110, v220, v221
v_cvt_pk_bf16_f32 v111, v222, v223
mav 200,24,36
trv 60,3,61440
v_mul_f32 v224, s76, v224
mav 200,40,40
trv 62,3,61952
v_mul_f32 v225, s76, v225
mav 200,56,44
v_mul_f32 v226, s76, v226
v_mul_f32 v227, s76, v227
mav0 204,60,44
v_mul_f32 v240, s76, v240
v_mul_f32 v241, s76, v241
mav 204,44,40
v_mul_f32 v242, s76, v242
v_mul_f32 v243, s76, v243
mav 204,28,36
v_cvt_pk_bf16_f32 v112, v224, v225
v_cvt_pk_bf16_f32 v113, v226, v227
mav 204,12,32
s_waitcnt lgkmcnt(0)
v_cvt_pk_bf16_f32 v114, v240, v241
v_cvt_pk_bf16_f32 v115, v242, v243
mav0 220,12,48
trv 32,4,49152
v_mul_f32 v228, s76, v228
mav 220,28,52
buffer_load_dwordx4 v11, s[4:7], s69 offen offset:1024 lds
mav 220,44,56
trv 34,4,49664
s_add_u32 m0, s71, 12288
mav 220,60,60
trv 36,4,53248
s_add_u32 s69, s79, 32896
mav0 216,56,60
trv 38,4,53760
v_mul_f32 v229, s76, v229
mav 216,40,56
buffer_load_dwordx4 v10, s[4:7], s69 offen offset:0 lds
mav 216,24,52
trv 40,4,57344
v_mul_f32 v230, s76, v230
mav 216,8,48
trv 42,4,57856
v_mul_f32 v231, s76, v231
mav0 212,4,48
trv 44,4,61440
v_mul_f32 v244, s76, v244
mav 212,20,52
buffer_load_dwordx4 v11, s[4:7], s69 offen offset:1024 lds
mav 212,36,56
trv 46,4,61952
v_mul_f32 v245, s76, v245
mav 212,52,60
s_add_u32 m0, s71, 14336
s_add_u32 s69, s79, 49280
v_mul_f32 v246, s76, v246
mav0 208,48,60
v_mul_f32 v247, s76, v247
v_cvt_pk_bf16_f32 v116, v228, v229
mav 208,32,56
buffer_load_dwordx4 v10, s[4:7], s69 offen offset:0 lds
mav 208,16,52
v_cvt_pk_bf16_f32 v117, v230, v231
v_cvt_pk_bf16_f32 v118, v244, v245
mav 208,0,48
s_waitcnt lgkmcnt(0)
v_cvt_pk_bf16_f32 v119, v246, v247
v_mul_f32 v232, s76, v232
mav0 224,0,32
trv 48,5,49152
v_mul_f32 v233, s76, v233
mav 224,16,36
buffer_store_dwordx4 v[76:79], v1, s[48:51], s99 offen offset:0 sc1
mav 224,32,40
trv 50,5,49664
v_mul_f32 v234, s76, v234
mav 224,48,44
trv 52,5,53248
v_mul_f32 v235, s76, v235
mav0 228,52,44
v_mul_f32 v248, s76, v248
v_mul_f32 v249, s76, v249
v_mul_f32 v250, s76, v250
v_mul_f32 v251, s76, v251
v_cvt_pk_bf16_f32 v120, v232, v233
v_cvt_pk_bf16_f32 v121, v234, v235
v_cvt_pk_bf16_f32 v122, v248, v249
v_cvt_pk_bf16_f32 v123, v250, v251
mav 228,36,40
trv 54,5,53760
v_mul_f32 v236, s76, v236
mav 228,20,36
trv 56,5,57344
v_mul_f32 v237, s76, v237
mav 228,4,32
trv 58,5,57856
v_mul_f32 v238, s76, v238
mav0 232,8,32
v_mul_f32 v239, s76, v239
v_mul_f32 v252, s76, v252
v_mul_f32 v253, s76, v253
v_mul_f32 v254, s76, v254
v_mul_f32 v255, s76, v255
v_cvt_pk_bf16_f32 v124, v236, v237
v_cvt_pk_bf16_f32 v125, v238, v239
v_cvt_pk_bf16_f32 v126, v252, v253
v_cvt_pk_bf16_f32 v127, v254, v255
mav 232,24,36
trv 60,5,61440
mav 232,40,40
trv 62,5,61952
mav 232,56,44
buffer_load_dwordx4 v11, s[4:7], s69 offen offset:1024 lds
mav0 236,60,44
s_add_u32 s72, s72, 0x100000
s_bitset0_b32 s72, 22
s_add_u32 m0, s70, 32768
mav 236,44,40
s_add_u32 s69, s72, 0
v_xor_b32 v2, 0x10000, v2
v_xor_b32 v3, 0x10000, v3
mav 236,28,36
buffer_store_dwordx4 v[80:83], v1, s[48:51], s96 offen offset:1024 sc1
mav 236,12,32
s_waitcnt vmcnt(32) lgkmcnt(0)
v_readfirstlane_b32 s94, v17
s_nop 3
s_cmp_lg_u32 s94, 0
s_cbranch_scc0 L_tag_spin
L_tag_back:
s_barrier
v_xor_b32 v4, 0x10000, v4
v_xor_b32 v5, 0x10000, v5
mav0 252,12,48
trv 32,2,0
mav 252,28,52
trv 34,2,512
mav 252,44,56
trv 36,2,4096
mav 252,60,60
trv 38,2,4608
mav0 248,56,60
trv 40,2,8192
mav 248,40,56
buffer_load_dwordx4 v20, s[20:23], s69 offen offset:0 lds
mav 248,24,52
trv 42,2,8704
mav 248,8,48
trv 44,2,12288
mav0 244,4,48
trv 46,2,12800
mav 244,20,52
buffer_load_dwordx4 v21, s[20:23], s69 offen offset:1024 lds
mav 244,36,56
mav 244,52,60
mav0 240,48,60
mav 240,32,56
buffer_load_dwordx4 v22, s[20:23], s69 offen offset:2048 lds
mav 240,16,52
mav 240,0,48
s_waitcnt lgkmcnt(0)
mav 128,64,32
trv 48,3,0
mav 128,80,36
buffer_load_dwordx4 v23, s[20:23], s69 offen offset:3072 lds
mav 128,96,40
trv 50,3,512
mav 128,112,44
trv 52,3,4096
s_waitcnt vmcnt(32)
mav 132,116,44
L_stub3:
s_cbranch_execz L_walk_a0
rda 0,6,0
mav 132,100,40
rda 16,7,0
mav 132,84,36
trv 54,3,4608
mav 132,68,32
trv 56,3,8192
mav 136,72,32
trv 58,3,8704
mav 136,88,36
trv 60,3,12288
mav 136,104,40
trv 62,3,12800
s_waitcnt lgkmcnt(5)
mav 136,120,44
buffer_store_dwordx4 v[84:87], v1, s[48:51], s97 offen offset:1024 sc1
mav 140,124,44
s_add_u32 s79, s79, 256
s_bitset0_b32 s79, 10
s_add_u32 m0, s71, 0
mav 140,108,40
s_add_u32 s69, s79, 0
mav 140,92,36
mav 140,76,32
s_waitcnt lgkmcnt(0)
mav 156,76,48
trv 32,4,0
mav 156,92,52
buffer_load_dwordx4 v10, s[4:7], s69 offen offset:0 lds
mav 156,108,56
trv 34,4,512
mav 156,124,60
trv 36,4,4096
mav 152,120,60
trv 38,4,4608
mav 152,104,56
buffer_load_dwordx4 v11, s[4:7], s69 offen offset:1024 lds
mav 152,88,52
trv 40,4,8192
mav 152,72,48
trv 42,4,8704
mav 148,68,48
trv 44,4,12288
mav 148,84,52
trv 46,4,12800
s_waitcnt vmcnt(29)
mav 148,100,56
rda 4,6,2048
mav 148,116,60
rda 20,7,2048
mav 144,112,60
mav 144,96,56
mav 144,80,52
mav 144,64,48
s_waitcnt lgkmcnt(2)
mav 160,64,32
trv 48,5,0
s_waitcnt lgkmcnt(1)
mav 160,80,36
trv 50,5,512
s_add_u32 m0, s71, 2048
mav 160,96,40
trv 52,5,4096
s_add_u32 s69, s79, 16384
mav 160,112,44
buffer_load_dwordx4 v10, s[4:7], s69 offen offset:0 lds
mav 164,116,44
trv 54,5,4608
mav 164,100,40
trv 56,5,8192
mav 164,84,36
buffer_load_dwordx4 v11, s[4:7], s69 offen offset:1024 lds
mav 164,68,32
trv 58,5,8704
s_add_u32 m0, s70, 49152
mav 168,72,32
trv 60,5,12288
s_add_u32 s69, s72, 128
mav 168,88,36
trv 62,5,12800
mav 168,104,40
buffer_load_dwordx4 v20, s[20:23], s69 offen offset:0 lds
mav 168,120,44
mav 172,124,44
mav 172,108,40
mav 172,92,36
buffer_load_dwordx4 v21, s[20:23], s69 offen offset:1024 lds
mav 172,76,32
s_waitcnt lgkmcnt(0)
mav 188,76,48
trv 32,2,16384
s_waitcnt vmcnt(30)
mav 188,92,52
rda 8,6,4096
mav 188,108,56
buffer_load_dwordx4 v22, s[20:23], s69 offen offset:2048 lds
mav 188,124,60
rda 24,7,4096
mav 184,120,60
trv 34,2,16896
mav 184,104,56
trv 36,2,20480
mav 184,88,52
trv 38,2,20992
mav 184,72,48
trv 40,2,24576
mav 180,68,48
trv 42,2,25088
mav 180,84,52
trv 44,2,28672
mav 180,100,56
trv 46,2,29184
mav 180,116,60
buffer_load_dwordx4 v23, s[20:23], s69 offen offset:3072 lds
mav 176,112,60
s_waitcnt lgkmcnt(7)
s_add_u32 m0, s71, 4096
s_add_u32 s69, s79, 32768
mav 176,96,56
mav 176,80,52
buffer_store_dwordx4 v[88:91], v1, s[48:51], s98 offen offset:1024 sc1
mav 176,64,48
s_waitcnt lgkmcnt(0)
mav 192,64,32
trv 48,3,16384
mav 192,80,36
trv 50,3,16896
mav 192,96,40
trv 52,3,20480
mav 192,112,44
trv 54,3,20992
mav 196,116,44
trv 56,3,24576
mav 196,100,40
buffer_load_dwordx4 v10, s[4:7], s69 offen offset:0 lds
mav 196,84,36
trv 58,3,25088
s_waitcnt vmcnt(32)
mav 196,68,32
rda 12,6,6144
mav 200,72,32
rda 28,7,6144
mav 200,88,36
trv 60,3,28672
mav 200,104,40
trv 62,3,29184
mav 200,120,44
buffer_load_dwordx4 v11, s[4:7], s69 offen offset:1024 lds
mav 204,124,44
mav 204,108,40
s_waitcnt lgkmcnt(2)
s_add_u32 m0, s71, 6144
s_add_u32 s69, s79, 49152
mav 204,92,36
buffer_load_dwordx4 v10, s[4:7], s69 offen offset:0 lds
mav 204,76,32
s_waitcnt lgkmcnt(0)
mav 220,76,48
trv 32,4,16384
mav 220,92,52
trv 34,4,16896
mav 220,108,56
buffer_load_dwordx4 v11, s[4:7], s69 offen offset:1024 lds
mav 220,124,60
trv 36,4,20480
mav 216,120,60
trv 38,4,20992
mav 216,104,56
trv 40,4,24576
mav 216,88,52
trv 42,4,25088
mav 216,72,48
trv 44,4,28672
mav 212,68,48
trv 46,4,29184
mav 212,84,52
buffer_store_dwordx4 v[92:95], v1, s[48:51], s99 offen offset:1024 sc1
mav 212,100,56
mav 212,116,60
mav 208,112,60
s_waitcnt vmcnt(33)
rda 32,6,8192
mav 208,96,56
rda 48,7,8192
mav 208,80,52
mav 208,64,48
s_waitcnt lgkmcnt(2)
mav 224,64,32
trv 48,5,16384
mav 224,80,36
trv 50,5,16896
mav 224,96,40
trv 52,5,20480
mav 224,112,44
trv 54,5,20992
mav 228,116,44
trv 56,5,24576
s_waitcnt lgkmcnt(5)
mav 228,100,40
trv 58,5,25088
s_add_u32 m0, s71, 8192
mav 228,84,36
trv 60,5,28672
s_add_u32 s69, s79, 128
mav 228,68,32
buffer_load_dwordx4 v10, s[4:7], s69 offen offset:0 lds
mav 232,72,32
trv 62,5,29184
mav 232,88,36
mav 232,104,40
buffer_load_dwordx4 v11, s[4:7], s69 offen offset:1024 lds
mav 232,120,44
s_add_u32 s72, s72, 0x100000
s_bitset0_b32 s72, 22
s_lshr_b32 s94, s72, 20
mav 236,124,44
s_mul_i32 s94, s94, 458752
s_add_u32 s94, s94, s73
s_add_u32 m0, s70, 65536
mav 236,108,40
s_add_u32 s69, s94, 0
v_xor_b32 v2, 0x10000, v2
v_xor_b32 v3, 0x10000, v3
mav 236,92,36
buffer_store_dwordx4 v[96:99], v1, s[48:51], s96 offen offset:2048 sc1
mav 236,76,32
s_waitcnt vmcnt(32) lgkmcnt(0)
s_barrier
v_xor_b32 v4, 0x10000, v4
v_xor_b32 v5, 0x10000, v5
mav 252,76,48
trv 32,2,0
mav 252,92,52
trv 34,2,512
mav 252,108,56
trv 36,2,4096
mav 252,124,60
trv 38,2,4608
s_waitcnt vmcnt(28)
mav 248,120,60
rda 36,6,10240
mav 248,104,56
buffer_load_dwordx4 v12, s[28:31], s69 offen offset:0 lds
mav 248,88,52
rda 52,7,10240
mav 248,72,48
trv 40,2,8192
mav 244,68,48
trv 42,2,8704
mav 244,84,52
trv 44,2,12288
mav 244,100,56
trv 46,2,12800
mav 244,116,60
buffer_load_dwordx4 v13, s[28:31], s69 offen offset:1024 lds
mav 240,112,60
mav 240,96,56
mav 240,80,52
buffer_load_dwordx4 v14, s[28:31], s69 offen offset:2048 lds
mav 240,64,48
s_waitcnt lgkmcnt(0)
mav 128,128,32
trv 48,3,0
mav 128,144,36
trv 50,3,512
mav 128,160,40
buffer_load_dwordx4 v15, s[28:31], s69 offen offset:3072 lds
mav 128,176,44
trv 52,3,4096
s_add_u32 m0, s71, 10240
mav 132,180,44
trv 54,3,4608
s_add_u32 s69, s79, 16512
mav 132,164,40
trv 56,3,8192
mav 132,148,36
buffer_load_dwordx4 v10, s[4:7], s69 offen offset:0 lds
mav 132,132,32
trv 58,3,8704
mav 136,136,32
trv 60,3,12288
mav 136,152,36
trv 62,3,12800
s_waitcnt vmcnt(31)
mav 136,168,40
buffer_load_dwordx4 v11, s[4:7], s69 offen offset:1024 lds
mav 136,184,44
rda 40,6,12288
mav 140,188,44
rda 56,7,12288
mav 140,172,40
mav 140,156,36
buffer_store_dwordx4 v[100:103], v1, s[48:51], s97 offen offset:2048 sc1
mav 140,140,32
s_waitcnt lgkmcnt(2)
mav 156,140,48
trv 32,4,0
mav 156,156,52
trv 34,4,512
s_waitcnt lgkmcnt(2)
mav 156,172,56
trv 36,4,4096
s_add_u32 m0, s71, 12288
mav 156,188,60
trv 38,4,4608
s_add_u32 s69, s79, 32896
mav 152,184,60
trv 40,4,8192
mav 152,168,56
buffer_load_dwordx4 v10, s[4:7], s69 offen offset:0 lds
mav 152,152,52
trv 42,4,8704
mav 152,136,48
trv 44,4,12288
mav 148,132,48
trv 46,4,12800
mav 148,148,52
buffer_load_dwordx4 v11, s[4:7], s69 offen offset:1024 lds
mav 148,164,56
mav 148,180,60
mav 144,176,60
mav 144,160,56
mav 144,144,52
mav 144,128,48
s_waitcnt lgkmcnt(0)
mav 160,128,32
trv 48,5,0
s_waitcnt vmcnt(32)
mav 160,144,36
rda 44,6,14336
mav 160,160,40
rda 60,7,14336
mav 160,176,44
trv 50,5,512
mav 164,180,44
trv 52,5,4096
mav 164,164,40
trv 54,5,4608
mav 164,148,36
trv 56,5,8192
mav 164,132,32
trv 58,5,8704
s_waitcnt lgkmcnt(5)
mav 168,136,32
trv 60,5,12288
s_add_u32 m0, s71, 14336
mav 168,152,36
trv 62,5,12800
s_add_u32 s69, s79, 49280
mav 168,168,40
buffer_load_dwordx4 v10, s[4:7], s69 offen offset:0 lds
mav 168,184,44
mav 172,188,44
mav 172,172,40
buffer_load_dwordx4 v11, s[4:7], s69 offen offset:1024 lds
mav 172,156,36
s_add_u32 m0, s70, 81920
s_add_u32 s69, s94, 0
mav 172,140,32
s_waitcnt lgkmcnt(0)
mav 188,140,48
trv 32,2,16384
mav 188,156,52
buffer_load_dwordx4 v12, s[32:35], s69 offen offset:0 lds
mav 188,172,56
trv 34,2,16896
mav 188,188,60
trv 36,2,20480
mav 184,184,60
trv 38,2,20992
mav 184,168,56
buffer_load_dwordx4 v13, s[32:35], s69 offen offset:1024 lds
mav 184,152,52
trv 40,2,24576
s_waitcnt vmcnt(28)
mav 184,136,48
rda 64,6,0
mav 180,132,48
trv 42,2,25088
mav 180,148,52
trv 44,2,28672
mav 180,164,56
trv 46,2,29184
buffer_store_dwordx4 v[104:107], v1, s[48:51], s98 offen offset:2048 sc1
mav 180,180,60
rda 80,7,0
mav 176,176,60
mav 176,160,56
mav 176,144,52
mav 176,128,48
s_waitcnt lgkmcnt(1)
mav 192,128,32
buffer_load_dwordx4 v14, s[32:35], s69 offen offset:2048 lds
mav 192,144,36
trv 48,3,16384
mav 192,160,40
trv 50,3,16896
mav 192,176,44
trv 52,3,20480
mav 196,180,44
buffer_load_dwordx4 v15, s[32:35], s69 offen offset:3072 lds
mav 196,164,40
trv 54,3,20992
s_waitcnt lgkmcnt(4)
mav 196,148,36
trv 56,3,24576
s_add_u32 s79, s79, 256
mav 196,132,32
trv 58,3,25088
s_bitset0_b32 s79, 10
mav 200,136,32
trv 60,3,28672
s_add_u32 m0, s71, 0
mav 200,152,36
trv 62,3,29184
s_add_u32 s69, s79, 0
mav 200,168,40
buffer_load_dwordx4 v10, s[4:7], s69 offen offset:0 lds
mav 200,184,44
mav 204,188,44
s_waitcnt vmcnt(30)
rda 68,6,2048
mav 204,172,40
buffer_load_dwordx4 v11, s[4:7], s69 offen offset:1024 lds
mav 204,156,36
rda 84,7,2048
mav 204,140,32
s_waitcnt lgkmcnt(2)
mav 220,140,48
trv 32,4,16384
mav 220,156,52
trv 34,4,16896
mav 220,172,56
trv 36,4,20480
mav 220,188,60
trv 38,4,20992
mav 216,184,60
trv 40,4,24576
s_waitcnt lgkmcnt(5)
mav 216,168,56
trv 42,4,25088
s_add_u32 m0, s71, 2048
mav 216,152,52
trv 44,4,28672
s_add_u32 s69, s79, 16384
mav 216,136,48
buffer_load_dwordx4 v10, s[4:7], s69 offen offset:0 lds
mav 212,132,48
trv 46,4,29184
mav 212,148,52
buffer_store_dwordx4 v[108:111], v1, s[48:51], s99 offen offset:2048 sc1
mav 212,164,56
mav 212,180,60
mav 208,176,60
mav 208,160,56
mav 208,144,52
mav 208,128,48
s_waitcnt lgkmcnt(0)
mav 224,128,32
trv 48,5,16384
mav 224,144,36
buffer_load_dwordx4 v11, s[4:7], s69 offen offset:1024 lds
mav 224,160,40
trv 50,5,16896
mav 224,176,44
trv 52,5,20480
s_waitcnt vmcnt(27)
mav 228,180,44
rda 72,6,4096
mav 228,164,40
rda 88,7,4096
mav 228,148,36
trv 54,5,20992
mav 228,132,32
trv 56,5,24576
mav 232,136,32
trv 58,5,25088
mav 232,152,36
trv 60,5,28672
mav 232,168,40
trv 62,5,29184
s_waitcnt lgkmcnt(5)
mav 232,184,44
buffer_store_dwordx4 v[112:115], v1, s[48:51], s96 offen offset:3072 sc1
mav 236,188,44
s_add_u32 m0, s71, 4096
s_add_u32 s69, s79, 32768
mav 236,172,40
mav 236,156,36
mav 236,140,32
s_waitcnt lgkmcnt(0)
s_barrier
mav 252,140,48
trv 32,2,32768
mav 252,156,52
buffer_load_dwordx4 v10, s[4:7], s69 offen offset:0 lds
mav 252,172,56
trv 34,2,33280
mav 252,188,60
trv 36,2,36864
mav 248,184,60
trv 38,2,37376
mav 248,168,56
buffer_load_dwordx4 v11, s[4:7], s69 offen offset:1024 lds
mav 248,152,52
trv 40,2,40960
s_add_u32 s72, s72, 0x100000
mav 248,136,48
trv 42,2,41472
s_bitset0_b32 s72, 22
mav 244,132,48
trv 44,2,45056
s_lshr_b32 s94, s72, 20
mav 244,148,52
trv 46,2,45568
s_mul_i32 s94, s94, 458752
mav 244,164,56
s_add_u32 s94, s94, s73
s_add_u32 m0, s70, 0
s_add_u32 s69, s94, 0
mav 244,180,60
buffer_load_dwordx4 v12, s[28:31], s69 offen offset:0 lds
mav 240,176,60
s_waitcnt vmcnt(29)
rda 76,6,6144
mav 240,160,56
rda 92,7,6144
mav 240,144,52
buffer_load_dwordx4 v13, s[28:31], s69 offen offset:1024 lds
mav 240,128,48
s_waitcnt lgkmcnt(2)
mav 128,192,32
trv 48,3,32768
mav 128,208,36
trv 50,3,33280
mav 128,224,40
buffer_load_dwordx4 v14, s[28:31], s69 offen offset:2048 lds
mav 128,240,44
trv 52,3,36864
L_stub4:
s_cbranch_execz L_walk_a1
mav 132,244,44
trv 54,3,37376
mav 132,228,40
trv 56,3,40960
s_nop 0
mav 132,212,36
buffer_load_dwordx4 v15, s[28:31], s69 offen offset:3072 lds
mav 132,196,32
trv 58,3,41472
s_waitcnt lgkmcnt(6)
mav 136,200,32
trv 60,3,45056
s_add_u32 m0, s71, 6144
mav 136,216,36
trv 62,3,45568
s_add_u32 s69, s79, 49152
mav 136,232,40
buffer_load_dwordx4 v10, s[4:7], s69 offen offset:0 lds
mav 136,248,44
v_cvt_pk_bf16_f32 v64, v128, v129
v_cvt_pk_bf16_f32 v65, v130, v131
mav 140,252,44
v_cvt_pk_bf16_f32 v66, v132, v133
v_cvt_pk_bf16_f32 v67, v134, v135
mav 140,236,40
s_nop 2
mav 140,220,36
buffer_load_dwordx4 v11, s[4:7], s69 offen offset:1024 lds
mav 140,204,32
s_waitcnt lgkmcnt(0)
s_waitcnt vmcnt(31)
v_cvt_pk_bf16_f32 v68, v136, v137
mav 156,204,48
rda 96,6,8192
v_cvt_pk_bf16_f32 v69, v138, v139
mav 156,220,52
rda 112,7,8192
v_cvt_pk_bf16_f32 v70, v140, v141
mav 156,236,56
trv 32,4,32768
v_cvt_pk_bf16_f32 v71, v142, v143
mav 156,252,60
trv 34,4,33280
mav 152,248,60
trv 36,4,36864
mav 152,232,56
trv 38,4,37376
mav 152,216,52
trv 40,4,40960
mav 152,200,48
buffer_store_dwordx4 v[116:119], v1, s[48:51], s97 offen offset:3072 sc1
mav 148,196,48
trv 42,4,41472
s_waitcnt lgkmcnt(6)
mav 148,212,52
trv 44,4,45056
s_add_u32 m0, s71, 8192
mav 148,228,56
trv 46,4,45568
s_add_u32 s69, s79, 128
mav 148,244,60
v_cvt_pk_bf16_f32 v76, v152, v153
v_cvt_pk_bf16_f32 v77, v154, v155
mav 144,240,60
v_cvt_pk_bf16_f32 v78, v156, v157
v_cvt_pk_bf16_f32 v79, v158, v159
mav 144,224,56
buffer_load_dwordx4 v10, s[4:7], s69 offen offset:0 lds
mav 144,208,52
mav 144,192,48
s_waitcnt lgkmcnt(0)
mav 160,192,32
trv 48,5,32768
mav 160,208,36
buffer_load_dwordx4 v11, s[4:7], s69 offen offset:1024 lds
mav 160,224,40
trv 50,5,33280
s_add_u32 m0, s70, 16384
mav 160,240,44
trv 52,5,36864
s_add_u32 s69, s94, 0
mav 164,244,44
trv 54,5,37376
v_cvt_pk_bf16_f32 v72, v144, v145
mav 164,228,40
trv 56,5,40960
v_cvt_pk_bf16_f32 v73, v146, v147
mav 164,212,36
trv 58,5,41472
s_waitcnt vmcnt(27)
mav 164,196,32
rda 100,6,10240
v_cvt_pk_bf16_f32 v74, v148, v149
mav 168,200,32
buffer_load_dwordx4 v12, s[32:35], s69 offen offset:0 lds
mav 168,216,36
trv 60,5,45056
v_cvt_pk_bf16_f32 v75, v150, v151
mav 168,232,40
trv 62,5,45568
v_cvt_pk_bf16_f32 v80, v160, v161
mav 168,248,44
buffer_load_dwordx4 v13, s[32:35], s69 offen offset:1024 lds
mav 172,252,44
rda 116,7,10240
v_cvt_pk_bf16_f32 v81, v162, v163
mav 172,236,40
v_cvt_pk_bf16_f32 v82, v164, v165
v_cvt_pk_bf16_f32 v83, v166, v167
mav 172,220,36
v_cvt_pk_bf16_f32 v84, v168, v169
v_cvt_pk_bf16_f32 v85, v170, v171
mav 172,204,32
s_waitcnt lgkmcnt(1)
mav 188,204,48
buffer_load_dwordx4 v14, s[32:35], s69 offen offset:2048 lds
mav 188,220,52
trv 32,2,49152
s_nop 0
mav 188,236,56
trv 34,2,49664
v_cvt_pk_bf16_f32 v86, v172, v173
mav 188,252,60
buffer_load_dwordx4 v15, s[32:35], s69 offen offset:3072 lds
mav 184,248,60
trv 36,2,53248
s_waitcnt lgkmcnt(3)
mav 184,232,56
trv 38,2,53760
s_add_u32 m0, s71, 10240
mav 184,216,52
buffer_store_dwordx4 v[120:123], v1, s[48:51], s98 offen offset:3072 sc1
mav 184,200,48
trv 40,2,57344
s_add_u32 s69, s79, 16512
mav 180,196,48
trv 42,2,57856
v_cvt_pk_bf16_f32 v87, v174, v175
mav 180,212,52
trv 44,2,61440
s_nop 0
mav 180,228,56
trv 46,2,61952
v_cvt_pk_bf16_f32 v92, v184, v185
mav 180,244,60
v_cvt_pk_bf16_f32 v93, v186, v187
v_cvt_pk_bf16_f32 v94, v188, v189
mav 176,240,60
s_waitcnt vmcnt(29)
rda 104,6,12288
mav 176,224,56
rda 120,7,12288
v_cvt_pk_bf16_f32 v95, v190, v191
mav 176,208,52
buffer_load_dwordx4 v10, s[4:7], s69 offen offset:0 lds
mav 176,192,48
s_waitcnt lgkmcnt(2)
mav 192,192,32
trv 48,3,49152
v_add_u32 v9, s92, v1
mav 192,208,36
trv 50,3,49664
s_nop 0
mav 192,224,40
buffer_load_dwordx4 v11, s[4:7], s69 offen offset:1024 lds
mav 192,240,44
trv 52,3,53248
s_waitcnt lgkmcnt(3)
mav 196,244,44
trv 54,3,53760
s_add_u32 m0, s71, 12288
mav 196,228,40
trv 56,3,57344
s_add_u32 s69, s79, 32896
mav 196,212,36
buffer_load_dwordx4 v10, s[4:7], s69 offen offset:0 lds
mav 196,196,32
trv 58,3,57856
v_cvt_pk_bf16_f32 v88, v176, v177
mav 200,200,32
trv 60,3,61440
v_cvt_pk_bf16_f32 v89, v178, v179
mav 200,216,36
trv 62,3,61952
v_cvt_pk_bf16_f32 v90, v180, v181
mav 200,232,40
buffer_load_dwordx4 v11, s[4:7], s69 offen offset:1024 lds
mav 200,248,44
v_cvt_pk_bf16_f32 v91, v182, v183
v_cvt_pk_bf16_f32 v96, v192, v193
mav 204,252,44
v_cvt_pk_bf16_f32 v97, v194, v195
v_cvt_pk_bf16_f32 v98, v196, v197
mav 204,236,40
v_cvt_pk_bf16_f32 v99, v198, v199
s_nop 0
mav 204,220,36
buffer_store_dwordx4 v[124:127], v1, s[48:51], s99 offen offset:3072 sc1
mav 204,204,32
s_waitcnt lgkmcnt(0)
v_cvt_pk_bf16_f32 v100, v200, v201
v_cvt_pk_bf16_f32 v101, v202, v203
mav 220,204,48
trv 32,4,49152
s_add_u32 s96, s75, 16384
mav 220,220,52
trv 34,4,49664
v_cvt_pk_bf16_f32 v102, v204, v205
mav 220,236,56
trv 36,4,53248
v_cvt_pk_bf16_f32 v103, v206, v207
mav 220,252,60
trv 38,4,53760
s_waitcnt vmcnt(32)
mav 216,248,60
rda 108,6,14336
s_add_u32 s97, s75, 20480
mav 216,232,56
rda 124,7,14336
s_add_u32 s98, s75, 24576
mav 216,216,52
trv 40,4,57344
s_add_u32 s99, s75, 28672
mav 216,200,48
trv 42,4,57856
mav 212,196,48
trv 44,4,61440
mav 212,212,52
trv 46,4,61952
s_nop 0
mav 212,228,56
s_waitcnt lgkmcnt(4)
s_add_u32 m0, s71, 14336
s_add_u32 s69, s79, 49280
mav 212,244,60
buffer_load_dwordx4 v10, s[4:7], s69 offen offset:0 lds
mav 208,240,60
v_cvt_pk_bf16_f32 v108, v216, v217
v_cvt_pk_bf16_f32 v109, v218, v219
mav 208,224,56
v_cvt_pk_bf16_f32 v110, v220, v221
v_cvt_pk_bf16_f32 v111, v222, v223
mav 208,208,52
buffer_load_dwordx4 v11, s[4:7], s69 offen offset:1024 lds
mav 208,192,48
s_waitcnt lgkmcnt(0)
s_add_u32 s72, s72, 0x100000
s_bitset0_b32 s72, 22
mav 224,192,32
trv 48,5,49152
s_lshr_b32 s94, s72, 20
mav 224,208,36
trv 50,5,49664
s_mul_i32 s94, s94, 458752
mav 224,224,40
trv 52,5,53248
s_add_u32 s94, s94, s73
mav 224,240,44
trv 54,5,53760
s_add_u32 m0, s70, 32768
mav 228,244,44
trv 56,5,57344
s_add_u32 s69, s94, 0
mav 228,228,40
trv 58,5,57856
v_cvt_pk_bf16_f32 v104, v208, v209
mav 228,212,36
trv 60,5,61440
v_cvt_pk_bf16_f32 v105, v210, v211
mav 228,196,32
trv 62,5,61952
v_cvt_pk_bf16_f32 v106, v212, v213
mav 232,200,32
v_cvt_pk_bf16_f32 v107, v214, v215
v_cvt_pk_bf16_f32 v112, v224, v225
mav 232,216,36
s_waitcnt vmcnt(27)
rda 128,6,0
mav 232,232,40
rda 144,7,0
v_cvt_pk_bf16_f32 v113, v226, v227
mav 232,248,44
v_xor_b32 v2, 0x10000, v2
v_xor_b32 v3, 0x10000, v3
mav 236,252,44
v_xor_b32 v4, 0x10000, v4
v_xor_b32 v5, 0x10000, v5
mav 236,236,40
v_cvt_pk_bf16_f32 v114, v228, v229
v_cvt_pk_bf16_f32 v115, v230, v231
mav 236,220,36
v_cvt_pk_bf16_f32 v116, v232, v233
v_cvt_pk_bf16_f32 v117, v234, v235
mav 236,204,32
s_waitcnt lgkmcnt(2)
s_barrier
mav 252,204,48
buffer_load_dwordx4 v12, s[28:31], s69 offen offset:0 lds
mav 252,220,52
trv 32,2,0
s_nop 0
mav 252,236,56
trv 34,2,512
v_cvt_pk_bf16_f32 v118, v236, v237
mav 252,252,60
buffer_load_dwordx4 v13, s[28:31], s69 offen offset:1024 lds
mav 248,248,60
trv 36,2,4096
v_cvt_pk_bf16_f32 v119, v238, v239
mav 248,232,56
trv 38,2,4608
mav 248,216,52
trv 40,2,8192
mav 248,200,48
buffer_load_dwordx4 v14, s[28:31], s69 offen offset:2048 lds
mav 244,196,48
trv 42,2,8704
mav 244,212,52
trv 44,2,12288
s_nop 0
mav 244,228,56
trv 46,2,12800
v_cvt_pk_bf16_f32 v124, v248, v249
mav 244,244,60
buffer_load_dwordx4 v15, s[28:31], s69 offen offset:3072 lds
mav 240,240,60
s_waitcnt lgkmcnt(8)
s_add_u32 s79, s79, 256
s_bitset0_b32 s79, 10
mav 240,224,56
s_add_u32 m0, s71, 0
s_add_u32 s69, s79, 0
v_cvt_pk_bf16_f32 v125, v250, v251
mav 240,208,52
v_cvt_pk_bf16_f32 v126, v252, v253
v_cvt_pk_bf16_f32 v127, v254, v255
mav 240,192,48
s_waitcnt lgkmcnt(0)
s_waitcnt vmcnt(28)
s_cmp_lg_u32 s92, 0
s_cbranch_scc1 L_noffn
mva0 128,32,0
buffer_load_dwordx4 v10, s[4:7], s69 offen offset:0 lds
mva 128,36,16
rda 132,6,2048
s_bfe_i32 s65, s56, 0x10002
mva 128,40,32
rda 148,7,2048
v_cvt_pk_bf16_f32 v120, v240, v241
mva 128,44,48
trv 48,2,16384
v_cvt_pk_bf16_f32 v121, v242, v243
mva0 132,44,52
trv 50,2,16896
buffer_store_dwordx4 v[64:67], v1, s[48:51], s96 offen offset:0 sc1
mva 132,40,36
trv 52,2,20480
v_cvt_pk_bf16_f32 v122, v244, v245
mva 132,36,20
trv 54,2,20992
v_cvt_pk_bf16_f32 v123, v246, v247
mva 132,32,4
trv 56,2,24576
s_and_b32 s65, s65, 15
mva0 136,32,8
trv 58,2,25088
s_xor_b32 s8, s65, s57
mva 136,36,24
trv 60,2,28672
s_lshr_b32 s10, s56, 3
mva 136,40,40
trv 62,2,29184
s_and_b32 s9, s56, 3
mva 136,44,56
buffer_load_dwordx4 v11, s[4:7], s69 offen offset:1024 lds
mva0 140,44,60
s_waitcnt lgkmcnt(8)
s_add_u32 m0, s71, 2048
s_add_u32 s69, s79, 16384
mva 140,40,44
s_lshl_b32 s17, s58, 12
s_lshr_b32 s65, s58, 1
s_and_b32 s66, s58, 1
mva 140,36,28
buffer_load_dwordx4 v10, s[4:7], s69 offen offset:0 lds
mva 140,32,12
s_waitcnt lgkmcnt(0)
s_lshl_b32 s67, s8, 1
s_add_u32 s67, s67, s65
mva0 156,48,12
trv 32,3,0
s_mul_i32 s68, s10, 14
mva 156,52,28
trv 34,3,512
s_add_u32 s68, s68, s66
mva 156,56,44
buffer_load_dwordx4 v11, s[4:7], s69 offen offset:1024 lds
mva 156,60,60
trv 36,3,4096
s_mul_i32 s11, s67, 230400
mva0 152,60,56
trv 38,3,4608
s_lshl_b32 s16, s68, 12
mva 152,56,40
trv 40,3,8192
s_add_u32 s11, s11, s16
mva 152,52,24
trv 42,3,8704
s_waitcnt vmcnt(30)
mva 152,48,8
rda 136,6,4096
s_add_u32 s11, s11, 50331648
mva0 148,48,4
rda 152,7,4096
s_lshl_b32 s16, s68, 15
mva 148,52,20
trv 44,3,12288
s_lshl_b32 s68, s56, 2
mva 148,56,36
trv 46,3,12800
s_add_u32 s68, s68, s66
mva 148,60,52
buffer_store_dwordx4 v[68:71], v1, s[48:51], s96 offen offset:1024 sc1
mva0 144,60,48
s_lshl_b32 s18, s68, 12
s_lshl_b32 s19, s68, 15
s_lshl_b32 s68, s9, 1
mva 144,56,32
s_waitcnt lgkmcnt(2)
s_add_u32 m0, s71, 4096
s_add_u32 s69, s79, 32768
mva 144,52,16
s_add_u32 s68, s68, s65
s_lshl_b32 s68, s68, 7
s_add_u32 s16, s16, s68
mva 144,48,0
s_waitcnt lgkmcnt(0)
s_add_u32 s19, s19, s68
s_sub_u32 s65, 7, s58
mva0 160,32,0
trv 48,3,16384
s_lshl_b32 s23, s65, 14
mva 160,36,16
buffer_load_dwordx4 v10, s[4:7], s69 offen offset:0 lds
mva 160,40,32
trv 50,3,16896
s_add_u32 s65, s58, 4
mva 160,44,48
trv 52,3,20480
s_lshl_b32 s21, s65, 14
mva0 164,44,52
trv 54,3,20992
s_sub_u32 s40, 162816, s17
mva 164,40,36
buffer_load_dwordx4 v11, s[4:7], s69 offen offset:1024 lds
mva 164,36,20
trv 56,3,24576
s_add_u32 m0, s70, 49152
mva 164,32,4
trv 58,3,25088
s_add_u32 s69, s94, 0
mva0 168,32,8
trv 60,3,28672
s_add_u32 s22, s17, 150528
mva 168,36,24
buffer_load_dwordx4 v12, s[32:35], s69 offen offset:0 lds
mva 168,40,40
trv 62,3,29184
s_lshl_b32 s65, s58, 3
mva 168,44,56
s_xor_b32 s65, s65, 24
s_add_u32 s65, s65, s57
s_add_u32 s65, s65, 1
mva0 172,44,60
s_waitcnt vmcnt(28)
rda 140,6,6144
mva 172,40,44
buffer_load_dwordx4 v13, s[32:35], s69 offen offset:1024 lds
mva 172,36,28
rda 156,7,6144
s_lshr_b32 s65, s65, 5
mva 172,32,12
s_waitcnt lgkmcnt(2)
s_mul_i32 s65, s65, 0x18000
s_add_u32 s21, s21, s65
mva0 188,48,12
trv 32,4,0
s_lshr_b32 s65, s65, 2
mva 188,52,28
buffer_load_dwordx4 v14, s[32:35], s69 offen offset:2048 lds
mva 188,56,44
trv 34,4,512
s_add_u32 s22, s22, s65
mva 188,60,60
trv 36,4,4096
s_lshr_b32 s65, s2, 3
mva0 184,60,56
trv 38,4,4608
s_lshl_b32 s65, s65, 2
mva 184,56,40
buffer_load_dwordx4 v15, s[32:35], s69 offen offset:3072 lds
mva 184,52,24
trv 40,4,8192
s_waitcnt lgkmcnt(5)
mva 184,48,8
trv 42,4,8704
s_add_u32 m0, s71, 6144
mva0 180,48,4
trv 44,4,12288
s_add_u32 s69, s79, 49152
mva 180,52,20
buffer_load_dwordx4 v10, s[4:7], s69 offen offset:0 lds
mva 180,56,36
trv 46,4,12800
s_add_u32 s65, s65, s58
mva 180,60,52
s_mul_i32 s66, s10, 112
s_add_u32 s66, s66, s65
s_lshl_b32 s41, s66, 12
mva0 176,60,48
buffer_store_dwordx4 v[72:75], v1, s[48:51], s96 offen offset:2048 sc1
mva 176,56,32
s_lshl_b32 s66, s10, 20
s_lshl_b32 s42, s65, 13
s_add_u32 s42, s42, s66
mva 176,52,16
s_mul_i32 s20, s65, 1280
s_add_u32 s20, s20, s66
s_add_u32 s20, s20, 917504
mva 176,48,0
s_waitcnt lgkmcnt(0)
s_add_u32 s43, s57, 1
s_lshr_b32 s43, s43, 3
mva0 192,32,0
trv 48,4,16384
s_lshl_b32 s43, s43, 28
mva 192,36,16
trv 50,4,16896
mva 192,40,32
trv 52,4,20480
mva 192,44,48
trv 54,4,20992
s_waitcnt vmcnt(30)
mva0 196,44,52
buffer_load_dwordx4 v11, s[4:7], s69 offen offset:1024 lds
mva 196,40,36
rda 160,6,8192
mva 196,36,20
rda 176,7,8192
mva 196,32,4
trv 56,4,24576
mva0 200,32,8
trv 58,4,25088
mva 200,36,24
trv 60,4,28672
mva 200,40,40
trv 62,4,29184
mva 200,44,56
buffer_store_dwordx4 v[76:79], v1, s[48:51], s96 offen offset:3072 sc1
mva0 204,44,60
s_waitcnt lgkmcnt(4)
L_stub5:
s_cbranch_execz L_walk_a1
s_add_u32 m0, s71, 8192
s_add_u32 s69, s79, 128
mva 204,40,44
mva 204,36,28
mva 204,32,12
s_waitcnt lgkmcnt(0)
mva0 220,48,12
trv 32,5,0
mva 220,52,28
buffer_load_dwordx4 v10, s[4:7], s69 offen offset:0 lds
mva 220,56,44
trv 34,5,512
mva 220,60,60
trv 36,5,4096
mva0 216,60,56
trv 38,5,4608
mva 216,56,40
buffer_load_dwordx4 v11, s[4:7], s69 offen offset:1024 lds
mva 216,52,24
trv 40,5,8192
mva 216,48,8
trv 42,5,8704
mva0 212,48,4
trv 44,5,12288
mva 212,52,20
trv 46,5,12800
s_waitcnt vmcnt(27)
mva 212,56,36
rda 164,6,10240
mva 212,60,52
rda 180,7,10240
mva0 208,60,48
mva 208,56,32
mva 208,52,16
mva 208,48,0
s_waitcnt lgkmcnt(2)
mva0 224,32,0
trv 48,5,16384
s_waitcnt lgkmcnt(1)
mva 224,36,16
trv 50,5,16896
s_add_u32 m0, s71, 10240
mva 224,40,32
trv 52,5,20480
s_add_u32 s69, s79, 16512
mva 224,44,48
buffer_load_dwordx4 v10, s[4:7], s69 offen offset:0 lds
mva0 228,44,52
trv 54,5,20992
mva 228,40,36
trv 56,5,24576
mva 228,36,20
buffer_load_dwordx4 v11, s[4:7], s69 offen offset:1024 lds
mva 228,32,4
trv 58,5,25088
s_add_u32 s72, s72, 0x100000
mva0 232,32,8
trv 60,5,28672
s_bitset0_b32 s72, 22
mva 232,36,24
trv 62,5,29184
s_lshr_b32 s94, s72, 20
mva 232,40,40
buffer_store_dwordx4 v[80:83], v1, s[48:51], s97 offen offset:0 sc1
mva 232,44,56
s_mul_i32 s94, s94, 458752
s_add_u32 s94, s94, s73
s_add_u32 m0, s70, 65536
mva0 236,44,60
s_add_u32 s69, s94, 0
v_xor_b32 v2, 0x10000, v2
v_xor_b32 v3, 0x10000, v3
mva 236,40,44
v_xor_b32 v4, 0x10000, v4
v_xor_b32 v5, 0x10000, v5
mva 236,36,28
mva 236,32,12
s_waitcnt lgkmcnt(0)
s_barrier
mva0 252,48,12
trv 32,2,0
s_waitcnt vmcnt(28)
mva 252,52,28
buffer_load_dwordx4 v12, s[28:31], s69 offen offset:0 lds
mva 252,56,44
rda 168,6,12288
mva 252,60,60
rda 184,7,12288
mva0 248,60,56
trv 34,2,512
mva 248,56,40
trv 36,2,4096
mva 248,52,24
trv 38,2,4608
mva 248,48,8
trv 40,2,8192
mva0 244,48,4
trv 42,2,8704
mva 244,52,20
trv 44,2,12288
mva 244,56,36
trv 46,2,12800
mva 244,60,52
buffer_load_dwordx4 v13, s[28:31], s69 offen offset:1024 lds
mva0 240,60,48
mva 240,56,32
mva 240,52,16
buffer_load_dwordx4 v14, s[28:31], s69 offen offset:2048 lds
mva 240,48,0
s_waitcnt lgkmcnt(0)
mva 128,32,64
trv 48,2,16384
mva 128,36,80
trv 50,2,16896
mva 128,40,96
buffer_load_dwordx4 v15, s[28:31], s69 offen offset:3072 lds
mva 128,44,112
trv 52,2,20480
s_add_u32 m0, s71, 12288
mva 132,44,116
trv 54,2,20992
s_add_u32 s69, s79, 32896
mva 132,40,100
trv 56,2,24576
mva 132,36,84
buffer_load_dwordx4 v10, s[4:7], s69 offen offset:0 lds
mva 132,32,68
trv 58,2,25088
s_waitcnt vmcnt(30)
mva 136,32,72
rda 172,6,14336
mva 136,36,88
trv 60,2,28672
mva 136,40,104
trv 62,2,29184
mva 136,44,120
buffer_load_dwordx4 v11, s[4:7], s69 offen offset:1024 lds
mva 140,44,124
rda 188,7,14336
mva 140,40,108
mva 140,36,92
buffer_store_dwordx4 v[84:87], v1, s[48:51], s97 offen offset:1024 sc1
mva 140,32,76
s_waitcnt lgkmcnt(1)
mva 156,48,76
trv 32,3,0
mva 156,52,92
trv 34,3,512
s_waitcnt lgkmcnt(2)
mva 156,56,108
trv 36,3,4096
s_add_u32 m0, s71, 14336
mva 156,60,124
trv 38,3,4608
s_add_u32 s69, s79, 49280
mva 152,60,120
trv 40,3,8192
mva 152,56,104
buffer_load_dwordx4 v10, s[4:7], s69 offen offset:0 lds
mva 152,52,88
trv 42,3,8704
mva 152,48,72
trv 44,3,12288
mva 148,48,68
trv 46,3,12800
mva 148,52,84
buffer_load_dwordx4 v11, s[4:7], s69 offen offset:1024 lds
mva 148,56,100
s_add_u32 m0, s70, 81920
s_add_u32 s69, s94, 0
mva 148,60,116
mva 144,60,112
mva 144,56,96
buffer_store_dwordx4 v[88:91], v1, s[48:51], s97 offen offset:2048 sc1
mva 144,52,80
mva 144,48,64
s_waitcnt lgkmcnt(0)
mva 160,32,64
trv 48,3,16384
mva 160,36,80
trv 50,3,16896
mva 160,40,96
trv 52,3,20480
mva 160,44,112
trv 54,3,20992
s_waitcnt vmcnt(28)
mva 164,44,116
rda 192,6,0
mva 164,40,100
rda 208,7,0
mva 164,36,84
trv 56,3,24576
mva 164,32,68
trv 58,3,25088
mva 168,32,72
buffer_load_dwordx4 v12, s[32:35], s69 offen offset:0 lds
mva 168,36,88
trv 60,3,28672
mva 168,40,104
trv 62,3,29184
mva 168,44,120
buffer_load_dwordx4 v13, s[32:35], s69 offen offset:1024 lds
mva 172,44,124
mva 172,40,108
mva 172,36,92
mva 172,32,76
s_waitcnt lgkmcnt(0)
mva 188,48,76
buffer_load_dwordx4 v14, s[32:35], s69 offen offset:2048 lds
mva 188,52,92
trv 32,4,0
mva 188,56,108
trv 34,4,512
mva 188,60,124
buffer_load_dwordx4 v15, s[32:35], s69 offen offset:3072 lds
mva 184,60,120
trv 36,4,4096
s_add_u32 s72, s72, 0x100000
mva 184,56,104
trv 38,4,4608
s_bitset0_b32 s72, 22
mva 184,52,88
trv 40,4,8192
s_add_u32 m0, s70, 0
mva 184,48,72
trv 42,4,8704
s_add_u32 s69, s72, 0
mva 180,48,68
trv 44,4,12288
mva 180,52,84
trv 46,4,12800
mva 180,56,100
buffer_store_dwordx4 v[92:95], v1, s[48:51], s97 offen offset:3072 sc1
mva 180,60,116
mva 176,60,112
mva 176,56,96
mva 176,52,80
mva 176,48,64
s_waitcnt lgkmcnt(0)
mva 192,32,64
trv 48,4,16384
s_waitcnt vmcnt(31)
mva 192,36,80
rda 196,6,2048
mva 192,40,96
rda 212,7,2048
mva 192,44,112
trv 50,4,16896
mva 196,44,116
trv 52,4,20480
mva 196,40,100
trv 54,4,20992
mva 196,36,84
trv 56,4,24576
mva 196,32,68
trv 58,4,25088
mva 200,32,72
trv 60,4,28672
mva 200,36,88
trv 62,4,29184
mva 200,40,104
mva 200,44,120
mva 204,44,124
mva 204,40,108
mva 204,36,92
mva 204,32,76
s_waitcnt lgkmcnt(0)
mva 220,48,76
trv 32,5,0
mva 220,52,92
trv 34,5,512
mva 220,56,108
trv 36,5,4096
mva 220,60,124
trv 38,5,4608
mva 216,60,120
trv 40,5,8192
mva 216,56,104
trv 42,5,8704
mva 216,52,88
trv 44,5,12288
mva 216,48,72
trv 46,5,12800
mva 212,48,68
buffer_store_dwordx4 v[96:99], v1, s[48:51], s98 offen offset:0 sc1
mva 212,52,84
mva 212,56,100
mva 212,60,116
mva 208,60,112
s_waitcnt vmcnt(29)
rda 200,6,4096
mva 208,56,96
rda 216,7,4096
mva 208,52,80
mva 208,48,64
s_waitcnt lgkmcnt(2)
mva 224,32,64
trv 48,5,16384
mva 224,36,80
trv 50,5,16896
mva 224,40,96
trv 52,5,20480
mva 224,44,112
trv 54,5,20992
mva 228,44,116
trv 56,5,24576
mva 228,40,100
trv 58,5,25088
mva 228,36,84
trv 60,5,28672
mva 228,32,68
trv 62,5,29184
mva 232,32,72
mva 232,36,88
mva 232,40,104
mva 232,44,120
mva 236,44,124
buffer_store_dwordx4 v[100:103], v1, s[48:51], s98 offen offset:1024 sc1
mva 236,40,108
mva 236,36,92
mva 236,32,76
s_waitcnt vmcnt(26) lgkmcnt(0)
s_barrier
mva 252,48,76
trv 32,2,32768
mva 252,52,92
trv 34,2,33280
mva 252,56,108
buffer_load_dwordx4 v20, s[12:15], s69 offen offset:0 lds
mva 252,60,124
trv 36,2,36864
mva 248,60,120
trv 38,2,37376
mva 248,56,104
trv 40,2,40960
mva 248,52,88
buffer_load_dwordx4 v21, s[12:15], s69 offen offset:1024 lds
mva 248,48,72
trv 42,2,41472
mva 244,48,68
trv 44,2,45056
mva 244,52,84
trv 46,2,45568
s_waitcnt vmcnt(25)
mva 244,56,100
buffer_load_dwordx4 v22, s[12:15], s69 offen offset:2048 lds
mva 244,60,116
rda 204,6,6144
mva 240,60,112
rda 220,7,6144
mva 240,56,96
mva 240,52,80
buffer_load_dwordx4 v23, s[12:15], s69 offen offset:3072 lds
mva 240,48,64
s_waitcnt lgkmcnt(2)
s_add_u32 s72, s72, 0x100000
s_bitset0_b32 s72, 22
mva 128,32,128
trv 48,2,49152
s_add_u32 m0, s70, 16384
mva 128,36,144
trv 50,2,49664
s_add_u32 s69, s72, 0
mva 128,40,160
trv 52,2,53248
mva 128,44,176
trv 54,2,53760
mva 132,44,180
trv 56,2,57344
mva 132,40,164
trv 58,2,57856
mva 132,36,148
trv 60,2,61440
mva 132,32,132
trv 62,2,61952
mva 136,32,136
buffer_store_dwordx4 v[104:107], v1, s[48:51], s98 offen offset:2048 sc1
mva 136,36,152
mva 136,40,168
mva 136,44,184
mva 140,44,188
mva 140,40,172
mva 140,36,156
mva 140,32,140
s_waitcnt lgkmcnt(0)
mva 156,48,140
trv 32,3,32768
mva 156,52,156
trv 34,3,33280
mva 156,56,172
trv 36,3,36864
mva 156,60,188
trv 38,3,37376
mva 152,60,184
trv 40,3,40960
mva 152,56,168
trv 42,3,41472
mva 152,52,152
trv 44,3,45056
s_waitcnt vmcnt(25)
mva 152,48,136
rda 224,6,8192
mva 148,48,132
rda 240,7,8192
mva 148,52,148
trv 46,3,45568
mva 148,56,164
mva 148,60,180
mva 144,60,176
mva 144,56,160
mva 144,52,144
mva 144,48,128
s_waitcnt lgkmcnt(0)
mva 160,32,128
trv 48,3,49152
mva 160,36,144
trv 50,3,49664
mva 160,40,160
trv 52,3,53248
mva 160,44,176
trv 54,3,53760
mva 164,44,180
trv 56,3,57344
mva 164,40,164
trv 58,3,57856
mva 164,36,148
trv 60,3,61440
mva 164,32,132
trv 62,3,61952
mva 168,32,136
buffer_load_dwordx4 v20, s[12:15], s69 offen offset:0 lds
mva 168,36,152
mva 168,40,168
mva 168,44,184
buffer_load_dwordx4 v21, s[12:15], s69 offen offset:1024 lds
mva 172,44,188
mva 172,40,172
mva 172,36,156
mva 172,32,140
s_waitcnt lgkmcnt(0)
mva 188,48,140
buffer_load_dwordx4 v22, s[12:15], s69 offen offset:2048 lds
mva 188,52,156
trv 32,4,32768
mva 188,56,172
trv 34,4,33280
mva 188,60,188
buffer_load_dwordx4 v23, s[12:15], s69 offen offset:3072 lds
mva 184,60,184
trv 36,4,36864
s_add_u32 s72, s72, 0x100000
mva 184,56,168
trv 38,4,37376
s_bitset0_b32 s72, 22
mva 184,52,152
trv 40,4,40960
s_add_u32 m0, s70, 32768
mva 184,48,136
trv 42,4,41472
s_add_u32 s69, s72, 0
mva 180,48,132
buffer_store_dwordx4 v[108:111], v1, s[48:51], s98 offen offset:3072 sc1
mva 180,52,148
trv 44,4,45056
s_waitcnt vmcnt(28)
mva 180,56,164
trv 46,4,45568
mva 180,60,180
rda 228,6,10240
mva 176,60,176
rda 244,7,10240
mva 176,56,160
mva 176,52,144
mva 176,48,128
s_waitcnt lgkmcnt(2)
mva 192,32,128
trv 48,4,49152
mva 192,36,144
trv 50,4,49664
mva 192,40,160
trv 52,4,53248
mva 192,44,176
trv 54,4,53760
mva 196,44,180
trv 56,4,57344
mva 196,40,164
trv 58,4,57856
mva 196,36,148
trv 60,4,61440
mva 196,32,132
trv 62,4,61952
mva 200,32,136
buffer_store_dwordx4 v[112:115], v1, s[48:51], s99 offen offset:0 sc1
mva 200,36,152
mva 200,40,168
mva 200,44,184
mva 204,44,188
mva 204,40,172
mva 204,36,156
mva 204,32,140
s_waitcnt lgkmcnt(0)
mva 220,48,140
trv 32,5,32768
s_waitcnt vmcnt(22)
mva 220,52,156
rda 232,6,12288
mva 220,56,172
rda 248,7,12288
mva 220,60,188
trv 34,5,33280
mva 216,60,184
trv 36,5,36864
mva 216,56,168
trv 38,5,37376
mva 216,52,152
trv 40,5,40960
mva 216,48,136
trv 42,5,41472
mva 212,48,132
trv 44,5,45056
mva 212,52,148
trv 46,5,45568
mva 212,56,164
mva 212,60,180
mva 208,60,176
buffer_store_dwordx4 v[116:119], v1, s[48:51], s99 offen offset:1024 sc1
mva 208,56,160
L_stub6:
s_cbranch_execz L_walk_a1
mva 208,52,144
mva 208,48,128
s_waitcnt lgkmcnt(0)
mva 224,32,128
trv 48,5,49152
mva 224,36,144
trv 50,5,49664
mva 224,40,160
trv 52,5,53248
mva 224,44,176
trv 54,5,53760
mva 228,44,180
trv 56,5,57344
mva 228,40,164
trv 58,5,57856
mva 228,36,148
trv 60,5,61440
mva 228,32,132
trv 62,5,61952
mva 232,32,136
mva 232,36,152
mva 232,40,168
mva 232,44,184
v_xor_b32 v2, 0x10000, v2
v_xor_b32 v3, 0x10000, v3
mva 236,44,188
s_waitcnt vmcnt(20)
rda 236,6,14336
mva 236,40,172
rda 252,7,14336
v_xor_b32 v4, 0x10000, v4
mva 236,36,156
v_xor_b32 v5, 0x10000, v5
mva 236,32,140
s_waitcnt vmcnt(15) lgkmcnt(2)
s_barrier
mva 252,48,140
buffer_load_dwordx4 v20, s[12:15], s69 offen offset:0 lds
mva 252,52,156
trv 32,2,0
mva 252,56,172
trv 34,2,512
mva 252,60,188
buffer_load_dwordx4 v21, s[12:15], s69 offen offset:1024 lds
mva 248,60,184
trv 36,2,4096
mva 248,56,168
trv 38,2,4608
mva 248,52,152
trv 40,2,8192
mva 248,48,136
buffer_load_dwordx4 v22, s[12:15], s69 offen offset:2048 lds
mva 244,48,132
trv 42,2,8704
mva 244,52,148
trv 44,2,12288
mva 244,56,164
trv 46,2,12800
mva 244,60,180
buffer_load_dwordx4 v23, s[12:15], s69 offen offset:3072 lds
mva 240,60,176
s_add_u32 s72, s72, 0x100000
s_bitset0_b32 s72, 22
s_add_u32 m0, s70, 49152
mva 240,56,160
s_add_u32 s69, s72, 0
mva 240,52,144
mva 240,48,128
s_waitcnt lgkmcnt(0)
mva 128,32,192
trv 48,2,16384
mva 128,36,208
trv 50,2,16896
mva 128,40,224
trv 52,2,20480
mva 128,44,240
trv 54,2,20992
mva 132,44,244
trv 56,2,24576
mva 132,40,228
trv 58,2,25088
s_nop 0
mva 132,36,212
trv 60,2,28672
v_mul_f32 v128, s77, v128
mva 132,32,196
trv 62,2,29184
v_mul_f32 v129, s77, v129
mva 136,32,200
buffer_store_dwordx4 v[120:123], v1, s[48:51], s99 offen offset:2048 sc1
mva 136,36,216
v_exp_f32 v128, v128
mva 136,40,232
v_exp_f32 v129, v129
mva 136,44,248
v_add_f32 v128, 1.0, v128
v_add_f32 v129, 1.0, v129
mva 140,44,252
v_rcp_f32 v128, v128
mva 140,40,236
v_rcp_f32 v129, v129
mva 140,36,220
v_mul_f32 v132, s77, v132
v_mul_f32 v133, s77, v133
mva 140,32,204
s_waitcnt lgkmcnt(0)
v_exp_f32 v132, v132
mva 156,48,204
trv 32,3,0
v_mul_f32 v136, s77, v136
mva 156,52,220
trv 34,3,512
v_mul_f32 v137, s77, v137
mva 156,56,236
trv 36,3,4096
v_mul_f32 v140, s77, v140
mva 156,60,252
trv 38,3,4608
v_mul_f32 v141, s77, v141
mva 152,60,248
trv 40,3,8192
mva 152,56,232
trv 42,3,8704
mva 152,52,216
trv 44,3,12288
mva 152,48,200
trv 46,3,12800
mva 148,48,196
buffer_store_dwordx4 v[124:127], v1, s[48:51], s99 offen offset:3072 sc1
mva 148,52,212
v_exp_f32 v133, v133
mva 148,56,228
v_exp_f32 v136, v136
mva 148,60,244
v_exp_f32 v137, v137
mva 144,60,240
v_exp_f32 v140, v140
mva 144,56,224
v_exp_f32 v141, v141
mva 144,52,208
v_add_f32 v132, 1.0, v132
v_add_f32 v133, 1.0, v133
mva 144,48,192
s_waitcnt lgkmcnt(0)
v_rcp_f32 v132, v132
mva 160,32,192
trv 48,3,16384
v_add_f32 v136, 1.0, v136
mva 160,36,208
trv 50,3,16896
v_add_f32 v137, 1.0, v137
mva 160,40,224
trv 52,3,20480
v_mul_f32 v128, v128, v144
mva 160,44,240
trv 54,3,20992
v_mul_f32 v129, v129, v145
mva 164,44,244
trv 56,3,24576
v_cvt_pk_bf16_f32 v128, v128, v129
mva 164,40,228
trv 58,3,25088
v_mul_f32 v130, s77, v130
mva 164,36,212
trv 60,3,28672
v_mul_f32 v131, s77, v131
mva 164,32,196
trv 62,3,29184
v_add_f32 v140, 1.0, v140
mva 168,32,200
buffer_load_dwordx4 v20, s[12:15], s69 offen offset:0 lds
mva 168,36,216
v_exp_f32 v130, v130
mva 168,40,232
v_exp_f32 v131, v131
mva 168,44,248
buffer_load_dwordx4 v21, s[12:15], s69 offen offset:1024 lds
mva 172,44,252
v_rcp_f32 v133, v133
mva 172,40,236
v_rcp_f32 v136, v136
mva 172,36,220
v_rcp_f32 v137, v137
mva 172,32,204
s_waitcnt lgkmcnt(0)
v_add_f32 v130, 1.0, v130
v_add_f32 v131, 1.0, v131
mva 188,48,204
buffer_load_dwordx4 v22, s[12:15], s69 offen offset:2048 lds
mva 188,52,220
trv 32,4,0
v_mul_f32 v132, v132, v148
mva 188,56,236
trv 34,4,512
v_mul_f32 v133, v133, v149
mva 188,60,252
buffer_load_dwordx4 v23, s[12:15], s69 offen offset:3072 lds
mva 184,60,248
trv 36,4,4096
v_cvt_pk_bf16_f32 v132, v132, v133
mva 184,56,232
trv 38,4,4608
v_mul_f32 v134, s77, v134
mva 184,52,216
trv 40,4,8192
v_mul_f32 v135, s77, v135
mva 184,48,200
trv 42,4,8704
v_mul_f32 v136, v136, v152
mva 180,48,196
trv 44,4,12288
v_mul_f32 v137, v137, v153
mva 180,52,212
trv 46,4,12800
v_cvt_pk_bf16_f32 v136, v136, v137
mva 180,56,228
v_rcp_f32 v130, v130
mva 180,60,244
v_rcp_f32 v131, v131
mva 176,60,240
v_exp_f32 v134, v134
mva 176,56,224
v_exp_f32 v135, v135
mva 176,52,208
v_mul_f32 v130, v130, v146
v_mul_f32 v131, v131, v147
mva 176,48,192
s_waitcnt lgkmcnt(0)
v_cvt_pk_bf16_f32 v129, v130, v131
v_mul_f32 v160, s77, v160
mva 192,32,192
trv 48,4,16384
v_mul_f32 v161, s77, v161
mva 192,36,208
trv 50,4,16896
v_add_f32 v134, 1.0, v134
mva 192,40,224
trv 52,4,20480
v_add_f32 v135, 1.0, v135
mva 192,44,240
trv 54,4,20992
v_mul_f32 v138, s77, v138
mva 196,44,244
trv 56,4,24576
v_mul_f32 v139, s77, v139
mva 196,40,228
trv 58,4,25088
v_add_f32 v141, 1.0, v141
mva 196,36,212
trv 60,4,28672
mva 196,32,196
trv 62,4,29184
mva 200,32,200
v_exp_f32 v160, v160
mva 200,36,216
v_exp_f32 v161, v161
mva 200,40,232
v_rcp_f32 v134, v134
mva 200,44,248
v_rcp_f32 v135, v135
mva 204,44,252
v_exp_f32 v138, v138
mva 204,40,236
v_exp_f32 v139, v139
mva 204,36,220
v_rcp_f32 v140, v140
mva 204,32,204
s_waitcnt lgkmcnt(0)
v_rcp_f32 v141, v141
mva 220,48,204
trv 32,5,0
v_add_f32 v160, 1.0, v160
mva 220,52,220
trv 34,5,512
v_add_f32 v161, 1.0, v161
mva 220,56,236
trv 36,5,4096
v_mul_f32 v134, v134, v150
mva 220,60,252
trv 38,5,4608
v_mul_f32 v135, v135, v151
mva 216,60,248
trv 40,5,8192
v_cvt_pk_bf16_f32 v133, v134, v135
mva 216,56,232
trv 42,5,8704
v_mul_f32 v164, s77, v164
mva 216,52,216
trv 44,5,12288
v_mul_f32 v165, s77, v165
mva 216,48,200
trv 46,5,12800
v_add_f32 v138, 1.0, v138
mva 212,48,196
v_rcp_f32 v160, v160
mva 212,52,212
v_rcp_f32 v161, v161
mva 212,56,228
v_exp_f32 v164, v164
mva 212,60,244
v_exp_f32 v165, v165
mva 208,60,240
v_mul_f32 v160, v160, v176
v_mul_f32 v161, v161, v177
mva 208,56,224
v_cvt_pk_bf16_f32 v130, v160, v161
v_mul_f32 v162, s77, v162
mva 208,52,208
v_mul_f32 v163, s77, v163
v_add_f32 v164, 1.0, v164
mva 208,48,192
s_waitcnt lgkmcnt(0)
v_exp_f32 v162, v162
mva 224,32,192
trv 48,5,16384
v_add_f32 v165, 1.0, v165
mva 224,36,208
trv 50,5,16896
v_add_f32 v139, 1.0, v139
mva 224,40,224
trv 52,5,20480
v_mul_f32 v140, v140, v156
mva 224,44,240
trv 54,5,20992
v_mul_f32 v141, v141, v157
mva 228,44,244
trv 56,5,24576
v_cvt_pk_bf16_f32 v140, v140, v141
mva 228,40,228
trv 58,5,25088
v_mul_f32 v142, s77, v142
mva 228,36,212
trv 60,5,28672
v_mul_f32 v143, s77, v143
mva 228,32,196
trv 62,5,29184
mva 232,32,200
v_exp_f32 v163, v163
mva 232,36,216
v_rcp_f32 v164, v164
mva 232,40,232
v_rcp_f32 v165, v165
mva 232,44,248
v_rcp_f32 v138, v138
mva 236,44,252
v_rcp_f32 v139, v139
mva 236,40,236
v_exp_f32 v142, v142
mva 236,36,220
v_exp_f32 v143, v143
mva 236,32,204
s_waitcnt vmcnt(4) lgkmcnt(0)
s_barrier
v_xor_b32 v2, 0x10000, v2
v_xor_b32 v3, 0x10000, v3
v_xor_b32 v4, 0x10000, v4
v_xor_b32 v5, 0x10000, v5
L_noffn_end:
mva 252,48,204
buffer_store_dwordx2 v[16:17], v29, s[48:51], 0 offen offset:128 sc1
mva 252,52,220
trv 32,2,0
s_add_u32 s72, s72, 0x100000
mva 252,56,236
trv 34,2,512
s_bitset0_b32 s72, 22
mva 252,60,252
trv 36,2,4096
s_add_u32 m0, s70, 65536
mva 248,60,248
trv 38,2,4608
s_add_u32 s69, s72, 128
mva 248,56,232
trv 40,2,8192
v_add_f32 v162, 1.0, v162
mva 248,52,216
buffer_load_dwordx4 v20, s[12:15], s69 offen offset:0 lds
mva 248,48,200
trv 42,2,8704
v_add_f32 v163, 1.0, v163
mva 244,48,196
trv 44,2,12288
v_mul_f32 v164, v164, v180
mva 244,52,212
trv 46,2,12800
v_mul_f32 v165, v165, v181
mva 244,56,228
buffer_load_dwordx4 v21, s[12:15], s69 offen offset:1024 lds
mva 244,60,244
v_rcp_f32 v162, v162
mva 240,60,240
v_rcp_f32 v163, v163
mva 240,56,224
v_mul_f32 v162, v162, v178
v_mul_f32 v163, v163, v179
mva 240,52,208
buffer_load_dwordx4 v22, s[12:15], s69 offen offset:2048 lds
mva 240,48,192
s_waitcnt lgkmcnt(0)
v_cvt_pk_bf16_f32 v131, v162, v163
v_cvt_pk_bf16_f32 v134, v164, v165
mva0 64,32,0
trv 48,2,16384
v_mul_f32 v166, s77, v166
mva 64,36,16
trv 50,2,16896
v_mul_f32 v167, s77, v167
mva 64,40,32
buffer_load_dwordx4 v23, s[12:15], s69 offen offset:3072 lds
mva 64,44,48
trv 52,2,20480
s_add_u32 s72, s72, 0x100000
mva0 68,44,52
trv 54,2,20992
s_bitset0_b32 s72, 22
mva 68,40,36
trv 56,2,24576
s_add_u32 m0, s70, 81920
mva 68,36,20
trv 58,2,25088
s_add_u32 s69, s72, 128
mva 68,32,4
trv 60,2,28672
v_mul_f32 v138, v138, v154
mva0 72,32,8
trv 62,2,29184
v_mul_f32 v139, v139, v155
mva 72,36,24
buffer_store_dwordx4 v[128:131], v9, s[48:51], s0 offen offset:0 sc1
mva 72,40,40
s_cmp_ge_u32 s58, 2
s_cselect_b64 vcc, -1, 0
mva 72,44,56
v_exp_f32 v166, v166
mva0 76,44,60
v_exp_f32 v167, v167
mva 76,40,44
v_add_u32 v6, 0x8000, v1
v_add_u32 v7, 0x18000, v1
mva 76,36,28
s_lshr_b32 s65, s58, 1
s_xor_b32 s65, s65, s58
s_and_b32 s65, s65, 1
mva 76,32,12
s_waitcnt lgkmcnt(0)
s_lshl_b32 s65, s65, 14
s_add_u32 s66, s65, 0x20000
mva 76,48,76
trv 32,3,0
v_add_u32 v10, s66, v1
mva 76,52,92
trv 34,3,512
v_lshrrev_b32 v24, 4, v0
mva 76,56,108
trv 36,3,4096
v_lshlrev_b32 v24, 2, v24
mva 76,60,124
trv 38,3,4608
v_and_b32 v25, 15, v0
mva 72,60,120
trv 40,3,8192
v_sub_u32 v24, v25, v24
mva 72,56,104
trv 42,3,8704
v_subrev_u32 v25, 0, v24
mva 72,52,88
trv 44,3,12288
v_ashrrev_i32 v25, 31, v25
mva 72,48,72
trv 46,3,12800
v_and_b32 v12, 0xf149f2ca, v25
mva 68,48,68
v_subrev_u32 v25, 1, v24
v_ashrrev_i32 v25, 31, v25
mva 68,52,84
v_and_b32 v13, 0xf149f2ca, v25
v_subrev_u32 v25, 2, v24
mva 68,56,100
v_ashrrev_i32 v25, 31, v25
v_and_b32 v14, 0xf149f2ca, v25
mva 68,60,116
v_subrev_u32 v25, 3, v24
v_ashrrev_i32 v25, 31, v25
mva 64,60,112
v_and_b32 v15, 0xf149f2ca, v25
v_bfe_i32 v11, v0, 0, 1
mva 64,56,96
v_and_b32 v11, 0xaaaaaaaa, v11
v_or_b32 v11, 0x44444444, v11
mva 64,52,80
v_and_b32 v24, 2, v0
v_subrev_u32 v24, 1, v24
mva 64,48,64
s_waitcnt lgkmcnt(0)
v_ashrrev_i32 v24, 31, v24
v_and_b32 v24, 0x3f803f80, v24
mva0 80,32,0
trv 48,3,16384
v_mov_b32 v25, v24
mva 80,36,16
trv 50,3,16896
v_mov_b64 v[26:27], v[24:25]
mva 80,40,32
trv 52,3,20480
v_add_f32 v166, 1.0, v166
mva 80,44,48
trv 54,3,20992
v_add_f32 v167, 1.0, v167
mva0 84,44,52
trv 56,3,24576
v_cvt_pk_bf16_f32 v137, v138, v139
mva 84,40,36
trv 58,3,25088
v_mul_f32 v168, s77, v168
mva 84,36,20
trv 60,3,28672
v_mul_f32 v169, s77, v169
mva 84,32,4
trv 62,3,29184
v_add_f32 v142, 1.0, v142
mva0 88,32,8
buffer_load_dwordx4 v20, s[12:15], s69 offen offset:0 lds
mva 88,36,24
v_rcp_f32 v166, v166
mva 88,40,40
v_rcp_f32 v167, v167
mva 88,44,56
buffer_load_dwordx4 v21, s[12:15], s69 offen offset:1024 lds
mva0 92,44,60
v_exp_f32 v168, v168
mva 92,40,44
v_exp_f32 v169, v169
mva 92,36,28
v_mul_f32 v166, v166, v182
v_mul_f32 v167, v167, v183
mva 92,32,12
s_waitcnt lgkmcnt(0)
v_cvt_pk_bf16_f32 v135, v166, v167
v_add_f32 v168, 1.0, v168
mva 92,48,76
buffer_load_dwordx4 v22, s[12:15], s69 offen offset:2048 lds
mva 92,52,92
trv 32,4,0
v_add_f32 v169, 1.0, v169
mva 92,56,108
trv 34,4,512
v_add_f32 v143, 1.0, v143
mva 92,60,124
buffer_load_dwordx4 v23, s[12:15], s69 offen offset:3072 lds
mva 88,60,120
trv 36,4,4096
v_lshrrev_b32 v18, 3, v0
mva 88,56,104
trv 38,4,4608
v_lshlrev_b32 v8, 15, v0
mva 88,52,88
trv 40,4,8192
v_lshl_add_u32 v8, v18, 27, v8
mva 88,48,72
trv 42,4,8704
v_xor_b32 v8, s59, v8
mva 84,48,68
trv 44,4,12288
v_mul_f32 v192, s77, v192
mva 84,52,84
trv 46,4,12800
v_mul_f32 v193, s77, v193
mva 84,56,100
buffer_store_dwordx4 v[132:135], v9, s[48:51], s0 offen offset:1024 sc1
mva 84,60,116
v_rcp_f32 v168, v168
mva 80,60,112
v_rcp_f32 v169, v169
mva 80,56,96
v_rcp_f32 v142, v142
mva 80,52,80
v_rcp_f32 v143, v143
mva 80,48,64
s_waitcnt lgkmcnt(0)
v_exp_f32 v192, v192
mva0 96,32,0
trv 48,4,16384
v_mul_f32 v168, v168, v184
mva 96,36,16
trv 50,4,16896
v_mul_f32 v169, v169, v185
mva 96,40,32
trv 52,4,20480
v_cvt_pk_bf16_f32 v138, v168, v169
mva 96,44,48
trv 54,4,20992
v_mul_f32 v170, s77, v170
mva0 100,44,52
trv 56,4,24576
v_mul_f32 v171, s77, v171
mva 100,40,36
trv 58,4,25088
v_mul_f32 v142, v142, v158
mva 100,36,20
trv 60,4,28672
v_mul_f32 v143, v143, v159
mva 100,32,4
trv 62,4,29184
v_cvt_pk_bf16_f32 v141, v142, v143
mva0 104,32,8
L_stub7:
s_cbranch_execz L_walk_a1
v_exp_f32 v170, v170
mva 104,36,24
v_exp_f32 v171, v171
mva 104,40,40
v_exp_f32 v193, v193
mva 104,44,56
v_add_f32 v170, 1.0, v170
v_add_f32 v171, 1.0, v171
mva0 108,44,60
v_rcp_f32 v170, v170
mva 108,40,44
v_rcp_f32 v171, v171
mva 108,36,28
v_mul_f32 v170, v170, v186
v_mul_f32 v171, v171, v187
mva 108,32,12
s_waitcnt lgkmcnt(0)
v_cvt_pk_bf16_f32 v139, v170, v171
v_mul_f32 v172, s77, v172
mva 108,48,76
trv 32,5,0
v_mul_f32 v173, s77, v173
mva 108,52,92
trv 34,5,512
v_add_f32 v192, 1.0, v192
mva 108,56,108
trv 36,5,4096
v_add_f32 v193, 1.0, v193
mva 108,60,124
trv 38,5,4608
v_mul_f32 v196, s77, v196
mva 104,60,120
trv 40,5,8192
v_mul_f32 v197, s77, v197
mva 104,56,104
trv 42,5,8704
mva 104,52,88
trv 44,5,12288
mva 104,48,72
trv 46,5,12800
mva 100,48,68
buffer_store_dwordx4 v[136:139], v9, s[48:51], s0 offen offset:2048 sc1
mva 100,52,84
v_exp_f32 v172, v172
mva 100,56,100
v_exp_f32 v173, v173
mva 100,60,116
v_rcp_f32 v192, v192
mva 96,60,112
v_rcp_f32 v193, v193
mva 96,56,96
v_exp_f32 v196, v196
mva 96,52,80
v_exp_f32 v197, v197
mva 96,48,64
s_waitcnt lgkmcnt(0)
v_add_f32 v172, 1.0, v172
v_add_f32 v173, 1.0, v173
mva0 112,32,0
buffer_load_dwordx2 v[18:19], v8, s[48:51], 0 offen offset:128 sc1
mva 112,36,16
trv 48,5,16384
s_add_u32 s72, s72, 0x100000
mva 112,40,32
trv 50,5,16896
s_bitset0_b32 s72, 22
mva 112,44,48
trv 52,5,20480
s_add_u32 m0, s70, 0
mva0 116,44,52
trv 54,5,20992
s_add_u32 s69, s72, 128
mva 116,40,36
trv 56,5,24576
v_mul_f32 v192, v192, v208
mva 116,36,20
trv 58,5,25088
v_mul_f32 v193, v193, v209
mva 116,32,4
trv 60,5,28672
v_cvt_pk_bf16_f32 v192, v192, v193
mva0 120,32,8
trv 62,5,29184
v_mul_f32 v194, s77, v194
mva 120,36,24
v_rcp_f32 v172, v172
mva 120,40,40
v_rcp_f32 v173, v173
mva 120,44,56
v_mul_f32 v172, v172, v188
v_mul_f32 v173, v173, v189
mva0 124,44,60
v_cvt_pk_bf16_f32 v142, v172, v173
v_mul_f32 v174, s77, v174
mva 124,40,44
v_mul_f32 v175, s77, v175
v_mul_f32 v195, s77, v195
mva 124,36,28
v_exp_f32 v174, v174
mva 124,32,12
s_waitcnt vmcnt(13) lgkmcnt(0)
s_barrier
v_add_f32 v196, 1.0, v196
mva 124,48,76
buffer_load_dwordx4 v20, s[12:15], s69 offen offset:0 lds
mva 124,52,92
trv 32,2,32768
v_add_f32 v197, 1.0, v197
mva 124,56,108
trv 34,2,33280
v_mul_f32 v200, s77, v200
mva 124,60,124
buffer_load_dwordx4 v21, s[12:15], s69 offen offset:1024 lds
mva 120,60,120
trv 36,2,36864
v_mul_f32 v201, s77, v201
mva 120,56,104
trv 38,2,37376
mva 120,52,88
trv 40,2,40960
mva 120,48,72
buffer_load_dwordx4 v22, s[12:15], s69 offen offset:2048 lds
mva 116,48,68
trv 42,2,41472
mva 116,52,84
trv 44,2,45056
mva 116,56,100
trv 46,2,45568
mva 116,60,116
buffer_load_dwordx4 v23, s[12:15], s69 offen offset:3072 lds
mva 112,60,112
s_add_u32 s72, s72, 0x100000
v_exp_f32 v175, v175
mva 112,56,96
s_bitset0_b32 s72, 22
v_exp_f32 v194, v194
mva 112,52,80
s_add_u32 m0, s70, 16384
v_exp_f32 v195, v195
mva 112,48,64
s_waitcnt lgkmcnt(0)
v_rcp_f32 v196, v196
mva 64,32,128
trv 48,2,49152
s_add_u32 s69, s72, 128
mva 64,36,144
trv 50,2,49664
v_add_f32 v174, 1.0, v174
mva 64,40,160
trv 52,2,53248
v_add_f32 v175, 1.0, v175
mva 64,44,176
trv 54,2,53760
v_add_f32 v194, 1.0, v194
mva 68,44,180
trv 56,2,57344
v_add_f32 v195, 1.0, v195
mva 68,40,164
trv 58,2,57856
mva 68,36,148
trv 60,2,61440
mva 68,32,132
trv 62,2,61952
mva 72,32,136
v_rcp_f32 v174, v174
mva 72,36,152
v_rcp_f32 v175, v175
mva 72,40,168
v_rcp_f32 v194, v194
mva 72,44,184
v_rcp_f32 v195, v195
mva 76,44,188
v_rcp_f32 v197, v197
mva 76,40,172
v_exp_f32 v200, v200
mva 76,36,156
v_exp_f32 v201, v201
mva 76,32,140
s_waitcnt lgkmcnt(0)
v_mul_f32 v174, v174, v190
v_mul_f32 v175, v175, v191
mva 76,48,204
trv 32,3,32768
v_cvt_pk_bf16_f32 v143, v174, v175
mva 76,52,220
trv 34,3,33280
v_mul_f32 v194, v194, v210
mva 76,56,236
trv 36,3,36864
v_mul_f32 v195, v195, v211
mva 76,60,252
trv 38,3,37376
v_cvt_pk_bf16_f32 v193, v194, v195
mva 72,60,248
trv 40,3,40960
v_mul_f32 v224, s77, v224
mva 72,56,232
trv 42,3,41472
v_mul_f32 v225, s77, v225
mva 72,52,216
trv 44,3,45056
v_cvt_pk_bf16_f32 v76, v76, v77
mva 72,48,200
trv 46,3,45568
v_cvt_pk_bf16_f32 v77, v78, v79
mva 68,48,196
buffer_store_dwordx4 v[140:143], v9, s[48:51], s0 offen offset:3072 sc1
mva 68,52,212
v_exp_f32 v224, v224
mva 68,56,228
v_exp_f32 v225, v225
mva 68,60,244
v_cvt_pk_bf16_f32 v72, v72, v73
v_cvt_pk_bf16_f32 v73, v74, v75
mva 64,60,240
v_add_f32 v224, 1.0, v224
v_add_f32 v225, 1.0, v225
mva 64,56,224
v_rcp_f32 v224, v224
mva 64,52,208
v_rcp_f32 v225, v225
mva 64,48,192
s_waitcnt lgkmcnt(0)
v_cvt_pk_bf16_f32 v68, v68, v69
v_cvt_pk_bf16_f32 v69, v70, v71
mva 80,32,128
trv 48,3,49152
v_mul_f32 v224, v224, v240
mva 80,36,144
trv 50,3,49664
v_cvt_pk_bf16_f32 v64, v64, v65
mva 80,40,160
trv 52,3,53248
v_cvt_pk_bf16_f32 v65, v66, v67
mva 80,44,176
trv 54,3,53760
v_mul_f32 v225, v225, v241
mva 84,44,180
trv 56,3,57344
v_cvt_pk_bf16_f32 v194, v224, v225
mva 84,40,164
trv 58,3,57856
v_mul_f32 v226, s77, v226
mva 84,36,148
trv 60,3,61440
v_mul_f32 v227, s77, v227
mva 84,32,132
trv 62,3,61952
v_mul_f32 v196, v196, v212
mva 88,32,136
buffer_load_dwordx4 v20, s[12:15], s69 offen offset:0 lds
mva 88,36,152
v_exp_f32 v226, v226
mva 88,40,168
v_exp_f32 v227, v227
mva 88,44,184
buffer_load_dwordx4 v21, s[12:15], s69 offen offset:1024 lds
mva 92,44,188
v_add_f32 v226, 1.0, v226
v_add_f32 v227, 1.0, v227
mva 92,40,172
v_rcp_f32 v226, v226
mva 92,36,156
v_rcp_f32 v227, v227
mva 92,32,140
s_waitcnt lgkmcnt(0)
v_mul_f32 v226, v226, v242
v_mul_f32 v227, v227, v243
mva 92,48,204
buffer_load_dwordx4 v22, s[12:15], s69 offen offset:2048 lds
mva 92,52,220
trv 32,4,32768
v_cvt_pk_bf16_f32 v195, v226, v227
mva 92,56,236
trv 34,4,33280
v_mul_f32 v197, v197, v213
mva 92,60,252
buffer_load_dwordx4 v23, s[12:15], s69 offen offset:3072 lds
mva 88,60,248
trv 36,4,36864
s_add_u32 m0, s62, 0
mva 88,56,232
trv 38,4,37376
v_cvt_pk_bf16_f32 v196, v196, v197
mva 88,52,216
trv 40,4,40960
v_cvt_pk_bf16_f32 v78, v92, v93
mva 88,48,200
trv 42,4,41472
v_cvt_pk_bf16_f32 v79, v94, v95
mva 84,48,196
trv 44,4,45056
v_mul_f32 v198, s77, v198
mva 84,52,212
trv 46,4,45568
v_mul_f32 v199, s77, v199
mva 84,56,228
buffer_store_dwordx4 v[192:195], v9, s[48:51], s1 offen offset:0 sc1
mva 84,60,244
v_exp_f32 v198, v198
mva 80,60,240
v_exp_f32 v199, v199
mva 80,56,224
v_cvt_pk_bf16_f32 v74, v88, v89
v_cvt_pk_bf16_f32 v75, v90, v91
mva 80,52,208
v_add_f32 v198, 1.0, v198
v_cvt_pk_bf16_f32 v70, v84, v85
mva 80,48,192
s_waitcnt lgkmcnt(0)
v_cvt_pk_bf16_f32 v71, v86, v87
v_add_f32 v199, 1.0, v199
mva 96,32,128
trv 48,4,49152
v_add_f32 v200, 1.0, v200
mva 96,36,144
trv 50,4,49664
v_cvt_pk_bf16_f32 v66, v80, v81
mva 96,40,160
trv 52,4,53248
v_cvt_pk_bf16_f32 v67, v82, v83
mva 96,44,176
trv 54,4,53760
v_add_f32 v201, 1.0, v201
mva 100,44,180
trv 56,4,57344
v_mul_f32 v204, s77, v204
mva 100,40,164
trv 58,4,57856
v_mul_f32 v205, s77, v205
mva 100,36,148
trv 60,4,61440
v_mov_b64 v[208:209], 0
mva 100,32,132
trv 62,4,61952
v_mov_b64 v[210:211], 0
mva 104,32,136
v_rcp_f32 v198, v198
mva 104,36,152
v_rcp_f32 v199, v199
mva 104,40,168
v_rcp_f32 v200, v200
mva 104,44,184
v_rcp_f32 v201, v201
mva 108,44,188
v_exp_f32 v204, v204
mva 108,40,172
v_exp_f32 v205, v205
mva 108,36,156
v_mul_f32 v198, v198, v214
v_mul_f32 v199, v199, v215
mva 108,32,140
s_waitcnt lgkmcnt(0)
v_cvt_pk_bf16_f32 v197, v198, v199
v_mul_f32 v228, s77, v228
mva 108,48,204
trv 32,5,32768
v_mul_f32 v229, s77, v229
mva 108,52,220
trv 34,5,33280
v_mul_f32 v200, v200, v216
mva 108,56,236
trv 36,5,36864
v_mul_f32 v201, v201, v217
mva 108,60,252
trv 38,5,37376
v_cvt_pk_bf16_f32 v200, v200, v201
mva 104,60,248
trv 40,5,40960
v_mul_f32 v202, s77, v202
mva 104,56,232
trv 42,5,41472
v_mul_f32 v203, s77, v203
mva 104,52,216
trv 44,5,45056
v_cvt_pk_bf16_f32 v92, v108, v109
mva 104,48,200
trv 46,5,45568
v_cvt_pk_bf16_f32 v93, v110, v111
mva 100,48,196
v_exp_f32 v228, v228
mva 100,52,212
v_exp_f32 v229, v229
mva 100,56,228
v_exp_f32 v202, v202
mva 100,60,244
v_exp_f32 v203, v203
mva 96,60,240
v_cvt_pk_bf16_f32 v88, v104, v105
v_cvt_pk_bf16_f32 v89, v106, v107
mva 96,56,224
v_add_f32 v228, 1.0, v228
v_add_f32 v229, 1.0, v229
mva 96,52,208
v_rcp_f32 v228, v228
mva 96,48,192
s_waitcnt lgkmcnt(0)
v_rcp_f32 v229, v229
mva 112,32,128
trv 48,5,49152
v_cvt_pk_bf16_f32 v84, v100, v101
mva 112,36,144
trv 50,5,49664
v_cvt_pk_bf16_f32 v85, v102, v103
mva 112,40,160
trv 52,5,53248
v_cvt_pk_bf16_f32 v80, v96, v97
mva 112,44,176
trv 54,5,53760
v_cvt_pk_bf16_f32 v81, v98, v99
mva 116,44,180
trv 56,5,57344
v_mul_f32 v228, v228, v244
mva 116,40,164
trv 58,5,57856
v_mul_f32 v229, v229, v245
mva 116,36,148
trv 60,5,61440
v_cvt_pk_bf16_f32 v198, v228, v229
mva 116,32,132
trv 62,5,61952
v_mul_f32 v230, s77, v230
mva 120,32,136
v_mul_f32 v231, s77, v231
v_add_f32 v202, 1.0, v202
mva 120,36,152
v_exp_f32 v230, v230
mva 120,40,168
v_exp_f32 v231, v231
mva 120,44,184
v_xor_b32 v2, 0x10000, v2
v_xor_b32 v3, 0x10000, v3
mva 124,44,188
v_xor_b32 v4, 0x10000, v4
v_xor_b32 v5, 0x10000, v5
mva 124,40,172
v_add_f32 v230, 1.0, v230
v_add_f32 v231, 1.0, v231
mva 124,36,156
v_rcp_f32 v230, v230
mva 124,32,140
s_waitcnt vmcnt(10) lgkmcnt(0)
s_cmp_lg_u32 s58, 2
s_cbranch_scc1 L_kv1_back
v_cmp_eq_u64 s[92:93], v[18:19], v[16:17]
s_nop 3
s_cmp_eq_u32 s92, 0xff
s_cbranch_scc0 L_kv1_spin
L_kv1_back:
s_barrier
mva 124,48,204
global_load_lds_dwordx4 v1, s[88:89] offset:0 sc1
mva 124,52,220
trv 32,2,0
v_add_f32 v203, 1.0, v203
mva 124,56,236
trv 34,2,512
v_add_f32 v204, 1.0, v204
mva 124,60,252
trv 36,2,4096
v_add_f32 v205, 1.0, v205
mva 120,60,248
trv 38,2,4608
v_mov_b64 v[224:225], 0
mva 120,56,232
trv 40,2,8192
v_mov_b64 v[226:227], 0
mva 120,52,216
trv 42,2,8704
v_cvt_pk_bf16_f32 v94, v124, v125
mva 120,48,200
trv 44,2,12288
v_cvt_pk_bf16_f32 v95, v126, v127
mva 116,48,196
trv 46,2,12800
v_mov_b64 v[240:241], 0
mva 116,52,212
s_add_u32 s90, s88, 4096
s_addc_u32 s91, s89, 0
mva 116,56,228
global_load_lds_dwordx4 v1, s[88:89] offset:1024 sc1
mva 116,60,244
v_rcp_f32 v231, v231
mva 112,60,240
v_rcp_f32 v202, v202
mva 112,56,224
global_load_lds_dwordx4 v1, s[88:89] offset:2048 sc1
mva 112,52,208
v_rcp_f32 v203, v203
mva 112,48,192
s_waitcnt lgkmcnt(0)
v_rcp_f32 v204, v204
mva0 128,32,0
trv 48,2,16384
v_cvt_pk_bf16_f32 v90, v120, v121
mva 128,36,16
global_load_lds_dwordx4 v1, s[88:89] offset:3072 sc1
mva 128,40,32
trv 50,2,16896
s_add_u32 m0, s62, 4096
mva 128,44,48
trv 52,2,20480
v_cvt_pk_bf16_f32 v91, v122, v123
mva0 132,44,52
trv 54,2,20992
v_cvt_pk_bf16_f32 v86, v116, v117
mva 132,40,36
global_load_lds_dwordx4 v1, s[90:91] offset:0 sc1
mva 132,36,20
trv 56,2,24576
v_cvt_pk_bf16_f32 v87, v118, v119
mva 132,32,4
trv 58,2,25088
v_cvt_pk_bf16_f32 v82, v112, v113
mva0 136,32,8
trv 60,2,28672
v_cvt_pk_bf16_f32 v83, v114, v115
mva 136,36,24
trv 62,2,29184
v_mul_f32 v230, v230, v246
mva 136,40,40
s_add_u32 s88, s90, 28672
s_addc_u32 s89, s91, 0
mva 136,44,56
global_load_lds_dwordx4 v1, s[90:91] offset:1024 sc1
mva0 140,44,60
v_rcp_f32 v205, v205
mva 140,40,44
v_mul_f32 v231, v231, v247
v_cvt_pk_bf16_f32 v199, v230, v231
mva 140,36,28
global_load_lds_dwordx4 v1, s[90:91] offset:2048 sc1
mva 140,32,12
s_waitcnt lgkmcnt(0)
v_mul_f32 v202, v202, v218
v_mul_f32 v203, v203, v219
mva 140,48,76
trv 32,3,0
v_cvt_pk_bf16_f32 v201, v202, v203
mva 140,52,92
trv 34,3,512
v_mul_f32 v232, s77, v232
mva 140,56,108
global_load_lds_dwordx4 v1, s[90:91] offset:3072 sc1
mva 140,60,124
trv 36,3,4096
s_add_u32 m0, s62, 65536
mva 136,60,120
trv 38,3,4608
v_mul_f32 v233, s77, v233
mva 136,56,104
trv 40,3,8192
v_mul_f32 v204, v204, v220
mva 136,52,88
global_load_lds_dwordx4 v1, s[88:89] offset:0 sc1
mva 136,48,72
trv 42,3,8704
v_mul_f32 v205, v205, v221
mva 132,48,68
trv 44,3,12288
v_cvt_pk_bf16_f32 v204, v204, v205
mva 132,52,84
trv 46,3,12800
v_mul_f32 v206, s77, v206
mva 132,56,100
buffer_store_dwordx4 v[196:199], v9, s[48:51], s1 offen offset:1024 sc1
mva 132,60,116
s_add_u32 s90, s88, 4096
s_addc_u32 s91, s89, 0
mva 128,60,112
v_exp_f32 v232, v232
mva 128,56,96
v_exp_f32 v233, v233
mva 128,52,80
v_add_f32 v232, 1.0, v232
v_add_f32 v233, 1.0, v233
mva 128,48,64
s_waitcnt lgkmcnt(0)
v_rcp_f32 v232, v232
mva0 144,32,0
trv 48,3,16384
v_mul_f32 v207, s77, v207
mva 144,36,16
global_load_lds_dwordx4 v1, s[88:89] offset:1024 sc1
mva 144,40,32
trv 50,3,16896
v_mov_b64 v[20:21], 0
mva 144,44,48
trv 52,3,20480
v_mov_b64 v[22:23], 0
mva0 148,44,52
trv 54,3,20992
v_lshrrev_b32 v18, 5, v0
mva 148,40,36
global_load_lds_dwordx4 v1, s[88:89] offset:2048 sc1
mva 148,36,20
trv 56,3,24576
v_lshlrev_b32 v8, 10, v0
mva 148,32,4
trv 58,3,25088
v_lshl_add_u32 v8, v18, 27, v8
mva0 152,32,8
trv 60,3,28672
v_xor_b32 v8, s59, v8
mva 152,36,24
global_load_lds_dwordx4 v1, s[88:89] offset:3072 sc1
mva 152,40,40
trv 62,3,29184
s_add_u32 m0, s62, 69632
L_stub8:
s_cbranch_execz L_walk_a2
mva 152,44,56
s_add_u32 s79, s85, s63
v_rcp_f32 v233, v233
mva0 156,44,60
s_sub_u32 s78, 15, s57
v_exp_f32 v206, v206
mva 156,40,44
global_load_lds_dwordx4 v1, s[90:91] offset:0 sc1
mva 156,36,28
s_add_u32 s88, s90, 28672
s_addc_u32 s89, s91, 0
mva 156,32,12
s_waitcnt lgkmcnt(0)
v_exp_f32 v207, v207
mva 156,48,76
trv 32,4,0
v_mul_f32 v232, v232, v248
mva 156,52,92
global_load_lds_dwordx4 v1, s[90:91] offset:1024 sc1
mva 156,56,108
trv 34,4,512
v_mul_f32 v233, v233, v249
mva 156,60,124
trv 36,4,4096
v_cvt_pk_bf16_f32 v202, v232, v233
mva 152,60,120
trv 38,4,4608
v_mul_f32 v234, s77, v234
mva 152,56,104
global_load_lds_dwordx4 v1, s[90:91] offset:2048 sc1
mva 152,52,88
trv 40,4,8192
v_mul_f32 v235, s77, v235
mva 152,48,72
trv 42,4,8704
v_add_f32 v206, 1.0, v206
mva 148,48,68
trv 44,4,12288
v_add_f32 v207, 1.0, v207
mva 148,52,84
global_load_lds_dwordx4 v1, s[90:91] offset:3072 sc1
mva 148,56,100
trv 46,4,12800
s_lshl_b32 s78, s78, 16
mva 148,60,116
s_add_u32 s78, s78, s79
v_exp_f32 v234, v234
mva 144,60,112
s_add_u32 s71, s57, 1
v_exp_f32 v235, v235
mva 144,56,96
s_lshl_b32 s71, s71, 16
v_rcp_f32 v206, v206
mva 144,52,80
s_add_u32 s79, s79, s71
v_rcp_f32 v207, v207
mva 144,48,64
s_waitcnt lgkmcnt(0)
v_add_f32 v234, 1.0, v234
v_add_f32 v235, 1.0, v235
mva0 160,32,0
trv 48,4,16384
v_mul_f32 v206, v206, v222
mva 160,36,16
trv 50,4,16896
v_mul_f32 v207, v207, v223
mva 160,40,32
trv 52,4,20480
v_cvt_pk_bf16_f32 v205, v206, v207
mva 160,44,48
trv 54,4,20992
v_mul_f32 v236, s77, v236
mva0 164,44,52
trv 56,4,24576
v_mul_f32 v237, s77, v237
mva 164,40,36
trv 58,4,25088
s_andn2_b32 s71, 1, s58
mva 164,36,20
trv 60,4,28672
s_lshl_b32 s71, s71, 15
mva 164,32,4
trv 62,4,29184
s_mov_b32 s75, 0
mva0 168,32,8
s_lshl_b32 s82, s58, 2
v_rcp_f32 v234, v234
mva 168,36,24
s_lshr_b32 s82, 0x1022, s82
v_rcp_f32 v235, v235
mva 168,40,40
s_and_b32 s82, s82, 3
v_exp_f32 v236, v236
mva 168,44,56
s_lshl_b32 s83, s57, 1
v_exp_f32 v237, v237
mva0 172,44,60
s_add_u32 s82, s83, s82
v_mul_f32 v234, v234, v250
v_mul_f32 v235, v235, v251
mva 172,40,44
s_add_u32 s61, s83, 1
v_cvt_pk_bf16_f32 v203, v234, v235
v_add_f32 v236, 1.0, v236
mva 172,36,28
buffer_store_dwordx4 v[200:203], v9, s[48:51], s1 offen offset:2048 sc1
mva 172,32,12
s_waitcnt lgkmcnt(0)
v_add_f32 v237, 1.0, v237
s_mov_b32 s81, 0
mva 172,48,76
trv 32,5,0
s_mov_b32 s80, 0
mva 172,52,92
trv 34,5,512
v_mov_b64 v[242:243], 0
mva 172,56,108
trv 36,5,4096
v_mov_b64 v[192:193], 0
mva 172,60,124
trv 38,5,4608
v_mov_b64 v[194:195], 0
mva 168,60,120
trv 40,5,8192
v_mov_b64 v[212:213], 0
mva 168,56,104
trv 42,5,8704
v_mov_b64 v[214:215], 0
mva 168,52,88
trv 44,5,12288
v_mov_b64 v[228:229], 0
mva 168,48,72
trv 46,5,12800
v_mov_b64 v[230:231], 0
mva 164,48,68
v_rcp_f32 v236, v236
mva 164,52,84
v_rcp_f32 v237, v237
mva 164,56,100
v_mul_f32 v236, v236, v252
v_mul_f32 v237, v237, v253
mva 164,60,116
v_cvt_pk_bf16_f32 v206, v236, v237
v_mul_f32 v238, s77, v238
mva 160,60,112
v_mul_f32 v239, s77, v239
v_mov_b64 v[244:245], 0
mva 160,56,96
v_exp_f32 v238, v238
mva 160,52,80
v_exp_f32 v239, v239
mva 160,48,64
s_waitcnt lgkmcnt(0)
v_add_f32 v238, 1.0, v238
v_add_f32 v239, 1.0, v239
mva0 176,32,0
trv 48,5,16384
v_mov_b64 v[246:247], 0
mva 176,36,16
trv 50,5,16896
v_mov_b64 v[196:197], 0
mva 176,40,32
trv 52,5,20480
v_mov_b64 v[198:199], 0
mva 176,44,48
trv 54,5,20992
v_mov_b64 v[216:217], 0
mva0 180,44,52
trv 56,5,24576
v_mov_b64 v[218:219], 0
mva 180,40,36
trv 58,5,25088
v_mov_b64 v[232:233], 0
mva 180,36,20
trv 60,5,28672
v_mov_b64 v[234:235], 0
mva 180,32,4
trv 62,5,29184
v_mov_b64 v[248:249], 0
mva0 184,32,8
v_rcp_f32 v238, v238
mva 184,36,24
v_rcp_f32 v239, v239
mva 184,40,40
v_mul_f32 v238, v238, v254
v_mul_f32 v239, v239, v255
mva 184,44,56
v_xor_b32 v2, 0x10000, v2
v_xor_b32 v3, 0x10000, v3
mva0 188,44,60
v_xor_b32 v4, 0x10000, v4
v_xor_b32 v5, 0x10000, v5
mva 188,40,44
v_cvt_pk_bf16_f32 v207, v238, v239
v_mov_b64 v[250:251], 0
mva 188,36,28
buffer_store_dwordx4 v[204:207], v9, s[48:51], s1 offen offset:3072 sc1
mva 188,32,12
s_waitcnt vmcnt(11) lgkmcnt(0)
s_barrier
v_mov_b64 v[200:201], 0
mva 188,48,76
trv 32,2,0
v_mov_b64 v[202:203], 0
mva 188,52,92
trv 34,2,512
v_mov_b64 v[220:221], 0
mva 188,56,108
trv 36,2,4096
v_mov_b64 v[222:223], 0
mva 188,60,124
trv 38,2,4608
v_mov_b64 v[236:237], 0
mva 184,60,120
trv 40,2,8192
v_mov_b64 v[238:239], 0
mva 184,56,104
trv 42,2,8704
v_mov_b64 v[252:253], 0
mva 184,52,88
trv 44,2,12288
v_mov_b64 v[254:255], 0
mva 184,48,72
trv 46,2,12800
v_mov_b64 v[204:205], 0
mva 180,48,68
s_cbranch_vccnz L_q64
ds_write_b128 v10, v[64:67] offset:0
L_q64:
mva 180,52,84
v_mov_b64 v[206:207], 0
mva 180,56,100
mva 180,60,116
mva 176,60,112
s_cbranch_vccnz L_q68
ds_write_b128 v10, v[68:71] offset:1024
L_q68:
mva 176,56,96
mva 176,52,80
mva 176,48,64
s_waitcnt lgkmcnt(0)
mva 128,32,128
rda 0,6,0
mva 128,36,144
trv 48,2,16384
mva 128,40,160
trv 50,2,16896
mva 128,44,176
rda 4,6,1024
mva 132,44,180
trv 52,2,20480
mva 132,40,164
trv 54,2,20992
mva 132,36,148
trv 56,2,24576
mva 132,32,132
rda 8,6,2048
mva 136,32,136
trv 58,2,25088
mva 136,36,152
trv 60,2,28672
mva 136,40,168
trv 62,2,29184
mva 136,44,184
rda 12,6,3072
mva 140,44,188
s_cbranch_vccnz L_q72
ds_write_b128 v10, v[72:75] offset:2048
L_q72:
mva 140,40,172
mva 140,36,156
rda 16,6,4096
mva 140,32,140
s_waitcnt lgkmcnt(2)
mva 140,48,204
trv 32,3,0
mva 140,52,220
rda 20,6,5120
mva 140,56,236
trv 34,3,512
mva 140,60,252
trv 36,3,4096
mva 136,60,248
trv 38,3,4608
mva 136,56,232
rda 24,6,6144
s_nop 0
mva 136,52,216
trv 40,3,8192
v_cvt_pk_bf16_f32 v108, v140, v141
mva 136,48,200
trv 42,3,8704
v_cvt_pk_bf16_f32 v109, v142, v143
mva 132,48,196
rda 28,6,7168
v_mov_b64 v[140:141], 0
mva 132,52,212
trv 44,3,12288
v_mov_b64 v[142:143], 0
mva 132,56,228
trv 46,3,12800
v_cvt_pk_bf16_f32 v104, v136, v137
mva 132,60,244
s_cbranch_vccnz L_q76
ds_write_b128 v10, v[76:79] offset:3072
L_q76:
mva 128,60,240
rda 32,6,8192
v_cvt_pk_bf16_f32 v105, v138, v139
mva 128,56,224
v_mov_b64 v[136:137], 0
v_mov_b64 v[138:139], 0
mva 128,52,208
v_cvt_pk_bf16_f32 v100, v132, v133
v_cvt_pk_bf16_f32 v101, v134, v135
mva 128,48,192
s_waitcnt lgkmcnt(1)
rda 36,6,9216
mva 144,32,128
trv 48,3,16384
v_mov_b64 v[132:133], 0
mva 144,36,144
trv 50,3,16896
v_mov_b64 v[134:135], 0
mva 144,40,160
trv 52,3,20480
v_cvt_pk_bf16_f32 v96, v128, v129
mva 144,44,176
rda 40,6,10240
v_cvt_pk_bf16_f32 v97, v130, v131
mva 148,44,180
trv 54,3,20992
v_mov_b64 v[128:129], 0
mva 148,40,164
trv 56,3,24576
v_mov_b64 v[130:131], 0
mva 148,36,148
rda 44,6,11264
mva 148,32,132
trv 58,3,25088
mva 152,32,136
trv 60,3,28672
mva 152,36,152
trv 62,3,29184
mva 152,40,168
rda 48,6,12288
mva 152,44,184
s_cbranch_vccnz L_q80
ds_write_b128 v10, v[80:83] offset:4096
L_q80:
mva 156,44,188
mva 156,40,172
rda 52,6,13312
mva 156,36,156
mva 156,32,140
s_waitcnt lgkmcnt(2)
mva 156,48,204
trv 32,4,0
mva 156,52,220
rda 56,6,14336
mva 156,56,236
trv 34,4,512
mva 156,60,252
trv 36,4,4096
mva 152,60,248
rda 60,6,15360
mva 152,56,232
trv 38,4,4608
s_nop 0
mva 152,52,216
trv 40,4,8192
v_cvt_pk_bf16_f32 v110, v156, v157
mva 152,48,200
trv 42,4,8704
v_cvt_pk_bf16_f32 v111, v158, v159
mva 148,48,196
rda 64,6,16384
v_mov_b64 v[156:157], 0
mva 148,52,212
trv 44,4,12288
v_mov_b64 v[158:159], 0
mva 148,56,228
trv 46,4,12800
v_cvt_pk_bf16_f32 v106, v152, v153
mva 148,60,244
rda 68,6,17408
v_cvt_pk_bf16_f32 v107, v154, v155
mva 144,60,240
s_cbranch_vccnz L_q84
ds_write_b128 v10, v[84:87] offset:5120
L_q84:
mva 144,56,224
v_mov_b64 v[152:153], 0
v_mov_b64 v[154:155], 0
mva 144,52,208
v_cvt_pk_bf16_f32 v102, v148, v149
v_cvt_pk_bf16_f32 v103, v150, v151
mva 144,48,192
s_waitcnt lgkmcnt(1)
rda 72,6,18432
mva 160,32,128
trv 48,4,16384
v_mov_b64 v[148:149], 0
mva 160,36,144
trv 50,4,16896
v_mov_b64 v[150:151], 0
mva 160,40,160
rda 76,6,19456
v_cvt_pk_bf16_f32 v98, v144, v145
mva 160,44,176
trv 52,4,20480
v_cvt_pk_bf16_f32 v99, v146, v147
mva 164,44,180
trv 54,4,20992
v_mov_b64 v[144:145], 0
mva 164,40,164
trv 56,4,24576
v_mov_b64 v[146:147], 0
mva 164,36,148
rda 80,6,20480
mva 164,32,132
trv 58,4,25088
mva 168,32,136
trv 60,4,28672
mva 168,36,152
rda 84,6,21504
mva 168,40,168
trv 62,4,29184
mva 168,44,184
s_cbranch_vccnz L_q88
ds_write_b128 v10, v[88:91] offset:6144
L_q88:
mva 172,44,188
mva 172,40,172
rda 88,6,22528
mva 172,36,156
mva 172,32,140
s_waitcnt lgkmcnt(1)
mva 172,48,204
rda 92,6,23552
mva 172,52,220
trv 32,5,0
mva 172,56,236
trv 34,5,512
mva 172,60,252
trv 36,5,4096
mva 168,60,248
rda 96,6,24576
mva 168,56,232
trv 38,5,4608
s_nop 0
mva 168,52,216
trv 40,5,8192
v_cvt_pk_bf16_f32 v124, v172, v173
mva 168,48,200
trv 42,5,8704
v_cvt_pk_bf16_f32 v125, v174, v175
mva 164,48,196
rda 100,6,25600
v_mov_b64 v[172:173], 0
mva 164,52,212
trv 44,5,12288
v_mov_b64 v[174:175], 0
mva 164,56,228
trv 46,5,12800
v_cvt_pk_bf16_f32 v120, v168, v169
mva 164,60,244
rda 104,6,26624
v_cvt_pk_bf16_f32 v121, v170, v171
mva 160,60,240
s_cbranch_vccnz L_q92
ds_write_b128 v10, v[92:95] offset:7168
L_q92:
mva 160,56,224
v_mov_b64 v[168:169], 0
v_mov_b64 v[170:171], 0
mva 160,52,208
v_cvt_pk_bf16_f32 v116, v164, v165
v_cvt_pk_bf16_f32 v117, v166, v167
mva 160,48,192
s_waitcnt lgkmcnt(1)
rda 108,6,27648
mva 176,32,128
trv 48,5,16384
v_mov_b64 v[164:165], 0
mva 176,36,144
trv 50,5,16896
v_mov_b64 v[166:167], 0
mva 176,40,160
rda 112,6,28672
v_cvt_pk_bf16_f32 v112, v160, v161
mva 176,44,176
trv 52,5,20480
v_cvt_pk_bf16_f32 v113, v162, v163
mva 180,44,180
trv 54,5,20992
v_mov_b64 v[160:161], 0
mva 180,40,164
trv 56,5,24576
v_mov_b64 v[162:163], 0
mva 180,36,148
rda 116,6,29696
mva 180,32,132
trv 58,5,25088
mva 184,32,136
trv 60,5,28672
mva 184,36,152
rda 120,6,30720
mva 184,40,168
trv 62,5,29184
mva 184,44,184
s_cbranch_vccnz L_q96
ds_write_b128 v10, v[96:99] offset:8192
L_q96:
mva 188,44,188
mva 188,40,172
rda 124,6,31744
mva 188,36,156
mva 188,32,140
s_waitcnt lgkmcnt(1)
mva 188,48,204
s_cbranch_vccnz L_q100
ds_write_b128 v10, v[100:103] offset:9216
L_q100:
mva 188,52,220
mva 188,56,236
mva 188,60,252
mva 184,60,248
s_cbranch_vccnz L_q104
ds_write_b128 v10, v[104:107] offset:10240
L_q104:
mva 184,56,232
s_nop 2
mva 184,52,216
s_nop 0
v_cvt_pk_bf16_f32 v126, v188, v189
v_cvt_pk_bf16_f32 v127, v190, v191
mva 184,48,200
v_mov_b64 v[188:189], 0
v_mov_b64 v[190:191], 0
mva 180,48,196
s_cbranch_vccnz L_q108
ds_write_b128 v10, v[108:111] offset:11264
L_q108:
mva 180,52,212
s_nop 2
mva 180,56,228
v_cvt_pk_bf16_f32 v122, v184, v185
v_cvt_pk_bf16_f32 v123, v186, v187
mva 180,60,244
v_mov_b64 v[184:185], 0
v_mov_b64 v[186:187], 0
mva 176,60,240
mva 176,56,224
s_nop 2
mva 176,52,208
v_cvt_pk_bf16_f32 v118, v180, v181
v_cvt_pk_bf16_f32 v119, v182, v183
mva 176,48,192
s_nop 7
v_cvt_pk_bf16_f32 v114, v176, v177
v_cvt_pk_bf16_f32 v115, v178, v179
v_mov_b64 v[176:177], 0
v_mov_b64 v[178:179], 0
v_mov_b64 v[180:181], 0
v_mov_b64 v[182:183], 0
s_cbranch_vccnz L_q112
ds_write_b128 v10, v[112:115] offset:12288
L_q112:
s_cbranch_vccnz L_q116
ds_write_b128 v10, v[116:119] offset:13312
L_q116:
s_cbranch_vccnz L_q120
ds_write_b128 v10, v[120:123] offset:14336
L_q120:
s_cbranch_vccnz L_q124
ds_write_b128 v10, v[124:127] offset:15360
L_q124:
v_mov_b32 v44, 0xf149f2ca
v_mov_b32 v45, 0xf149f2ca
v_mov_b32 v46, 0xf149f2ca
v_mov_b32 v47, 0xf149f2ca
v_mov_b64 v[56:57], 0
v_mov_b64 v[58:59], 0
v_mov_b64 v[60:61], 0
s_cmp_eq_u32 s57, 0
s_cbranch_scc0 L_c_e8
s_branch L_c_mid
.p2align 6
L_c_e8:
mav0 32,0,64
v_exp_f32 v44, v44
mav 32,4,80
mav 32,8,96
s_waitcnt vmcnt(0) lgkmcnt(0)
s_barrier
v_exp_f32 v45, v45
mav 32,12,112
rda 128,7,0
v_cvt_pk_bf16_f32 v62, v44, v45
mav0 36,28,112
s_add_u32 m0, s62, 0
v_exp_f32 v46, v46
mav 36,24,96
global_load_lds_dwordx4 v1, s[88:89] offset:0 sc1
mav 36,20,80
s_add_u32 s90, s88, 4096
v_exp_f32 v47, v47
L_stub9:
s_cbranch_execz L_walk_a2
mav 36,16,64
rda 132,7,1024
v_cvt_pk_bf16_f32 v63, v46, v47
mav0 40,32,64
s_addc_u32 s91, s89, 0
v_exp_f32 v32, v32
mav 40,36,80
global_load_lds_dwordx4 v1, s[88:89] offset:1024 sc1
mav 40,40,96
v_exp_f32 v33, v33
mav 40,44,112
rda 136,7,2048
v_cvt_pk_bf16_f32 v48, v32, v33
mav0 44,60,112
v_exp_f32 v34, v34
mav 44,56,96
global_load_lds_dwordx4 v1, s[88:89] offset:2048 sc1
v_mov_b64 v[32:33], 0
mav 44,52,80
v_exp_f32 v35, v35
mav 44,48,64
rda 140,7,3072
v_cvt_pk_bf16_f32 v49, v34, v35
v_smfmac_f32_16x16x64_bf16 v[32:35], v[24:27], v[56:63], v11
mav 224,192,56
v_exp_f32 v36, v36
mav 224,196,60
global_load_lds_dwordx4 v1, s[88:89] offset:3072 sc1
mav 228,204,60
v_exp_f32 v37, v37
mav 228,200,56
rda 144,7,4096
v_cvt_pk_bf16_f32 v50, v36, v37
mav 232,208,56
s_add_u32 m0, s62, 4096
v_exp_f32 v38, v38
mav 232,212,60
global_load_lds_dwordx4 v1, s[90:91] offset:0 sc1
mav 236,220,60
s_add_u32 s88, s90, 28672
v_exp_f32 v39, v39
mav 236,216,56
rda 148,7,5120
v_cvt_pk_bf16_f32 v51, v38, v39
mav 240,224,56
s_addc_u32 s89, s91, 0
v_exp_f32 v40, v40
mav 240,228,60
global_load_lds_dwordx4 v1, s[90:91] offset:1024 sc1
v_add_f32 v23, v23, v32
mav 244,236,60
v_exp_f32 v41, v41
mav 244,232,56
rda 152,7,6144
v_cvt_pk_bf16_f32 v52, v40, v41
mav 248,240,56
v_exp_f32 v42, v42
mav 248,244,60
global_load_lds_dwordx4 v1, s[90:91] offset:2048 sc1
v_add_f32 v23, v23, v33
mav 252,252,60
v_exp_f32 v43, v43
mav 252,248,56
rda 156,7,7168
v_cvt_pk_bf16_f32 v53, v42, v43
mav0 32,0,68
v_exp_f32 v44, v44
mav 32,4,84
global_load_lds_dwordx4 v1, s[90:91] offset:3072 sc1
mav 32,8,100
v_exp_f32 v45, v45
mav 32,12,116
rda 160,7,8192
v_cvt_pk_bf16_f32 v54, v44, v45
mav0 36,28,116
v_exp_f32 v46, v46
mav 36,24,100
mav 36,20,84
v_exp_f32 v47, v47
mav 36,16,68
rda 164,7,9216
v_cvt_pk_bf16_f32 v55, v46, v47
mav0 40,32,68
v_exp_f32 v32, v32
mav 40,36,84
mav 40,40,100
v_exp_f32 v33, v33
mav 40,44,116
rda 168,7,10240
v_cvt_pk_bf16_f32 v56, v32, v33
mav0 44,60,116
v_exp_f32 v34, v34
mav 44,56,100
v_mov_b64 v[32:33], 0
mav 44,52,84
v_exp_f32 v35, v35
mav 44,48,68
rda 172,7,11264
v_cvt_pk_bf16_f32 v57, v34, v35
v_smfmac_f32_16x16x64_bf16 v[32:35], v[24:27], v[48:55], v11
mav 128,64,48
v_exp_f32 v36, v36
mav 128,68,52
mav 132,76,52
v_exp_f32 v37, v37
mav 132,72,48
rda 176,7,12288
v_cvt_pk_bf16_f32 v58, v36, v37
mav 136,80,48
v_exp_f32 v38, v38
mav 136,84,52
mav 140,92,52
v_exp_f32 v39, v39
mav 140,88,48
rda 180,7,13312
v_cvt_pk_bf16_f32 v59, v38, v39
mav 144,96,48
v_exp_f32 v40, v40
mav 144,100,52
v_add_f32 v20, v20, v32
mav 148,108,52
v_exp_f32 v41, v41
mav 148,104,48
rda 184,7,14336
v_cvt_pk_bf16_f32 v60, v40, v41
mav 152,112,48
v_exp_f32 v42, v42
mav 152,116,52
v_add_f32 v20, v20, v33
mav 156,124,52
v_exp_f32 v43, v43
mav 156,120,48
rda 188,7,15360
v_cvt_pk_bf16_f32 v61, v42, v43
mav0 32,0,72
v_exp_f32 v44, v44
mav 32,4,88
mav 32,8,104
v_exp_f32 v45, v45
mav 32,12,120
rda 192,7,16384
v_cvt_pk_bf16_f32 v62, v44, v45
mav0 36,28,120
v_exp_f32 v46, v46
mav 36,24,104
mav 36,20,88
v_exp_f32 v47, v47
mav 36,16,72
rda 196,7,17408
v_cvt_pk_bf16_f32 v63, v46, v47
mav0 40,32,72
v_exp_f32 v32, v32
mav 40,36,88
mav 40,40,104
v_exp_f32 v33, v33
mav 40,44,120
rda 200,7,18432
v_cvt_pk_bf16_f32 v48, v32, v33
mav0 44,60,120
v_exp_f32 v34, v34
mav 44,56,104
v_mov_b64 v[32:33], 0
mav 44,52,88
v_exp_f32 v35, v35
mav 44,48,72
rda 204,7,19456
v_cvt_pk_bf16_f32 v49, v34, v35
v_smfmac_f32_16x16x64_bf16 v[32:35], v[24:27], v[56:63], v11
mav 160,64,56
v_exp_f32 v36, v36
mav 160,68,60
mav 164,76,60
v_exp_f32 v37, v37
mav 164,72,56
rda 208,7,20480
v_cvt_pk_bf16_f32 v50, v36, v37
mav 168,80,56
v_exp_f32 v38, v38
mav 168,84,60
mav 172,92,60
v_exp_f32 v39, v39
mav 172,88,56
rda 212,7,21504
v_cvt_pk_bf16_f32 v51, v38, v39
mav 176,96,56
v_exp_f32 v40, v40
mav 176,100,60
v_add_f32 v21, v21, v32
mav 180,108,60
v_exp_f32 v41, v41
mav 180,104,56
rda 216,7,22528
v_cvt_pk_bf16_f32 v52, v40, v41
mav 184,112,56
v_exp_f32 v42, v42
mav 184,116,60
v_add_f32 v21, v21, v33
mav 188,124,60
v_exp_f32 v43, v43
mav 188,120,56
rda 220,7,23552
v_cvt_pk_bf16_f32 v53, v42, v43
mav0 32,0,76
v_exp_f32 v44, v44
mav 32,4,92
rda 224,7,24576
mav 32,8,108
v_exp_f32 v45, v45
mav 32,12,124
rda 228,7,25600
v_cvt_pk_bf16_f32 v54, v44, v45
mav0 36,28,124
s_add_u32 s81, s81, 1
v_exp_f32 v46, v46
mav 36,24,108
mav 36,20,92
v_exp_f32 v47, v47
mav 36,16,76
rda 232,7,26624
v_cvt_pk_bf16_f32 v55, v46, v47
mav0 40,32,76
v_exp_f32 v32, v32
mav 40,36,92
mav 40,40,108
v_exp_f32 v33, v33
mav 40,44,124
rda 236,7,27648
v_cvt_pk_bf16_f32 v56, v32, v33
mav0 44,60,124
v_exp_f32 v34, v34
mav 44,56,108
v_mov_b64 v[32:33], 0
mav 44,52,92
v_exp_f32 v35, v35
mav 44,48,76
rda 240,7,28672
v_cvt_pk_bf16_f32 v57, v34, v35
v_smfmac_f32_16x16x64_bf16 v[32:35], v[24:27], v[48:55], v11
mav 192,64,48
v_exp_f32 v36, v36
mav 192,68,52
mav 196,76,52
v_exp_f32 v37, v37
mav 196,72,48
rda 244,7,29696
v_cvt_pk_bf16_f32 v58, v36, v37
mav 200,80,48
v_exp_f32 v38, v38
mav 200,84,52
mav 204,92,52
v_exp_f32 v39, v39
mav 204,88,48
rda 248,7,30720
v_cvt_pk_bf16_f32 v59, v38, v39
mav 208,96,48
s_waitcnt lgkmcnt(7)
v_exp_f32 v40, v40
mav 208,100,52
v_add_f32 v22, v22, v32
mav 212,108,52
v_exp_f32 v41, v41
mav 212,104,48
rda 252,7,31744
v_cvt_pk_bf16_f32 v60, v40, v41
mav 216,112,48
v_exp_f32 v42, v42
mav 216,116,52
v_add_f32 v22, v22, v33
mav 220,124,52
v_exp_f32 v43, v43
mav 220,120,48
v_cvt_pk_bf16_f32 v61, v42, v43
mav0 32,128,64
v_exp_f32 v44, v44
mav 32,132,80
mav 32,136,96
s_waitcnt vmcnt(0) lgkmcnt(0)
s_barrier
v_exp_f32 v45, v45
mav 32,140,112
rda 0,6,0
v_cvt_pk_bf16_f32 v62, v44, v45
mav0 36,156,112
s_add_u32 m0, s62, 65536
v_exp_f32 v46, v46
mav 36,152,96
global_load_lds_dwordx4 v1, s[88:89] offset:0 sc1
mav 36,148,80
s_add_u32 s90, s88, 4096
v_exp_f32 v47, v47
mav 36,144,64
rda 4,6,1024
v_cvt_pk_bf16_f32 v63, v46, v47
mav0 40,160,64
s_addc_u32 s91, s89, 0
v_exp_f32 v32, v32
mav 40,164,80
global_load_lds_dwordx4 v1, s[88:89] offset:1024 sc1
mav 40,168,96
v_exp_f32 v33, v33
mav 40,172,112
rda 8,6,2048
v_cvt_pk_bf16_f32 v48, v32, v33
mav0 44,188,112
v_exp_f32 v34, v34
mav 44,184,96
global_load_lds_dwordx4 v1, s[88:89] offset:2048 sc1
v_mov_b64 v[32:33], 0
mav 44,180,80
v_exp_f32 v35, v35
mav 44,176,64
rda 12,6,3072
v_cvt_pk_bf16_f32 v49, v34, v35
v_smfmac_f32_16x16x64_bf16 v[32:35], v[24:27], v[56:63], v11
mav 224,64,56
v_exp_f32 v36, v36
mav 224,68,60
global_load_lds_dwordx4 v1, s[88:89] offset:3072 sc1
mav 228,76,60
v_exp_f32 v37, v37
mav 228,72,56
rda 16,6,4096
v_cvt_pk_bf16_f32 v50, v36, v37
mav 232,80,56
s_add_u32 m0, s62, 69632
v_exp_f32 v38, v38
mav 232,84,60
global_load_lds_dwordx4 v1, s[90:91] offset:0 sc1
mav 236,92,60
s_add_u32 s88, s90, 28672
v_exp_f32 v39, v39
mav 236,88,56
rda 20,6,5120
v_cvt_pk_bf16_f32 v51, v38, v39
mav 240,96,56
s_addc_u32 s89, s91, 0
v_exp_f32 v40, v40
mav 240,100,60
global_load_lds_dwordx4 v1, s[90:91] offset:1024 sc1
v_add_f32 v23, v23, v32
mav 244,108,60
v_exp_f32 v41, v41
mav 244,104,56
rda 24,6,6144
v_cvt_pk_bf16_f32 v52, v40, v41
mav 248,112,56
v_exp_f32 v42, v42
mav 248,116,60
global_load_lds_dwordx4 v1, s[90:91] offset:2048 sc1
v_add_f32 v23, v23, v33
mav 252,124,60
v_exp_f32 v43, v43
mav 252,120,56
rda 28,6,7168
v_cvt_pk_bf16_f32 v53, v42, v43
mav0 32,128,68
v_exp_f32 v44, v44
mav 32,132,84
global_load_lds_dwordx4 v1, s[90:91] offset:3072 sc1
mav 32,136,100
v_exp_f32 v45, v45
mav 32,140,116
rda 32,6,8192
v_cvt_pk_bf16_f32 v54, v44, v45
mav0 36,156,116
v_exp_f32 v46, v46
mav 36,152,100
mav 36,148,84
v_exp_f32 v47, v47
mav 36,144,68
rda 36,6,9216
v_cvt_pk_bf16_f32 v55, v46, v47
mav0 40,160,68
v_exp_f32 v32, v32
mav 40,164,84
mav 40,168,100
v_exp_f32 v33, v33
mav 40,172,116
rda 40,6,10240
v_cvt_pk_bf16_f32 v56, v32, v33
mav0 44,188,116
v_exp_f32 v34, v34
mav 44,184,100
v_mov_b64 v[32:33], 0
mav 44,180,84
v_exp_f32 v35, v35
mav 44,176,68
rda 44,6,11264
v_cvt_pk_bf16_f32 v57, v34, v35
v_smfmac_f32_16x16x64_bf16 v[32:35], v[24:27], v[48:55], v11
mav 128,192,48
v_exp_f32 v36, v36
mav 128,196,52
mav 132,204,52
v_exp_f32 v37, v37
mav 132,200,48
rda 48,6,12288
v_cvt_pk_bf16_f32 v58, v36, v37
mav 136,208,48
v_exp_f32 v38, v38
mav 136,212,52
mav 140,220,52
v_exp_f32 v39, v39
mav 140,216,48
rda 52,6,13312
v_cvt_pk_bf16_f32 v59, v38, v39
mav 144,224,48
v_exp_f32 v40, v40
mav 144,228,52
v_add_f32 v20, v20, v32
mav 148,236,52
v_exp_f32 v41, v41
mav 148,232,48
rda 56,6,14336
v_cvt_pk_bf16_f32 v60, v40, v41
mav 152,240,48
v_exp_f32 v42, v42
mav 152,244,52
v_add_f32 v20, v20, v33
mav 156,252,52
v_exp_f32 v43, v43
mav 156,248,48
rda 60,6,15360
v_cvt_pk_bf16_f32 v61, v42, v43
mav0 32,128,72
v_exp_f32 v44, v44
mav 32,132,88
mav 32,136,104
v_exp_f32 v45, v45
mav 32,140,120
rda 64,6,16384
v_cvt_pk_bf16_f32 v62, v44, v45
mav0 36,156,120
v_exp_f32 v46, v46
mav 36,152,104
buffer_store_dwordx2 v[16:17], v29, s[48:51], 0 offen offset:256 sc1
mav 36,148,88
v_exp_f32 v47, v47
mav 36,144,72
rda 68,6,17408
v_cvt_pk_bf16_f32 v63, v46, v47
mav0 40,160,72
v_exp_f32 v32, v32
mav 40,164,88
mav 40,168,104
v_exp_f32 v33, v33
mav 40,172,120
rda 72,6,18432
v_cvt_pk_bf16_f32 v48, v32, v33
mav0 44,188,120
v_exp_f32 v34, v34
mav 44,184,104
v_mov_b64 v[32:33], 0
mav 44,180,88
v_exp_f32 v35, v35
mav 44,176,72
rda 76,6,19456
v_cvt_pk_bf16_f32 v49, v34, v35
v_smfmac_f32_16x16x64_bf16 v[32:35], v[24:27], v[56:63], v11
mav 160,192,56
v_exp_f32 v36, v36
mav 160,196,60
mav 164,204,60
v_exp_f32 v37, v37
mav 164,200,56
rda 80,6,20480
v_cvt_pk_bf16_f32 v50, v36, v37
mav 168,208,56
v_exp_f32 v38, v38
mav 168,212,60
mav 172,220,60
v_exp_f32 v39, v39
mav 172,216,56
rda 84,6,21504
v_cvt_pk_bf16_f32 v51, v38, v39
mav 176,224,56
v_exp_f32 v40, v40
mav 176,228,60
v_add_f32 v21, v21, v32
mav 180,236,60
v_exp_f32 v41, v41
mav 180,232,56
rda 88,6,22528
v_cvt_pk_bf16_f32 v52, v40, v41
mav 184,240,56
v_exp_f32 v42, v42
mav 184,244,60
v_add_f32 v21, v21, v33
mav 188,252,60
v_exp_f32 v43, v43
mav 188,248,56
rda 92,6,23552
v_cvt_pk_bf16_f32 v53, v42, v43
mav0 32,128,76
v_exp_f32 v44, v44
mav 32,132,92
rda 96,6,24576
mav 32,136,108
v_exp_f32 v45, v45
mav 32,140,124
rda 100,6,25600
v_cvt_pk_bf16_f32 v54, v44, v45
mav0 36,156,124
s_add_u32 s81, s81, 1
v_exp_f32 v46, v46
mav 36,152,108
mav 36,148,92
s_cmp_lt_u32 s81, s83
v_exp_f32 v47, v47
mav 36,144,76
rda 104,6,26624
v_cvt_pk_bf16_f32 v55, v46, v47
mav0 40,160,76
v_exp_f32 v32, v32
mav 40,164,92
mav 40,168,108
v_exp_f32 v33, v33
mav 40,172,124
rda 108,6,27648
v_cvt_pk_bf16_f32 v56, v32, v33
mav0 44,188,124
v_exp_f32 v34, v34
mav 44,184,108
v_mov_b64 v[32:33], 0
mav 44,180,92
v_exp_f32 v35, v35
mav 44,176,76
rda 112,6,28672
v_cvt_pk_bf16_f32 v57, v34, v35
v_smfmac_f32_16x16x64_bf16 v[32:35], v[24:27], v[48:55], v11
mav 192,192,48
v_exp_f32 v36, v36
mav 192,196,52
mav 196,204,52
v_exp_f32 v37, v37
mav 196,200,48
rda 116,6,29696
v_cvt_pk_bf16_f32 v58, v36, v37
mav 200,208,48
v_exp_f32 v38, v38
mav 200,212,52
mav 204,220,52
v_exp_f32 v39, v39
mav 204,216,48
rda 120,6,30720
v_cvt_pk_bf16_f32 v59, v38, v39
mav 208,224,48
s_waitcnt lgkmcnt(7)
v_exp_f32 v40, v40
mav 208,228,52
v_add_f32 v22, v22, v32
mav 212,236,52
v_exp_f32 v41, v41
mav 212,232,48
rda 124,6,31744
v_cvt_pk_bf16_f32 v60, v40, v41
mav 216,240,48
v_exp_f32 v42, v42
mav 216,244,52
v_add_f32 v22, v22, v33
mav 220,252,52
v_exp_f32 v43, v43
mav 220,248,48
v_cvt_pk_bf16_f32 v61, v42, v43
s_cbranch_scc1 L_c_e8
L_c_mid:
s_add_u32 s88, s48, s78
s_addc_u32 s89, s49, 0
s_cmp_lg_u32 s58, 2
s_cbranch_scc1 L_c_e16
s_branch L_c_dh
.p2align 6
L_stub10:
s_cbranch_execz L_walk_a2
s_nop 0
L_c_o16:
mav0 32,128,64
v_exp_f32 v44, v44
mav 32,132,80
mav 32,136,96
s_waitcnt vmcnt(0) lgkmcnt(0)
s_barrier
v_exp_f32 v45, v45
mav 32,140,112
rda 0,6,0
v_cvt_pk_bf16_f32 v62, v44, v45
mav0 36,156,112
s_add_u32 m0, s63, 65536
v_exp_f32 v46, v46
mav 36,152,96
global_load_lds_dwordx4 v1, s[88:89] offset:0 sc1
mav 36,148,80
s_add_u32 s90, s88, 4096
v_exp_f32 v47, v47
mav 36,144,64
rda 4,6,1024
v_cvt_pk_bf16_f32 v63, v46, v47
mav0 40,160,64
s_addc_u32 s91, s89, 0
v_exp_f32 v32, v32
mav 40,164,80
global_load_lds_dwordx4 v1, s[88:89] offset:1024 sc1
L_stub11:
s_cbranch_execz L_walk_a2
mav 40,168,96
v_exp_f32 v33, v33
mav 40,172,112
rda 8,6,2048
v_cvt_pk_bf16_f32 v48, v32, v33
mav0 44,188,112
v_exp_f32 v34, v34
mav 44,184,96
global_load_lds_dwordx4 v1, s[88:89] offset:2048 sc1
v_mov_b64 v[32:33], 0
mav 44,180,80
v_exp_f32 v35, v35
mav 44,176,64
rda 12,6,3072
v_cvt_pk_bf16_f32 v49, v34, v35
v_smfmac_f32_16x16x64_bf16 v[32:35], v[24:27], v[56:63], v11
mav 224,64,56
v_exp_f32 v36, v36
mav 224,68,60
global_load_lds_dwordx4 v1, s[88:89] offset:3072 sc1
mav 228,76,60
v_exp_f32 v37, v37
mav 228,72,56
rda 16,6,4096
v_cvt_pk_bf16_f32 v50, v36, v37
mav 232,80,56
s_add_u32 m0, s63, 69632
v_exp_f32 v38, v38
mav 232,84,60
global_load_lds_dwordx4 v1, s[90:91] offset:0 sc1
mav 236,92,60
s_add_u32 s88, s90, 4096
v_exp_f32 v39, v39
mav 236,88,56
rda 20,6,5120
v_cvt_pk_bf16_f32 v51, v38, v39
mav 240,96,56
s_addc_u32 s89, s91, 0
v_exp_f32 v40, v40
mav 240,100,60
global_load_lds_dwordx4 v1, s[90:91] offset:1024 sc1
v_add_f32 v23, v23, v32
mav 244,108,60
v_exp_f32 v41, v41
mav 244,104,56
rda 24,6,6144
v_cvt_pk_bf16_f32 v52, v40, v41
mav 248,112,56
v_exp_f32 v42, v42
mav 248,116,60
global_load_lds_dwordx4 v1, s[90:91] offset:2048 sc1
v_add_f32 v23, v23, v33
mav 252,124,60
v_exp_f32 v43, v43
mav 252,120,56
rda 28,6,7168
v_cvt_pk_bf16_f32 v53, v42, v43
mav0 32,128,68
v_exp_f32 v44, v44
mav 32,132,84
global_load_lds_dwordx4 v1, s[90:91] offset:3072 sc1
mav 32,136,100
v_exp_f32 v45, v45
mav 32,140,116
rda 32,6,8192
v_cvt_pk_bf16_f32 v54, v44, v45
mav0 36,156,116
s_add_u32 m0, s63, 73728
v_exp_f32 v46, v46
mav 36,152,100
global_load_lds_dwordx4 v1, s[88:89] offset:0 sc1
mav 36,148,84
s_add_u32 s90, s88, 4096
v_exp_f32 v47, v47
mav 36,144,68
rda 36,6,9216
v_cvt_pk_bf16_f32 v55, v46, v47
mav0 40,160,68
s_addc_u32 s91, s89, 0
v_exp_f32 v32, v32
mav 40,164,84
global_load_lds_dwordx4 v1, s[88:89] offset:1024 sc1
mav 40,168,100
v_exp_f32 v33, v33
mav 40,172,116
rda 40,6,10240
v_cvt_pk_bf16_f32 v56, v32, v33
mav0 44,188,116
v_exp_f32 v34, v34
mav 44,184,100
global_load_lds_dwordx4 v1, s[88:89] offset:2048 sc1
v_mov_b64 v[32:33], 0
mav 44,180,84
v_exp_f32 v35, v35
mav 44,176,68
rda 44,6,11264
v_cvt_pk_bf16_f32 v57, v34, v35
v_smfmac_f32_16x16x64_bf16 v[32:35], v[24:27], v[48:55], v11
mav 128,192,48
v_exp_f32 v36, v36
mav 128,196,52
global_load_lds_dwordx4 v1, s[88:89] offset:3072 sc1
mav 132,204,52
v_exp_f32 v37, v37
mav 132,200,48
rda 48,6,12288
v_cvt_pk_bf16_f32 v58, v36, v37
mav 136,208,48
s_add_u32 m0, s63, 77824
v_exp_f32 v38, v38
mav 136,212,52
global_load_lds_dwordx4 v1, s[90:91] offset:0 sc1
mav 140,220,52
s_add_u32 s88, s90, 53248
v_exp_f32 v39, v39
mav 140,216,48
rda 52,6,13312
v_cvt_pk_bf16_f32 v59, v38, v39
mav 144,224,48
s_addc_u32 s89, s91, 0
v_exp_f32 v40, v40
mav 144,228,52
global_load_lds_dwordx4 v1, s[90:91] offset:1024 sc1
v_add_f32 v20, v20, v32
mav 148,236,52
v_exp_f32 v41, v41
mav 148,232,48
rda 56,6,14336
v_cvt_pk_bf16_f32 v60, v40, v41
mav 152,240,48
v_exp_f32 v42, v42
mav 152,244,52
global_load_lds_dwordx4 v1, s[90:91] offset:2048 sc1
v_add_f32 v20, v20, v33
mav 156,252,52
v_exp_f32 v43, v43
mav 156,248,48
rda 60,6,15360
v_cvt_pk_bf16_f32 v61, v42, v43
mav0 32,128,72
v_exp_f32 v44, v44
mav 32,132,88
global_load_lds_dwordx4 v1, s[90:91] offset:3072 sc1
mav 32,136,104
v_exp_f32 v45, v45
mav 32,140,120
rda 64,6,16384
v_cvt_pk_bf16_f32 v62, v44, v45
mav0 36,156,120
v_exp_f32 v46, v46
mav 36,152,104
mav 36,148,88
v_exp_f32 v47, v47
mav 36,144,72
rda 68,6,17408
v_cvt_pk_bf16_f32 v63, v46, v47
mav0 40,160,72
v_exp_f32 v32, v32
mav 40,164,88
mav 40,168,104
v_exp_f32 v33, v33
mav 40,172,120
rda 72,6,18432
v_cvt_pk_bf16_f32 v48, v32, v33
mav0 44,188,120
v_exp_f32 v34, v34
mav 44,184,104
v_mov_b64 v[32:33], 0
mav 44,180,88
v_exp_f32 v35, v35
mav 44,176,72
rda 76,6,19456
v_cvt_pk_bf16_f32 v49, v34, v35
v_smfmac_f32_16x16x64_bf16 v[32:35], v[24:27], v[56:63], v11
mav 160,192,56
v_exp_f32 v36, v36
mav 160,196,60
mav 164,204,60
v_exp_f32 v37, v37
mav 164,200,56
rda 80,6,20480
v_cvt_pk_bf16_f32 v50, v36, v37
mav 168,208,56
v_exp_f32 v38, v38
mav 168,212,60
mav 172,220,60
v_exp_f32 v39, v39
mav 172,216,56
rda 84,6,21504
v_cvt_pk_bf16_f32 v51, v38, v39
mav 176,224,56
v_exp_f32 v40, v40
mav 176,228,60
v_add_f32 v21, v21, v32
mav 180,236,60
v_exp_f32 v41, v41
mav 180,232,56
rda 88,6,22528
v_cvt_pk_bf16_f32 v52, v40, v41
mav 184,240,56
v_exp_f32 v42, v42
mav 184,244,60
v_add_f32 v21, v21, v33
mav 188,252,60
v_exp_f32 v43, v43
mav 188,248,56
rda 92,6,23552
v_cvt_pk_bf16_f32 v53, v42, v43
mav0 32,128,76
v_exp_f32 v44, v44
mav 32,132,92
rda 96,6,24576
mav 32,136,108
v_exp_f32 v45, v45
mav 32,140,124
rda 100,6,25600
v_cvt_pk_bf16_f32 v54, v44, v45
mav0 36,156,124
s_add_u32 s81, s81, 1
v_exp_f32 v46, v46
mav 36,152,108
mav 36,148,92
s_cmp_eq_u32 s81, s82
v_exp_f32 v47, v47
mav 36,144,76
rda 104,6,26624
v_cvt_pk_bf16_f32 v55, v46, v47
mav0 40,160,76
v_exp_f32 v32, v32
mav 40,164,92
mav 40,168,108
v_exp_f32 v33, v33
mav 40,172,124
rda 108,6,27648
v_cvt_pk_bf16_f32 v56, v32, v33
mav0 44,188,124
v_exp_f32 v34, v34
mav 44,184,108
v_mov_b64 v[32:33], 0
mav 44,180,92
v_exp_f32 v35, v35
mav 44,176,76
rda 112,6,28672
v_cvt_pk_bf16_f32 v57, v34, v35
v_smfmac_f32_16x16x64_bf16 v[32:35], v[24:27], v[48:55], v11
mav 192,192,48
v_exp_f32 v36, v36
mav 192,196,52
mav 196,204,52
v_exp_f32 v37, v37
mav 196,200,48
rda 116,6,29696
v_cvt_pk_bf16_f32 v58, v36, v37
mav 200,208,48
v_exp_f32 v38, v38
mav 200,212,52
mav 204,220,52
v_exp_f32 v39, v39
mav 204,216,48
rda 120,6,30720
v_cvt_pk_bf16_f32 v59, v38, v39
mav 208,224,48
s_waitcnt lgkmcnt(7)
v_exp_f32 v40, v40
mav 208,228,52
v_add_f32 v22, v22, v32
mav 212,236,52
v_exp_f32 v41, v41
mav 212,232,48
rda 124,6,31744
v_cvt_pk_bf16_f32 v60, v40, v41
mav 216,240,48
v_exp_f32 v42, v42
mav 216,244,52
v_add_f32 v22, v22, v33
mav 220,252,52
v_exp_f32 v43, v43
mav 220,248,48
v_cvt_pk_bf16_f32 v61, v42, v43
s_cbranch_scc1 L_c_de
L_c_e16:
L_stub12:
s_cbranch_execz L_walk_a3
mav0 32,0,64
v_exp_f32 v44, v44
mav 32,4,80
mav 32,8,96
s_waitcnt vmcnt(0) lgkmcnt(0)
s_barrier
v_exp_f32 v45, v45
mav 32,12,112
rda 128,7,0
v_cvt_pk_bf16_f32 v62, v44, v45
mav0 36,28,112
s_add_u32 m0, s63, 0
v_exp_f32 v46, v46
mav 36,24,96
global_load_lds_dwordx4 v1, s[88:89] offset:0 sc1
mav 36,20,80
s_add_u32 s90, s88, 4096
v_exp_f32 v47, v47
mav 36,16,64
rda 132,7,1024
v_cvt_pk_bf16_f32 v63, v46, v47
mav0 40,32,64
s_addc_u32 s91, s89, 0
v_exp_f32 v32, v32
mav 40,36,80
global_load_lds_dwordx4 v1, s[88:89] offset:1024 sc1
mav 40,40,96
v_exp_f32 v33, v33
mav 40,44,112
rda 136,7,2048
v_cvt_pk_bf16_f32 v48, v32, v33
mav0 44,60,112
v_exp_f32 v34, v34
mav 44,56,96
global_load_lds_dwordx4 v1, s[88:89] offset:2048 sc1
v_mov_b64 v[32:33], 0
mav 44,52,80
v_exp_f32 v35, v35
mav 44,48,64
rda 140,7,3072
v_cvt_pk_bf16_f32 v49, v34, v35
v_smfmac_f32_16x16x64_bf16 v[32:35], v[24:27], v[56:63], v11
mav 224,192,56
v_exp_f32 v36, v36
mav 224,196,60
global_load_lds_dwordx4 v1, s[88:89] offset:3072 sc1
mav 228,204,60
v_exp_f32 v37, v37
mav 228,200,56
rda 144,7,4096
v_cvt_pk_bf16_f32 v50, v36, v37
mav 232,208,56
s_add_u32 m0, s63, 4096
v_exp_f32 v38, v38
mav 232,212,60
global_load_lds_dwordx4 v1, s[90:91] offset:0 sc1
mav 236,220,60
s_add_u32 s88, s90, 4096
v_exp_f32 v39, v39
mav 236,216,56
rda 148,7,5120
v_cvt_pk_bf16_f32 v51, v38, v39
mav 240,224,56
s_addc_u32 s89, s91, 0
v_exp_f32 v40, v40
mav 240,228,60
global_load_lds_dwordx4 v1, s[90:91] offset:1024 sc1
v_add_f32 v23, v23, v32
mav 244,236,60
v_exp_f32 v41, v41
mav 244,232,56
rda 152,7,6144
v_cvt_pk_bf16_f32 v52, v40, v41
mav 248,240,56
v_exp_f32 v42, v42
mav 248,244,60
global_load_lds_dwordx4 v1, s[90:91] offset:2048 sc1
v_add_f32 v23, v23, v33
mav 252,252,60
v_exp_f32 v43, v43
mav 252,248,56
rda 156,7,7168
v_cvt_pk_bf16_f32 v53, v42, v43
mav0 32,0,68
v_exp_f32 v44, v44
mav 32,4,84
global_load_lds_dwordx4 v1, s[90:91] offset:3072 sc1
mav 32,8,100
v_exp_f32 v45, v45
mav 32,12,116
rda 160,7,8192
v_cvt_pk_bf16_f32 v54, v44, v45
mav0 36,28,116
s_add_u32 m0, s63, 8192
v_exp_f32 v46, v46
mav 36,24,100
global_load_lds_dwordx4 v1, s[88:89] offset:0 sc1
mav 36,20,84
s_add_u32 s90, s88, 4096
v_exp_f32 v47, v47
mav 36,16,68
rda 164,7,9216
v_cvt_pk_bf16_f32 v55, v46, v47
mav0 40,32,68
s_addc_u32 s91, s89, 0
v_exp_f32 v32, v32
mav 40,36,84
global_load_lds_dwordx4 v1, s[88:89] offset:1024 sc1
mav 40,40,100
v_exp_f32 v33, v33
mav 40,44,116
rda 168,7,10240
v_cvt_pk_bf16_f32 v56, v32, v33
mav0 44,60,116
v_exp_f32 v34, v34
mav 44,56,100
global_load_lds_dwordx4 v1, s[88:89] offset:2048 sc1
v_mov_b64 v[32:33], 0
mav 44,52,84
v_exp_f32 v35, v35
mav 44,48,68
rda 172,7,11264
v_cvt_pk_bf16_f32 v57, v34, v35
v_smfmac_f32_16x16x64_bf16 v[32:35], v[24:27], v[48:55], v11
mav 128,64,48
v_exp_f32 v36, v36
mav 128,68,52
global_load_lds_dwordx4 v1, s[88:89] offset:3072 sc1
mav 132,76,52
v_exp_f32 v37, v37
mav 132,72,48
rda 176,7,12288
v_cvt_pk_bf16_f32 v58, v36, v37
mav 136,80,48
s_add_u32 m0, s63, 12288
v_exp_f32 v38, v38
mav 136,84,52
global_load_lds_dwordx4 v1, s[90:91] offset:0 sc1
mav 140,92,52
s_add_u32 s88, s90, 53248
v_exp_f32 v39, v39
mav 140,88,48
rda 180,7,13312
v_cvt_pk_bf16_f32 v59, v38, v39
mav 144,96,48
s_addc_u32 s89, s91, 0
v_exp_f32 v40, v40
mav 144,100,52
global_load_lds_dwordx4 v1, s[90:91] offset:1024 sc1
v_add_f32 v20, v20, v32
mav 148,108,52
v_exp_f32 v41, v41
mav 148,104,48
rda 184,7,14336
v_cvt_pk_bf16_f32 v60, v40, v41
mav 152,112,48
v_exp_f32 v42, v42
mav 152,116,52
global_load_lds_dwordx4 v1, s[90:91] offset:2048 sc1
v_add_f32 v20, v20, v33
mav 156,124,52
v_exp_f32 v43, v43
mav 156,120,48
rda 188,7,15360
v_cvt_pk_bf16_f32 v61, v42, v43
mav0 32,0,72
v_exp_f32 v44, v44
mav 32,4,88
global_load_lds_dwordx4 v1, s[90:91] offset:3072 sc1
mav 32,8,104
v_exp_f32 v45, v45
mav 32,12,120
rda 192,7,16384
v_cvt_pk_bf16_f32 v62, v44, v45
mav0 36,28,120
v_exp_f32 v46, v46
mav 36,24,104
mav 36,20,88
v_exp_f32 v47, v47
mav 36,16,72
rda 196,7,17408
v_cvt_pk_bf16_f32 v63, v46, v47
mav0 40,32,72
v_exp_f32 v32, v32
mav 40,36,88
mav 40,40,104
v_exp_f32 v33, v33
mav 40,44,120
rda 200,7,18432
v_cvt_pk_bf16_f32 v48, v32, v33
mav0 44,60,120
v_exp_f32 v34, v34
mav 44,56,104
v_mov_b64 v[32:33], 0
mav 44,52,88
v_exp_f32 v35, v35
mav 44,48,72
rda 204,7,19456
v_cvt_pk_bf16_f32 v49, v34, v35
v_smfmac_f32_16x16x64_bf16 v[32:35], v[24:27], v[56:63], v11
mav 160,64,56
v_exp_f32 v36, v36
mav 160,68,60
mav 164,76,60
v_exp_f32 v37, v37
mav 164,72,56
rda 208,7,20480
v_cvt_pk_bf16_f32 v50, v36, v37
mav 168,80,56
v_exp_f32 v38, v38
mav 168,84,60
mav 172,92,60
v_exp_f32 v39, v39
mav 172,88,56
rda 212,7,21504
v_cvt_pk_bf16_f32 v51, v38, v39
mav 176,96,56
v_exp_f32 v40, v40
mav 176,100,60
v_add_f32 v21, v21, v32
mav 180,108,60
v_exp_f32 v41, v41
mav 180,104,56
rda 216,7,22528
v_cvt_pk_bf16_f32 v52, v40, v41
mav 184,112,56
v_exp_f32 v42, v42
mav 184,116,60
v_add_f32 v21, v21, v33
mav 188,124,60
v_exp_f32 v43, v43
mav 188,120,56
rda 220,7,23552
v_cvt_pk_bf16_f32 v53, v42, v43
mav0 32,0,76
v_exp_f32 v44, v44
mav 32,4,92
rda 224,7,24576
mav 32,8,108
v_exp_f32 v45, v45
mav 32,12,124
rda 228,7,25600
v_cvt_pk_bf16_f32 v54, v44, v45
mav0 36,28,124
s_add_u32 s81, s81, 1
v_exp_f32 v46, v46
mav 36,24,108
mav 36,20,92
s_cmp_lg_u32 s81, s61
v_exp_f32 v47, v47
mav 36,16,76
rda 232,7,26624
v_cvt_pk_bf16_f32 v55, v46, v47
mav0 40,32,76
v_exp_f32 v32, v32
mav 40,36,92
mav 40,40,108
v_exp_f32 v33, v33
mav 40,44,124
rda 236,7,27648
v_cvt_pk_bf16_f32 v56, v32, v33
mav0 44,60,124
v_exp_f32 v34, v34
mav 44,56,108
v_mov_b64 v[32:33], 0
mav 44,52,92
v_exp_f32 v35, v35
mav 44,48,76
rda 240,7,28672
v_cvt_pk_bf16_f32 v57, v34, v35
v_smfmac_f32_16x16x64_bf16 v[32:35], v[24:27], v[48:55], v11
mav 192,64,48
v_exp_f32 v36, v36
mav 192,68,52
mav 196,76,52
v_exp_f32 v37, v37
mav 196,72,48
rda 244,7,29696
v_cvt_pk_bf16_f32 v58, v36, v37
mav 200,80,48
v_exp_f32 v38, v38
mav 200,84,52
mav 204,92,52
v_exp_f32 v39, v39
mav 204,88,48
rda 248,7,30720
v_cvt_pk_bf16_f32 v59, v38, v39
mav 208,96,48
s_waitcnt lgkmcnt(7)
v_exp_f32 v40, v40
mav 208,100,52
v_add_f32 v22, v22, v32
mav 212,108,52
v_exp_f32 v41, v41
mav 212,104,48
rda 252,7,31744
v_cvt_pk_bf16_f32 v60, v40, v41
mav 216,112,48
v_exp_f32 v42, v42
mav 216,116,52
v_add_f32 v22, v22, v33
mav 220,124,52
v_exp_f32 v43, v43
mav 220,120,48
v_cvt_pk_bf16_f32 v61, v42, v43
s_cbranch_scc1 L_c_o16
s_cmp_lg_u32 s75, 0
s_cbranch_scc1 L_c_o0
v_subrev_u32 v6, s71, v6
v_subrev_u32 v7, s71, v7
s_add_u32 s88, s48, s79
s_addc_u32 s89, s49, 0
s_mov_b32 s61, 15
s_mov_b32 s75, 1
s_cmp_eq_u32 s58, 3
s_cbranch_scc1 L_c_do
s_cmp_eq_u32 s57, 7
s_cbranch_scc0 L_c_o16
s_branch L_c_o0
L_c_do:
v_mfma_f32_16x16x32_bf16 v[32:35], a[128:131], v[64:67], v[12:15]
L_stub13:
s_cbranch_execz L_walk_a3
v_exp_f32 v44, v44
mav 32,132,80
mav 32,136,96
s_waitcnt vmcnt(0) lgkmcnt(0)
s_barrier
v_exp_f32 v45, v45
mav 32,140,112
v_cvt_pk_bf16_f32 v62, v44, v45
s_add_u32 m0, s63, 65536
v_exp_f32 v46, v46
global_load_lds_dwordx4 v1, s[88:89] offset:0 sc1
s_add_u32 s90, s88, 4096
v_exp_f32 v47, v47
s_nop 0
v_cvt_pk_bf16_f32 v63, v46, v47
s_addc_u32 s91, s89, 0
v_exp_f32 v32, v32
global_load_lds_dwordx4 v1, s[88:89] offset:1024 sc1
v_exp_f32 v33, v33
s_nop 0
v_cvt_pk_bf16_f32 v48, v32, v33
v_exp_f32 v34, v34
global_load_lds_dwordx4 v1, s[88:89] offset:2048 sc1
v_mov_b64 v[32:33], 0
v_exp_f32 v35, v35
s_nop 0
v_cvt_pk_bf16_f32 v49, v34, v35
v_smfmac_f32_16x16x64_bf16 v[32:35], v[24:27], v[56:63], v11
mav 224,64,56
mav 224,68,60
global_load_lds_dwordx4 v1, s[88:89] offset:3072 sc1
mav 228,76,60
mav 228,72,56
v_mov_b32 v50, 0
mav 232,80,56
s_add_u32 m0, s63, 69632
mav 232,84,60
global_load_lds_dwordx4 v1, s[90:91] offset:0 sc1
mav 236,92,60
s_add_u32 s88, s90, 4096
mav 236,88,56
v_mov_b32 v51, 0
mav 240,96,56
s_addc_u32 s89, s91, 0
mav 240,100,60
global_load_lds_dwordx4 v1, s[90:91] offset:1024 sc1
v_add_f32 v23, v23, v32
mav 244,108,60
mav 244,104,56
mav 248,112,56
mav 248,116,60
global_load_lds_dwordx4 v1, s[90:91] offset:2048 sc1
v_add_f32 v23, v23, v33
mav 252,124,60
mav 252,120,56
mav0 32,128,68
mav 32,132,84
global_load_lds_dwordx4 v1, s[90:91] offset:3072 sc1
mav 32,136,100
mav 32,140,116
v_mfma_f32_16x16x32_bf16 v[36:39], a[156:159], v[116:119], v[12:15]
s_add_u32 m0, s63, 73728
mav 36,152,100
global_load_lds_dwordx4 v1, s[88:89] offset:0 sc1
mav 36,148,84
s_add_u32 s90, s88, 4096
mav 36,144,68
s_addc_u32 s91, s89, 0
v_exp_f32 v32, v32
global_load_lds_dwordx4 v1, s[88:89] offset:1024 sc1
v_exp_f32 v33, v33
s_nop 0
v_cvt_pk_bf16_f32 v56, v32, v33
v_exp_f32 v34, v34
global_load_lds_dwordx4 v1, s[88:89] offset:2048 sc1
v_exp_f32 v35, v35
s_nop 0
v_cvt_pk_bf16_f32 v57, v34, v35
mvv0 32,24,48
mav 128,192,48
v_exp_f32 v36, v36
global_load_lds_dwordx4 v1, s[88:89] offset:3072 sc1
v_exp_f32 v37, v37
mav 132,200,48
v_cvt_pk_bf16_f32 v58, v36, v37
mav 136,208,48
s_add_u32 m0, s63, 77824
v_exp_f32 v38, v38
global_load_lds_dwordx4 v1, s[90:91] offset:0 sc1
v_add_f32 v20, v20, v32
s_add_u32 s88, s90, 53248
v_exp_f32 v39, v39
mav 140,216,48
v_cvt_pk_bf16_f32 v59, v38, v39
mav 144,224,48
s_addc_u32 s89, s91, 0
global_load_lds_dwordx4 v1, s[90:91] offset:1024 sc1
mav 148,232,48
mav 152,240,48
global_load_lds_dwordx4 v1, s[90:91] offset:2048 sc1
mav 156,248,48
mav0 32,128,72
mav 32,132,88
global_load_lds_dwordx4 v1, s[90:91] offset:3072 sc1
mav 32,136,104
mav 32,140,120
mav0 36,156,120
mav 36,152,104
mav 36,148,88
mav 36,144,72
v_mfma_f32_16x16x32_bf16 v[40:43], a[160:163], v[72:75], v[12:15]
s_nop 2
v_exp_f32 v32, v32
mav 40,164,88
mav 40,168,104
v_exp_f32 v33, v33
mav 40,172,120
v_cvt_pk_bf16_f32 v48, v32, v33
v_exp_f32 v34, v34
v_exp_f32 v35, v35
s_nop 0
v_cvt_pk_bf16_f32 v49, v34, v35
mvv0 32,24,56
mav 160,192,56
v_exp_f32 v36, v36
v_exp_f32 v37, v37
mav 164,200,56
v_cvt_pk_bf16_f32 v50, v36, v37
mav 168,208,56
v_exp_f32 v38, v38
s_nop 0
v_add_f32 v21, v21, v32
v_exp_f32 v39, v39
mav 172,216,56
v_cvt_pk_bf16_f32 v51, v38, v39
mav 176,224,56
v_exp_f32 v40, v40
v_exp_f32 v41, v41
mav 180,232,56
v_cvt_pk_bf16_f32 v52, v40, v41
mav 184,240,56
v_exp_f32 v42, v42
v_exp_f32 v43, v43
mav 188,248,56
v_cvt_pk_bf16_f32 v53, v42, v43
mav0 32,128,76
mav 32,132,92
mav 32,136,108
mav 32,140,124
v_mov_b32 v54, 0
mav0 36,156,124
s_add_u32 s81, s81, 1
mav 36,152,108
mav 36,148,92
mav 36,144,76
v_mov_b32 v55, 0
mav0 40,160,76
v_exp_f32 v32, v32
mav 40,164,92
mav 40,168,108
v_exp_f32 v33, v33
mav 40,172,124
v_cvt_pk_bf16_f32 v56, v32, v33
v_mfma_f32_16x16x32_bf16 v[44:47], a[188:191], v[124:127], v[12:15]
v_exp_f32 v34, v34
mav 44,184,108
v_mov_b64 v[32:33], 0
mav 44,180,92
v_exp_f32 v35, v35
mav 44,176,76
v_cvt_pk_bf16_f32 v57, v34, v35
v_smfmac_f32_16x16x64_bf16 v[32:35], v[24:27], v[48:55], v11
mav 192,192,48
v_exp_f32 v36, v36
mav 192,196,52
mav 196,204,52
v_exp_f32 v37, v37
mav 196,200,48
v_cvt_pk_bf16_f32 v58, v36, v37
mav 200,208,48
v_exp_f32 v38, v38
mav 200,212,52
mav 204,220,52
v_exp_f32 v39, v39
mav 204,216,48
v_cvt_pk_bf16_f32 v59, v38, v39
mav 208,224,48
v_exp_f32 v40, v40
mav 208,228,52
v_add_f32 v22, v22, v32
mav 212,236,52
v_exp_f32 v41, v41
mav 212,232,48
v_cvt_pk_bf16_f32 v60, v40, v41
mav 216,240,48
v_exp_f32 v42, v42
mav 216,244,52
v_add_f32 v22, v22, v33
mav 220,252,52
v_exp_f32 v43, v43
mav 220,248,48
v_cvt_pk_bf16_f32 v61, v42, v43
v_exp_f32 v44, v44
v_exp_f32 v45, v45
v_exp_f32 v46, v46
v_exp_f32 v47, v47
v_mov_b64 v[32:33], 0
v_cvt_pk_bf16_f32 v62, v44, v45
v_cvt_pk_bf16_f32 v63, v46, v47
s_nop 1
v_smfmac_f32_16x16x64_bf16 v[32:35], v[24:27], v[56:63], v11
mav 224,192,56
s_nop 2
mav 224,196,60
s_nop 2
mav 228,204,60
s_nop 2
mav 228,200,56
v_add_f32 v23, v23, v32
v_add_f32 v23, v23, v33
mav 232,208,56
s_mov_b32 s65, 0x1f800000
v_mov_b32 v42, 0x5f800000
v_med3_f32 v38, v20, s65, v42
mav 232,212,60
v_med3_f32 v39, v21, s65, v42
v_med3_f32 v40, v22, s65, v42
mav 236,220,60
v_med3_f32 v41, v23, s65, v42
v_cmp_neq_f32 vcc, v38, v20
mav 236,216,56
v_cmp_neq_f32 s[94:95], v39, v21
v_cmp_neq_f32 s[92:93], v40, v22
mav 240,224,56
v_cmp_neq_f32 s[98:99], v41, v23
mav 240,228,60
mav 244,236,60
mav 244,232,56
mav 248,240,56
mav 248,244,60
mav 252,252,60
mav 252,248,56
s_or_b64 vcc, vcc, s[92:93]
s_or_b64 vcc, vcc, s[98:99]
s_or_b64 vcc, vcc, s[94:95]
s_cbranch_scc1 L_idle0_redo
L_idle0_ok:
v_rcp_f32 v20, v20
v_rcp_f32 v21, v21
v_rcp_f32 v22, v22
v_rcp_f32 v23, v23
s_waitcnt vmcnt(0) lgkmcnt(0)
s_barrier
s_cmp_eq_u32 s57, 7
s_cbranch_scc1 L_c_ie0
s_add_u32 s65, s64, 0
v_pk_mul_f32 v[128:129], v[128:129], v[20:21] op_sel:[0,0] op_sel_hi:[1,0]
v_pk_mul_f32 v[130:131], v[130:131], v[20:21] op_sel:[0,0] op_sel_hi:[1,0]
v_pk_mul_f32 v[132:133], v[132:133], v[20:21] op_sel:[0,0] op_sel_hi:[1,0]
v_pk_mul_f32 v[134:135], v[134:135], v[20:21] op_sel:[0,0] op_sel_hi:[1,0]
v_cvt_pk_bf16_f32 v128, v128, v129
v_cvt_pk_bf16_f32 v129, v130, v131
v_cvt_pk_bf16_f32 v130, v132, v133
v_cvt_pk_bf16_f32 v131, v134, v135
buffer_store_dwordx4 v[128:131], v1, s[48:51], s65 offen offset:0 sc1
s_add_u32 s65, s64, 4096
v_pk_mul_f32 v[136:137], v[136:137], v[20:21] op_sel:[0,0] op_sel_hi:[1,0]
v_pk_mul_f32 v[138:139], v[138:139], v[20:21] op_sel:[0,0] op_sel_hi:[1,0]
v_pk_mul_f32 v[140:141], v[140:141], v[20:21] op_sel:[0,0] op_sel_hi:[1,0]
v_pk_mul_f32 v[142:143], v[142:143], v[20:21] op_sel:[0,0] op_sel_hi:[1,0]
v_cvt_pk_bf16_f32 v136, v136, v137
v_cvt_pk_bf16_f32 v137, v138, v139
v_cvt_pk_bf16_f32 v138, v140, v141
v_cvt_pk_bf16_f32 v139, v142, v143
buffer_store_dwordx4 v[136:139], v1, s[48:51], s65 offen offset:0 sc1
s_add_u32 s65, s64, 8192
v_pk_mul_f32 v[144:145], v[144:145], v[20:21] op_sel:[0,0] op_sel_hi:[1,0]
v_pk_mul_f32 v[146:147], v[146:147], v[20:21] op_sel:[0,0] op_sel_hi:[1,0]
v_pk_mul_f32 v[148:149], v[148:149], v[20:21] op_sel:[0,0] op_sel_hi:[1,0]
v_pk_mul_f32 v[150:151], v[150:151], v[20:21] op_sel:[0,0] op_sel_hi:[1,0]
v_cvt_pk_bf16_f32 v144, v144, v145
v_cvt_pk_bf16_f32 v145, v146, v147
v_cvt_pk_bf16_f32 v146, v148, v149
v_cvt_pk_bf16_f32 v147, v150, v151
buffer_store_dwordx4 v[144:147], v1, s[48:51], s65 offen offset:0 sc1
s_add_u32 s65, s64, 12288
v_pk_mul_f32 v[152:153], v[152:153], v[20:21] op_sel:[0,0] op_sel_hi:[1,0]
v_pk_mul_f32 v[154:155], v[154:155], v[20:21] op_sel:[0,0] op_sel_hi:[1,0]
v_pk_mul_f32 v[156:157], v[156:157], v[20:21] op_sel:[0,0] op_sel_hi:[1,0]
v_pk_mul_f32 v[158:159], v[158:159], v[20:21] op_sel:[0,0] op_sel_hi:[1,0]
v_cvt_pk_bf16_f32 v152, v152, v153
v_cvt_pk_bf16_f32 v153, v154, v155
v_cvt_pk_bf16_f32 v154, v156, v157
v_cvt_pk_bf16_f32 v155, v158, v159
buffer_store_dwordx4 v[152:155], v1, s[48:51], s65 offen offset:0 sc1
s_add_u32 s65, s64, 0
v_pk_mul_f32 v[160:161], v[160:161], v[20:21] op_sel:[0,1] op_sel_hi:[1,1]
v_pk_mul_f32 v[162:163], v[162:163], v[20:21] op_sel:[0,1] op_sel_hi:[1,1]
v_pk_mul_f32 v[164:165], v[164:165], v[20:21] op_sel:[0,1] op_sel_hi:[1,1]
v_pk_mul_f32 v[166:167], v[166:167], v[20:21] op_sel:[0,1] op_sel_hi:[1,1]
v_cvt_pk_bf16_f32 v160, v160, v161
v_cvt_pk_bf16_f32 v161, v162, v163
v_cvt_pk_bf16_f32 v162, v164, v165
v_cvt_pk_bf16_f32 v163, v166, v167
buffer_store_dwordx4 v[160:163], v1, s[48:51], s65 offen offset:1024 sc1
s_add_u32 s65, s64, 4096
v_pk_mul_f32 v[168:169], v[168:169], v[20:21] op_sel:[0,1] op_sel_hi:[1,1]
v_pk_mul_f32 v[170:171], v[170:171], v[20:21] op_sel:[0,1] op_sel_hi:[1,1]
v_pk_mul_f32 v[172:173], v[172:173], v[20:21] op_sel:[0,1] op_sel_hi:[1,1]
v_pk_mul_f32 v[174:175], v[174:175], v[20:21] op_sel:[0,1] op_sel_hi:[1,1]
v_cvt_pk_bf16_f32 v168, v168, v169
v_cvt_pk_bf16_f32 v169, v170, v171
v_cvt_pk_bf16_f32 v170, v172, v173
v_cvt_pk_bf16_f32 v171, v174, v175
buffer_store_dwordx4 v[168:171], v1, s[48:51], s65 offen offset:1024 sc1
s_add_u32 s65, s64, 8192
v_pk_mul_f32 v[176:177], v[176:177], v[20:21] op_sel:[0,1] op_sel_hi:[1,1]
v_pk_mul_f32 v[178:179], v[178:179], v[20:21] op_sel:[0,1] op_sel_hi:[1,1]
v_pk_mul_f32 v[180:181], v[180:181], v[20:21] op_sel:[0,1] op_sel_hi:[1,1]
v_pk_mul_f32 v[182:183], v[182:183], v[20:21] op_sel:[0,1] op_sel_hi:[1,1]
v_cvt_pk_bf16_f32 v176, v176, v177
v_cvt_pk_bf16_f32 v177, v178, v179
v_cvt_pk_bf16_f32 v178, v180, v181
v_cvt_pk_bf16_f32 v179, v182, v183
buffer_store_dwordx4 v[176:179], v1, s[48:51], s65 offen offset:1024 sc1
s_add_u32 s65, s64, 12288
v_pk_mul_f32 v[184:185], v[184:185], v[20:21] op_sel:[0,1] op_sel_hi:[1,1]
v_pk_mul_f32 v[186:187], v[186:187], v[20:21] op_sel:[0,1] op_sel_hi:[1,1]
v_pk_mul_f32 v[188:189], v[188:189], v[20:21] op_sel:[0,1] op_sel_hi:[1,1]
v_pk_mul_f32 v[190:191], v[190:191], v[20:21] op_sel:[0,1] op_sel_hi:[1,1]
v_cvt_pk_bf16_f32 v184, v184, v185
v_cvt_pk_bf16_f32 v185, v186, v187
v_cvt_pk_bf16_f32 v186, v188, v189
v_cvt_pk_bf16_f32 v187, v190, v191
buffer_store_dwordx4 v[184:187], v1, s[48:51], s65 offen offset:1024 sc1
s_add_u32 s65, s64, 0
v_pk_mul_f32 v[192:193], v[192:193], v[22:23] op_sel:[0,0] op_sel_hi:[1,0]
v_pk_mul_f32 v[194:195], v[194:195], v[22:23] op_sel:[0,0] op_sel_hi:[1,0]
v_pk_mul_f32 v[196:197], v[196:197], v[22:23] op_sel:[0,0] op_sel_hi:[1,0]
v_pk_mul_f32 v[198:199], v[198:199], v[22:23] op_sel:[0,0] op_sel_hi:[1,0]
v_cvt_pk_bf16_f32 v192, v192, v193
v_cvt_pk_bf16_f32 v193, v194, v195
v_cvt_pk_bf16_f32 v194, v196, v197
v_cvt_pk_bf16_f32 v195, v198, v199
buffer_store_dwordx4 v[192:195], v1, s[48:51], s65 offen offset:2048 sc1
s_add_u32 s65, s64, 4096
v_pk_mul_f32 v[200:201], v[200:201], v[22:23] op_sel:[0,0] op_sel_hi:[1,0]
v_pk_mul_f32 v[202:203], v[202:203], v[22:23] op_sel:[0,0] op_sel_hi:[1,0]
v_pk_mul_f32 v[204:205], v[204:205], v[22:23] op_sel:[0,0] op_sel_hi:[1,0]
v_pk_mul_f32 v[206:207], v[206:207], v[22:23] op_sel:[0,0] op_sel_hi:[1,0]
v_cvt_pk_bf16_f32 v200, v200, v201
v_cvt_pk_bf16_f32 v201, v202, v203
v_cvt_pk_bf16_f32 v202, v204, v205
v_cvt_pk_bf16_f32 v203, v206, v207
buffer_store_dwordx4 v[200:203], v1, s[48:51], s65 offen offset:2048 sc1
s_add_u32 s65, s64, 8192
v_pk_mul_f32 v[208:209], v[208:209], v[22:23] op_sel:[0,0] op_sel_hi:[1,0]
v_pk_mul_f32 v[210:211], v[210:211], v[22:23] op_sel:[0,0] op_sel_hi:[1,0]
v_pk_mul_f32 v[212:213], v[212:213], v[22:23] op_sel:[0,0] op_sel_hi:[1,0]
v_pk_mul_f32 v[214:215], v[214:215], v[22:23] op_sel:[0,0] op_sel_hi:[1,0]
v_cvt_pk_bf16_f32 v208, v208, v209
v_cvt_pk_bf16_f32 v209, v210, v211
v_cvt_pk_bf16_f32 v210, v212, v213
v_cvt_pk_bf16_f32 v211, v214, v215
buffer_store_dwordx4 v[208:211], v1, s[48:51], s65 offen offset:2048 sc1
s_add_u32 s65, s64, 12288
v_pk_mul_f32 v[216:217], v[216:217], v[22:23] op_sel:[0,0] op_sel_hi:[1,0]
v_pk_mul_f32 v[218:219], v[218:219], v[22:23] op_sel:[0,0] op_sel_hi:[1,0]
v_pk_mul_f32 v[220:221], v[220:221], v[22:23] op_sel:[0,0] op_sel_hi:[1,0]
v_pk_mul_f32 v[222:223], v[222:223], v[22:23] op_sel:[0,0] op_sel_hi:[1,0]
v_cvt_pk_bf16_f32 v216, v216, v217
v_cvt_pk_bf16_f32 v217, v218, v219
v_cvt_pk_bf16_f32 v218, v220, v221
v_cvt_pk_bf16_f32 v219, v222, v223
buffer_store_dwordx4 v[216:219], v1, s[48:51], s65 offen offset:2048 sc1
s_add_u32 s65, s64, 0
v_pk_mul_f32 v[224:225], v[224:225], v[22:23] op_sel:[0,1] op_sel_hi:[1,1]
v_pk_mul_f32 v[226:227], v[226:227], v[22:23] op_sel:[0,1] op_sel_hi:[1,1]
v_pk_mul_f32 v[228:229], v[228:229], v[22:23] op_sel:[0,1] op_sel_hi:[1,1]
v_pk_mul_f32 v[230:231], v[230:231], v[22:23] op_sel:[0,1] op_sel_hi:[1,1]
v_cvt_pk_bf16_f32 v224, v224, v225
v_cvt_pk_bf16_f32 v225, v226, v227
v_cvt_pk_bf16_f32 v226, v228, v229
v_cvt_pk_bf16_f32 v227, v230, v231
buffer_store_dwordx4 v[224:227], v1, s[48:51], s65 offen offset:3072 sc1
s_add_u32 s65, s64, 4096
v_pk_mul_f32 v[232:233], v[232:233], v[22:23] op_sel:[0,1] op_sel_hi:[1,1]
v_pk_mul_f32 v[234:235], v[234:235], v[22:23] op_sel:[0,1] op_sel_hi:[1,1]
v_pk_mul_f32 v[236:237], v[236:237], v[22:23] op_sel:[0,1] op_sel_hi:[1,1]
v_pk_mul_f32 v[238:239], v[238:239], v[22:23] op_sel:[0,1] op_sel_hi:[1,1]
v_cvt_pk_bf16_f32 v232, v232, v233
v_cvt_pk_bf16_f32 v233, v234, v235
v_cvt_pk_bf16_f32 v234, v236, v237
v_cvt_pk_bf16_f32 v235, v238, v239
buffer_store_dwordx4 v[232:235], v1, s[48:51], s65 offen offset:3072 sc1
s_add_u32 s65, s64, 8192
v_pk_mul_f32 v[240:241], v[240:241], v[22:23] op_sel:[0,1] op_sel_hi:[1,1]
v_pk_mul_f32 v[242:243], v[242:243], v[22:23] op_sel:[0,1] op_sel_hi:[1,1]
v_pk_mul_f32 v[244:245], v[244:245], v[22:23] op_sel:[0,1] op_sel_hi:[1,1]
v_pk_mul_f32 v[246:247], v[246:247], v[22:23] op_sel:[0,1] op_sel_hi:[1,1]
v_cvt_pk_bf16_f32 v240, v240, v241
v_cvt_pk_bf16_f32 v241, v242, v243
v_cvt_pk_bf16_f32 v242, v244, v245
v_cvt_pk_bf16_f32 v243, v246, v247
buffer_store_dwordx4 v[240:243], v1, s[48:51], s65 offen offset:3072 sc1
s_add_u32 s65, s64, 12288
v_pk_mul_f32 v[248:249], v[248:249], v[22:23] op_sel:[0,1] op_sel_hi:[1,1]
v_pk_mul_f32 v[250:251], v[250:251], v[22:23] op_sel:[0,1] op_sel_hi:[1,1]
v_pk_mul_f32 v[252:253], v[252:253], v[22:23] op_sel:[0,1] op_sel_hi:[1,1]
v_pk_mul_f32 v[254:255], v[254:255], v[22:23] op_sel:[0,1] op_sel_hi:[1,1]
v_cvt_pk_bf16_f32 v248, v248, v249
v_cvt_pk_bf16_f32 v249, v250, v251
v_cvt_pk_bf16_f32 v250, v252, v253
v_cvt_pk_bf16_f32 v251, v254, v255
buffer_store_dwordx4 v[248:251], v1, s[48:51], s65 offen offset:3072 sc1
s_add_u32 m0, s63, 0
s_nop 0
global_load_lds_dwordx4 v1, s[88:89] offset:0 sc1
s_add_u32 s90, s88, 4096
s_addc_u32 s91, s89, 0
global_load_lds_dwordx4 v1, s[88:89] offset:1024 sc1
global_load_lds_dwordx4 v1, s[88:89] offset:2048 sc1
global_load_lds_dwordx4 v1, s[88:89] offset:3072 sc1
s_add_u32 m0, s63, 4096
s_nop 0
global_load_lds_dwordx4 v1, s[90:91] offset:0 sc1
s_add_u32 s88, s90, 4096
s_addc_u32 s89, s91, 0
global_load_lds_dwordx4 v1, s[90:91] offset:1024 sc1
global_load_lds_dwordx4 v1, s[90:91] offset:2048 sc1
global_load_lds_dwordx4 v1, s[90:91] offset:3072 sc1
s_add_u32 m0, s63, 8192
s_nop 0
global_load_lds_dwordx4 v1, s[88:89] offset:0 sc1
s_add_u32 s90, s88, 4096
s_addc_u32 s91, s89, 0
global_load_lds_dwordx4 v1, s[88:89] offset:1024 sc1
global_load_lds_dwordx4 v1, s[88:89] offset:2048 sc1
global_load_lds_dwordx4 v1, s[88:89] offset:3072 sc1
s_add_u32 m0, s63, 12288
s_nop 0
global_load_lds_dwordx4 v1, s[90:91] offset:0 sc1
s_add_u32 s88, s90, 53248
s_addc_u32 s89, s91, 0
global_load_lds_dwordx4 v1, s[90:91] offset:1024 sc1
global_load_lds_dwordx4 v1, s[90:91] offset:2048 sc1
global_load_lds_dwordx4 v1, s[90:91] offset:3072 sc1
v_mov_b64 v[20:21], 0
v_mov_b64 v[22:23], 0
v_mov_b32 v44, 0xf149f2ca
v_mov_b32 v45, 0xf149f2ca
v_mov_b32 v46, 0xf149f2ca
v_mov_b32 v47, 0xf149f2ca
v_mov_b64 v[56:57], 0
v_mov_b64 v[58:59], 0
v_mov_b64 v[60:61], 0
ds_read_b128 v[64:67], v10 offset:2048
ds_read_b128 v[68:71], v10 offset:3072
ds_read_b128 v[72:75], v10 offset:0
ds_read_b128 v[76:79], v10 offset:1024
v_mfma_f32_32x32x16_bf16 v[128:143], v[56:59], v[56:59], 0
ds_read_b128 v[80:83], v10 offset:6144
ds_read_b128 v[84:87], v10 offset:7168
ds_read_b128 v[88:91], v10 offset:4096
ds_read_b128 v[92:95], v10 offset:5120
v_mfma_f32_32x32x16_bf16 v[144:159], v[56:59], v[56:59], 0
ds_read_b128 v[96:99], v10 offset:10240
ds_read_b128 v[100:103], v10 offset:11264
ds_read_b128 v[104:107], v10 offset:8192
ds_read_b128 v[108:111], v10 offset:9216
v_mfma_f32_32x32x16_bf16 v[160:175], v[56:59], v[56:59], 0
ds_read_b128 v[112:115], v10 offset:14336
ds_read_b128 v[116:119], v10 offset:15360
ds_read_b128 v[120:123], v10 offset:12288
ds_read_b128 v[124:127], v10 offset:13312
v_mfma_f32_32x32x16_bf16 v[176:191], v[56:59], v[56:59], 0
rda 128,7,0
rda 132,7,1024
rda 136,7,2048
rda 140,7,3072
v_mfma_f32_32x32x16_bf16 v[192:207], v[56:59], v[56:59], 0
rda 144,7,4096
rda 148,7,5120
rda 152,7,6144
rda 156,7,7168
v_mfma_f32_32x32x16_bf16 v[208:223], v[56:59], v[56:59], 0
rda 160,7,8192
rda 164,7,9216
rda 168,7,10240
rda 172,7,11264
v_mfma_f32_32x32x16_bf16 v[224:239], v[56:59], v[56:59], 0
rda 176,7,12288
rda 180,7,13312
rda 184,7,14336
rda 188,7,15360
v_mfma_f32_32x32x16_bf16 v[240:255], v[56:59], v[56:59], 0
rda 192,7,16384
rda 196,7,17408
rda 200,7,18432
rda 204,7,19456
rda 208,7,20480
rda 212,7,21504
rda 216,7,22528
rda 220,7,23552
rda 224,7,24576
rda 228,7,25600
rda 232,7,26624
rda 236,7,27648
rda 240,7,28672
rda 244,7,29696
rda 248,7,30720
rda 252,7,31744
s_sub_u32 s60, 33, s83
s_sub_u32 s60, s60, s58
s_mul_i32 s64, s60, 525312
s_lshl_b32 s68, s56, 14
s_add_u32 s64, s64, s68
s_sub_u32 s64, s64, 2048
s_mov_b32 s80, 2
s_add_u32 s81, s81, 1
s_cmp_lg_u32 s81, s61
s_waitcnt lgkmcnt(0)
s_cbranch_scc1 L_c_o16
s_branch L_c_o0
.p2align 6
L_stub14:
s_cbranch_execz L_walk_a3
s_nop 0
L_c_dh:
v_mfma_f32_16x16x32_bf16 v[32:35], a[0:3], v[64:67], v[12:15]
v_exp_f32 v44, v44
mav 32,4,80
mav 32,8,96
s_waitcnt vmcnt(0) lgkmcnt(0)
s_barrier
v_exp_f32 v45, v45
mav 32,12,112
s_getpc_b64 s[92:93]
L_here7:
s_add_u32 s92, s92, L_c_de0-L_here7
s_addc_u32 s93, s93, 0
v_lshlrev_b32 v9, 7, v0
v_min_u32 v9, L_s7_end-L_c_de0, v9
v_cvt_pk_bf16_f32 v62, v44, v45
s_add_u32 m0, s63, 0
v_exp_f32 v46, v46
global_load_lds_dwordx4 v1, s[88:89] offset:0 sc1
s_add_u32 s90, s88, 4096
v_exp_f32 v47, v47
s_nop 0
v_cvt_pk_bf16_f32 v63, v46, v47
s_addc_u32 s91, s89, 0
v_exp_f32 v32, v32
global_load_lds_dwordx4 v1, s[88:89] offset:1024 sc1
v_exp_f32 v33, v33
global_load_dword v28, v9, s[92:93]
v_cvt_pk_bf16_f32 v48, v32, v33
v_exp_f32 v34, v34
global_load_lds_dwordx4 v1, s[88:89] offset:2048 sc1
v_mov_b64 v[32:33], 0
v_exp_f32 v35, v35
s_sub_u32 s92, s92, L_c_de0-L_c_o0-4095
s_subb_u32 s93, s93, 0
s_and_b32 s92, s92, 0xfffff000
v_lshrrev_b32 v9, 3, v0
v_mul_u32_u24 v9, 3072, v9
v_lshl_add_u32 v9, v0, 7, v9
v_min_u32 v9, L_guard-L_c_o0-4096, v9
global_load_dword v28, v9, s[92:93]
v_cvt_pk_bf16_f32 v49, v34, v35
v_smfmac_f32_16x16x64_bf16 v[32:35], v[24:27], v[56:63], v11
mav 224,192,56
mav 224,196,60
global_load_lds_dwordx4 v1, s[88:89] offset:3072 sc1
mav 228,204,60
mav 228,200,56
v_mov_b32 v50, 0
mav 232,208,56
s_add_u32 m0, s63, 4096
mav 232,212,60
global_load_lds_dwordx4 v1, s[90:91] offset:0 sc1
mav 236,220,60
s_add_u32 s88, s90, 4096
mav 236,216,56
L_stub15:
s_cbranch_execz L_walk_a3
v_mov_b32 v51, 0
mav 240,224,56
s_addc_u32 s89, s91, 0
mav 240,228,60
global_load_lds_dwordx4 v1, s[90:91] offset:1024 sc1
v_add_f32 v23, v23, v32
mav 244,236,60
mav 244,232,56
mav 248,240,56
mav 248,244,60
global_load_lds_dwordx4 v1, s[90:91] offset:2048 sc1
v_add_f32 v23, v23, v33
mav 252,252,60
mav 252,248,56
mav0 32,0,68
mav 32,4,84
global_load_lds_dwordx4 v1, s[90:91] offset:3072 sc1
mav 32,8,100
mav 32,12,116
v_mfma_f32_16x16x32_bf16 v[36:39], a[28:31], v[116:119], v[12:15]
s_add_u32 m0, s63, 8192
mav 36,24,100
global_load_lds_dwordx4 v1, s[88:89] offset:0 sc1
mav 36,20,84
s_add_u32 s90, s88, 4096
mav 36,16,68
s_addc_u32 s91, s89, 0
v_exp_f32 v32, v32
global_load_lds_dwordx4 v1, s[88:89] offset:1024 sc1
v_exp_f32 v33, v33
s_nop 0
v_cvt_pk_bf16_f32 v56, v32, v33
v_exp_f32 v34, v34
global_load_lds_dwordx4 v1, s[88:89] offset:2048 sc1
v_exp_f32 v35, v35
s_nop 0
v_cvt_pk_bf16_f32 v57, v34, v35
mvv0 32,24,48
mav 128,64,48
v_exp_f32 v36, v36
global_load_lds_dwordx4 v1, s[88:89] offset:3072 sc1
v_exp_f32 v37, v37
mav 132,72,48
v_cvt_pk_bf16_f32 v58, v36, v37
mav 136,80,48
s_add_u32 m0, s63, 12288
v_exp_f32 v38, v38
global_load_lds_dwordx4 v1, s[90:91] offset:0 sc1
v_add_f32 v20, v20, v32
s_add_u32 s88, s90, 53248
v_exp_f32 v39, v39
mav 140,88,48
v_cvt_pk_bf16_f32 v59, v38, v39
mav 144,96,48
s_addc_u32 s89, s91, 0
global_load_lds_dwordx4 v1, s[90:91] offset:1024 sc1
mav 148,104,48
mav 152,112,48
global_load_lds_dwordx4 v1, s[90:91] offset:2048 sc1
mav 156,120,48
mav0 32,0,72
mav 32,4,88
global_load_lds_dwordx4 v1, s[90:91] offset:3072 sc1
mav 32,8,104
mav 32,12,120
mav0 36,28,120
mav 36,24,104
buffer_store_dwordx2 v[16:17], v29, s[48:51], 0 offen offset:256 sc1
mav 36,20,88
mav 36,16,72
v_mfma_f32_16x16x32_bf16 v[40:43], a[32:35], v[72:75], v[12:15]
s_nop 1
v_exp_f32 v32, v32
mav 40,36,88
mav 40,40,104
v_exp_f32 v33, v33
mav 40,44,120
v_cvt_pk_bf16_f32 v48, v32, v33
v_exp_f32 v34, v34
v_exp_f32 v35, v35
s_nop 0
v_cvt_pk_bf16_f32 v49, v34, v35
mvv0 32,24,56
mav 160,64,56
v_exp_f32 v36, v36
v_exp_f32 v37, v37
mav 164,72,56
v_cvt_pk_bf16_f32 v50, v36, v37
mav 168,80,56
v_exp_f32 v38, v38
s_nop 0
v_add_f32 v21, v21, v32
v_exp_f32 v39, v39
mav 172,88,56
v_cvt_pk_bf16_f32 v51, v38, v39
mav 176,96,56
v_exp_f32 v40, v40
v_exp_f32 v41, v41
mav 180,104,56
v_cvt_pk_bf16_f32 v52, v40, v41
mav 184,112,56
v_exp_f32 v42, v42
v_exp_f32 v43, v43
mav 188,120,56
v_cvt_pk_bf16_f32 v53, v42, v43
mav0 32,0,76
mav 32,4,92
mav 32,8,108
mav 32,12,124
v_mov_b32 v54, 0
mav0 36,28,124
s_add_u32 s81, s81, 1
mav 36,24,108
mav 36,20,92
mav 36,16,76
v_mov_b32 v55, 0
mav0 40,32,76
v_exp_f32 v32, v32
mav 40,36,92
mav 40,40,108
v_exp_f32 v33, v33
mav 40,44,124
v_cvt_pk_bf16_f32 v56, v32, v33
v_mfma_f32_16x16x32_bf16 v[44:47], a[60:63], v[124:127], v[12:15]
v_exp_f32 v34, v34
mav 44,56,108
v_mov_b64 v[32:33], 0
mav 44,52,92
v_exp_f32 v35, v35
mav 44,48,76
v_cvt_pk_bf16_f32 v57, v34, v35
v_smfmac_f32_16x16x64_bf16 v[32:35], v[24:27], v[48:55], v11
mav 192,64,48
v_exp_f32 v36, v36
mav 192,68,52
mav 196,76,52
v_exp_f32 v37, v37
mav 196,72,48
v_cvt_pk_bf16_f32 v58, v36, v37
mav 200,80,48
v_exp_f32 v38, v38
mav 200,84,52
mav 204,92,52
v_exp_f32 v39, v39
mav 204,88,48
v_cvt_pk_bf16_f32 v59, v38, v39
mav 208,96,48
v_exp_f32 v40, v40
mav 208,100,52
v_add_f32 v22, v22, v32
mav 212,108,52
v_exp_f32 v41, v41
mav 212,104,48
v_cvt_pk_bf16_f32 v60, v40, v41
mav 216,112,48
v_exp_f32 v42, v42
mav 216,116,52
v_add_f32 v22, v22, v33
mav 220,124,52
v_exp_f32 v43, v43
mav 220,120,48
v_cvt_pk_bf16_f32 v61, v42, v43
v_subrev_u32 v6, s71, v6
v_subrev_u32 v7, s71, v7
s_add_u32 s88, s48, s79
s_addc_u32 s89, s49, 0
s_mov_b32 s61, 15
s_mov_b32 s75, 1
v_exp_f32 v44, v44
v_exp_f32 v45, v45
v_exp_f32 v46, v46
v_exp_f32 v47, v47
v_mov_b64 v[32:33], 0
v_cvt_pk_bf16_f32 v62, v44, v45
v_cvt_pk_bf16_f32 v63, v46, v47
s_nop 1
v_smfmac_f32_16x16x64_bf16 v[32:35], v[24:27], v[56:63], v11
mav 224,64,56
s_nop 2
mav 224,68,60
s_nop 2
mav 228,76,60
s_nop 2
mav 228,72,56
v_add_f32 v23, v23, v32
v_add_f32 v23, v23, v33
mav 232,80,56
s_mov_b32 s65, 0x1f800000
v_mov_b32 v42, 0x5f800000
v_med3_f32 v38, v20, s65, v42
mav 232,84,60
v_med3_f32 v39, v21, s65, v42
v_med3_f32 v40, v22, s65, v42
mav 236,92,60
v_med3_f32 v41, v23, s65, v42
v_cmp_neq_f32 vcc, v38, v20
mav 236,88,56
v_cmp_neq_f32 s[94:95], v39, v21
v_cmp_neq_f32 s[92:93], v40, v22
mav 240,96,56
v_cmp_neq_f32 s[98:99], v41, v23
mav 240,100,60
mav 244,108,60
mav 244,104,56
mav 248,112,56
mav 248,116,60
mav 252,124,60
mav 252,120,56
s_or_b64 vcc, vcc, s[92:93]
s_or_b64 vcc, vcc, s[98:99]
s_or_b64 vcc, vcc, s[94:95]
s_cbranch_scc1 L_idle1_redo
L_idle1_ok:
v_rcp_f32 v20, v20
v_rcp_f32 v21, v21
v_rcp_f32 v22, v22
v_rcp_f32 v23, v23
s_waitcnt vmcnt(0) lgkmcnt(0)
s_barrier
s_add_u32 s65, s64, 0
v_pk_mul_f32 v[128:129], v[128:129], v[20:21] op_sel:[0,0] op_sel_hi:[1,0]
v_pk_mul_f32 v[130:131], v[130:131], v[20:21] op_sel:[0,0] op_sel_hi:[1,0]
v_pk_mul_f32 v[132:133], v[132:133], v[20:21] op_sel:[0,0] op_sel_hi:[1,0]
v_pk_mul_f32 v[134:135], v[134:135], v[20:21] op_sel:[0,0] op_sel_hi:[1,0]
v_cvt_pk_bf16_f32 v128, v128, v129
v_cvt_pk_bf16_f32 v129, v130, v131
v_cvt_pk_bf16_f32 v130, v132, v133
v_cvt_pk_bf16_f32 v131, v134, v135
buffer_store_dwordx4 v[128:131], v1, s[48:51], s65 offen offset:0 sc1
s_add_u32 s65, s64, 4096
v_pk_mul_f32 v[136:137], v[136:137], v[20:21] op_sel:[0,0] op_sel_hi:[1,0]
v_pk_mul_f32 v[138:139], v[138:139], v[20:21] op_sel:[0,0] op_sel_hi:[1,0]
v_pk_mul_f32 v[140:141], v[140:141], v[20:21] op_sel:[0,0] op_sel_hi:[1,0]
v_pk_mul_f32 v[142:143], v[142:143], v[20:21] op_sel:[0,0] op_sel_hi:[1,0]
v_cvt_pk_bf16_f32 v136, v136, v137
v_cvt_pk_bf16_f32 v137, v138, v139
v_cvt_pk_bf16_f32 v138, v140, v141
v_cvt_pk_bf16_f32 v139, v142, v143
buffer_store_dwordx4 v[136:139], v1, s[48:51], s65 offen offset:0 sc1
s_add_u32 s65, s64, 8192
v_pk_mul_f32 v[144:145], v[144:145], v[20:21] op_sel:[0,0] op_sel_hi:[1,0]
v_pk_mul_f32 v[146:147], v[146:147], v[20:21] op_sel:[0,0] op_sel_hi:[1,0]
v_pk_mul_f32 v[148:149], v[148:149], v[20:21] op_sel:[0,0] op_sel_hi:[1,0]
v_pk_mul_f32 v[150:151], v[150:151], v[20:21] op_sel:[0,0] op_sel_hi:[1,0]
v_cvt_pk_bf16_f32 v144, v144, v145
v_cvt_pk_bf16_f32 v145, v146, v147
v_cvt_pk_bf16_f32 v146, v148, v149
v_cvt_pk_bf16_f32 v147, v150, v151
buffer_store_dwordx4 v[144:147], v1, s[48:51], s65 offen offset:0 sc1
s_add_u32 s65, s64, 12288
v_pk_mul_f32 v[152:153], v[152:153], v[20:21] op_sel:[0,0] op_sel_hi:[1,0]
v_pk_mul_f32 v[154:155], v[154:155], v[20:21] op_sel:[0,0] op_sel_hi:[1,0]
v_pk_mul_f32 v[156:157], v[156:157], v[20:21] op_sel:[0,0] op_sel_hi:[1,0]
v_pk_mul_f32 v[158:159], v[158:159], v[20:21] op_sel:[0,0] op_sel_hi:[1,0]
v_cvt_pk_bf16_f32 v152, v152, v153
v_cvt_pk_bf16_f32 v153, v154, v155
v_cvt_pk_bf16_f32 v154, v156, v157
v_cvt_pk_bf16_f32 v155, v158, v159
buffer_store_dwordx4 v[152:155], v1, s[48:51], s65 offen offset:0 sc1
s_add_u32 s65, s64, 0
v_pk_mul_f32 v[160:161], v[160:161], v[20:21] op_sel:[0,1] op_sel_hi:[1,1]
v_pk_mul_f32 v[162:163], v[162:163], v[20:21] op_sel:[0,1] op_sel_hi:[1,1]
v_pk_mul_f32 v[164:165], v[164:165], v[20:21] op_sel:[0,1] op_sel_hi:[1,1]
v_pk_mul_f32 v[166:167], v[166:167], v[20:21] op_sel:[0,1] op_sel_hi:[1,1]
v_cvt_pk_bf16_f32 v160, v160, v161
v_cvt_pk_bf16_f32 v161, v162, v163
v_cvt_pk_bf16_f32 v162, v164, v165
v_cvt_pk_bf16_f32 v163, v166, v167
buffer_store_dwordx4 v[160:163], v1, s[48:51], s65 offen offset:1024 sc1
s_add_u32 s65, s64, 4096
v_pk_mul_f32 v[168:169], v[168:169], v[20:21] op_sel:[0,1] op_sel_hi:[1,1]
v_pk_mul_f32 v[170:171], v[170:171], v[20:21] op_sel:[0,1] op_sel_hi:[1,1]
v_pk_mul_f32 v[172:173], v[172:173], v[20:21] op_sel:[0,1] op_sel_hi:[1,1]
v_pk_mul_f32 v[174:175], v[174:175], v[20:21] op_sel:[0,1] op_sel_hi:[1,1]
v_cvt_pk_bf16_f32 v168, v168, v169
v_cvt_pk_bf16_f32 v169, v170, v171
v_cvt_pk_bf16_f32 v170, v172, v173
v_cvt_pk_bf16_f32 v171, v174, v175
buffer_store_dwordx4 v[168:171], v1, s[48:51], s65 offen offset:1024 sc1
s_add_u32 s65, s64, 8192
v_pk_mul_f32 v[176:177], v[176:177], v[20:21] op_sel:[0,1] op_sel_hi:[1,1]
v_pk_mul_f32 v[178:179], v[178:179], v[20:21] op_sel:[0,1] op_sel_hi:[1,1]
v_pk_mul_f32 v[180:181], v[180:181], v[20:21] op_sel:[0,1] op_sel_hi:[1,1]
v_pk_mul_f32 v[182:183], v[182:183], v[20:21] op_sel:[0,1] op_sel_hi:[1,1]
v_cvt_pk_bf16_f32 v176, v176, v177
v_cvt_pk_bf16_f32 v177, v178, v179
v_cvt_pk_bf16_f32 v178, v180, v181
v_cvt_pk_bf16_f32 v179, v182, v183
buffer_store_dwordx4 v[176:179], v1, s[48:51], s65 offen offset:1024 sc1
s_add_u32 s65, s64, 12288
v_pk_mul_f32 v[184:185], v[184:185], v[20:21] op_sel:[0,1] op_sel_hi:[1,1]
v_pk_mul_f32 v[186:187], v[186:187], v[20:21] op_sel:[0,1] op_sel_hi:[1,1]
v_pk_mul_f32 v[188:189], v[188:189], v[20:21] op_sel:[0,1] op_sel_hi:[1,1]
v_pk_mul_f32 v[190:191], v[190:191], v[20:21] op_sel:[0,1] op_sel_hi:[1,1]
v_cvt_pk_bf16_f32 v184, v184, v185
v_cvt_pk_bf16_f32 v185, v186, v187
v_cvt_pk_bf16_f32 v186, v188, v189
v_cvt_pk_bf16_f32 v187, v190, v191
buffer_store_dwordx4 v[184:187], v1, s[48:51], s65 offen offset:1024 sc1
s_add_u32 s65, s64, 0
v_pk_mul_f32 v[192:193], v[192:193], v[22:23] op_sel:[0,0] op_sel_hi:[1,0]
v_pk_mul_f32 v[194:195], v[194:195], v[22:23] op_sel:[0,0] op_sel_hi:[1,0]
v_pk_mul_f32 v[196:197], v[196:197], v[22:23] op_sel:[0,0] op_sel_hi:[1,0]
v_pk_mul_f32 v[198:199], v[198:199], v[22:23] op_sel:[0,0] op_sel_hi:[1,0]
v_cvt_pk_bf16_f32 v192, v192, v193
v_cvt_pk_bf16_f32 v193, v194, v195
v_cvt_pk_bf16_f32 v194, v196, v197
v_cvt_pk_bf16_f32 v195, v198, v199
buffer_store_dwordx4 v[192:195], v1, s[48:51], s65 offen offset:2048 sc1
s_add_u32 s65, s64, 4096
v_pk_mul_f32 v[200:201], v[200:201], v[22:23] op_sel:[0,0] op_sel_hi:[1,0]
v_pk_mul_f32 v[202:203], v[202:203], v[22:23] op_sel:[0,0] op_sel_hi:[1,0]
v_pk_mul_f32 v[204:205], v[204:205], v[22:23] op_sel:[0,0] op_sel_hi:[1,0]
v_pk_mul_f32 v[206:207], v[206:207], v[22:23] op_sel:[0,0] op_sel_hi:[1,0]
v_cvt_pk_bf16_f32 v200, v200, v201
v_cvt_pk_bf16_f32 v201, v202, v203
v_cvt_pk_bf16_f32 v202, v204, v205
v_cvt_pk_bf16_f32 v203, v206, v207
buffer_store_dwordx4 v[200:203], v1, s[48:51], s65 offen offset:2048 sc1
s_add_u32 s65, s64, 8192
v_pk_mul_f32 v[208:209], v[208:209], v[22:23] op_sel:[0,0] op_sel_hi:[1,0]
v_pk_mul_f32 v[210:211], v[210:211], v[22:23] op_sel:[0,0] op_sel_hi:[1,0]
v_pk_mul_f32 v[212:213], v[212:213], v[22:23] op_sel:[0,0] op_sel_hi:[1,0]
v_pk_mul_f32 v[214:215], v[214:215], v[22:23] op_sel:[0,0] op_sel_hi:[1,0]
v_cvt_pk_bf16_f32 v208, v208, v209
v_cvt_pk_bf16_f32 v209, v210, v211
v_cvt_pk_bf16_f32 v210, v212, v213
v_cvt_pk_bf16_f32 v211, v214, v215
buffer_store_dwordx4 v[208:211], v1, s[48:51], s65 offen offset:2048 sc1
s_add_u32 s65, s64, 12288
v_pk_mul_f32 v[216:217], v[216:217], v[22:23] op_sel:[0,0] op_sel_hi:[1,0]
v_pk_mul_f32 v[218:219], v[218:219], v[22:23] op_sel:[0,0] op_sel_hi:[1,0]
v_pk_mul_f32 v[220:221], v[220:221], v[22:23] op_sel:[0,0] op_sel_hi:[1,0]
v_pk_mul_f32 v[222:223], v[222:223], v[22:23] op_sel:[0,0] op_sel_hi:[1,0]
v_cvt_pk_bf16_f32 v216, v216, v217
v_cvt_pk_bf16_f32 v217, v218, v219
v_cvt_pk_bf16_f32 v218, v220, v221
v_cvt_pk_bf16_f32 v219, v222, v223
buffer_store_dwordx4 v[216:219], v1, s[48:51], s65 offen offset:2048 sc1
s_add_u32 s65, s64, 0
v_pk_mul_f32 v[224:225], v[224:225], v[22:23] op_sel:[0,1] op_sel_hi:[1,1]
v_pk_mul_f32 v[226:227], v[226:227], v[22:23] op_sel:[0,1] op_sel_hi:[1,1]
v_pk_mul_f32 v[228:229], v[228:229], v[22:23] op_sel:[0,1] op_sel_hi:[1,1]
v_pk_mul_f32 v[230:231], v[230:231], v[22:23] op_sel:[0,1] op_sel_hi:[1,1]
v_cvt_pk_bf16_f32 v224, v224, v225
v_cvt_pk_bf16_f32 v225, v226, v227
v_cvt_pk_bf16_f32 v226, v228, v229
v_cvt_pk_bf16_f32 v227, v230, v231
buffer_store_dwordx4 v[224:227], v1, s[48:51], s65 offen offset:3072 sc1
s_add_u32 s65, s64, 4096
v_pk_mul_f32 v[232:233], v[232:233], v[22:23] op_sel:[0,1] op_sel_hi:[1,1]
v_pk_mul_f32 v[234:235], v[234:235], v[22:23] op_sel:[0,1] op_sel_hi:[1,1]
v_pk_mul_f32 v[236:237], v[236:237], v[22:23] op_sel:[0,1] op_sel_hi:[1,1]
v_pk_mul_f32 v[238:239], v[238:239], v[22:23] op_sel:[0,1] op_sel_hi:[1,1]
v_cvt_pk_bf16_f32 v232, v232, v233
v_cvt_pk_bf16_f32 v233, v234, v235
v_cvt_pk_bf16_f32 v234, v236, v237
v_cvt_pk_bf16_f32 v235, v238, v239
buffer_store_dwordx4 v[232:235], v1, s[48:51], s65 offen offset:3072 sc1
s_add_u32 s65, s64, 8192
v_pk_mul_f32 v[240:241], v[240:241], v[22:23] op_sel:[0,1] op_sel_hi:[1,1]
v_pk_mul_f32 v[242:243], v[242:243], v[22:23] op_sel:[0,1] op_sel_hi:[1,1]
v_pk_mul_f32 v[244:245], v[244:245], v[22:23] op_sel:[0,1] op_sel_hi:[1,1]
v_pk_mul_f32 v[246:247], v[246:247], v[22:23] op_sel:[0,1] op_sel_hi:[1,1]
v_cvt_pk_bf16_f32 v240, v240, v241
v_cvt_pk_bf16_f32 v241, v242, v243
v_cvt_pk_bf16_f32 v242, v244, v245
v_cvt_pk_bf16_f32 v243, v246, v247
buffer_store_dwordx4 v[240:243], v1, s[48:51], s65 offen offset:3072 sc1
s_add_u32 s65, s64, 12288
v_pk_mul_f32 v[248:249], v[248:249], v[22:23] op_sel:[0,1] op_sel_hi:[1,1]
v_pk_mul_f32 v[250:251], v[250:251], v[22:23] op_sel:[0,1] op_sel_hi:[1,1]
v_pk_mul_f32 v[252:253], v[252:253], v[22:23] op_sel:[0,1] op_sel_hi:[1,1]
v_pk_mul_f32 v[254:255], v[254:255], v[22:23] op_sel:[0,1] op_sel_hi:[1,1]
v_cvt_pk_bf16_f32 v248, v248, v249
v_cvt_pk_bf16_f32 v249, v250, v251
v_cvt_pk_bf16_f32 v250, v252, v253
v_cvt_pk_bf16_f32 v251, v254, v255
buffer_store_dwordx4 v[248:251], v1, s[48:51], s65 offen offset:3072 sc1
s_add_u32 m0, s63, 65536
s_nop 0
global_load_lds_dwordx4 v1, s[88:89] offset:0 sc1
s_add_u32 s90, s88, 4096
s_addc_u32 s91, s89, 0
global_load_lds_dwordx4 v1, s[88:89] offset:1024 sc1
global_load_lds_dwordx4 v1, s[88:89] offset:2048 sc1
global_load_lds_dwordx4 v1, s[88:89] offset:3072 sc1
s_add_u32 m0, s63, 69632
s_nop 0
global_load_lds_dwordx4 v1, s[90:91] offset:0 sc1
s_add_u32 s88, s90, 4096
s_addc_u32 s89, s91, 0
global_load_lds_dwordx4 v1, s[90:91] offset:1024 sc1
global_load_lds_dwordx4 v1, s[90:91] offset:2048 sc1
global_load_lds_dwordx4 v1, s[90:91] offset:3072 sc1
s_add_u32 m0, s63, 73728
s_nop 0
global_load_lds_dwordx4 v1, s[88:89] offset:0 sc1
s_add_u32 s90, s88, 4096
s_addc_u32 s91, s89, 0
global_load_lds_dwordx4 v1, s[88:89] offset:1024 sc1
global_load_lds_dwordx4 v1, s[88:89] offset:2048 sc1
global_load_lds_dwordx4 v1, s[88:89] offset:3072 sc1
s_add_u32 m0, s63, 77824
s_nop 0
global_load_lds_dwordx4 v1, s[90:91] offset:0 sc1
s_add_u32 s88, s90, 53248
s_addc_u32 s89, s91, 0
global_load_lds_dwordx4 v1, s[90:91] offset:1024 sc1
global_load_lds_dwordx4 v1, s[90:91] offset:2048 sc1
global_load_lds_dwordx4 v1, s[90:91] offset:3072 sc1
buffer_load_dwordx2 v[18:19], v8, s[48:51], 0 offen offset:256 sc1
v_mov_b64 v[20:21], 0
v_mov_b64 v[22:23], 0
v_mov_b32 v44, 0xf149f2ca
v_mov_b32 v45, 0xf149f2ca
v_mov_b32 v46, 0xf149f2ca
v_mov_b32 v47, 0xf149f2ca
v_mov_b64 v[56:57], 0
v_mov_b64 v[58:59], 0
v_mov_b64 v[60:61], 0
ds_read_b128 v[64:67], v10 offset:2048
ds_read_b128 v[68:71], v10 offset:3072
ds_read_b128 v[72:75], v10 offset:0
ds_read_b128 v[76:79], v10 offset:1024
v_mfma_f32_32x32x16_bf16 v[128:143], v[56:59], v[56:59], 0
ds_read_b128 v[80:83], v10 offset:6144
ds_read_b128 v[84:87], v10 offset:7168
ds_read_b128 v[88:91], v10 offset:4096
ds_read_b128 v[92:95], v10 offset:5120
v_mfma_f32_32x32x16_bf16 v[144:159], v[56:59], v[56:59], 0
ds_read_b128 v[96:99], v10 offset:10240
ds_read_b128 v[100:103], v10 offset:11264
ds_read_b128 v[104:107], v10 offset:8192
ds_read_b128 v[108:111], v10 offset:9216
v_mfma_f32_32x32x16_bf16 v[160:175], v[56:59], v[56:59], 0
ds_read_b128 v[112:115], v10 offset:14336
ds_read_b128 v[116:119], v10 offset:15360
ds_read_b128 v[120:123], v10 offset:12288
ds_read_b128 v[124:127], v10 offset:13312
v_mfma_f32_32x32x16_bf16 v[176:191], v[56:59], v[56:59], 0
rda 0,6,0
rda 4,6,1024
rda 8,6,2048
rda 12,6,3072
v_mfma_f32_32x32x16_bf16 v[192:207], v[56:59], v[56:59], 0
rda 16,6,4096
rda 20,6,5120
rda 24,6,6144
rda 28,6,7168
v_mfma_f32_32x32x16_bf16 v[208:223], v[56:59], v[56:59], 0
rda 32,6,8192
rda 36,6,9216
rda 40,6,10240
rda 44,6,11264
v_mfma_f32_32x32x16_bf16 v[224:239], v[56:59], v[56:59], 0
rda 48,6,12288
rda 52,6,13312
rda 56,6,14336
rda 60,6,15360
v_mfma_f32_32x32x16_bf16 v[240:255], v[56:59], v[56:59], 0
rda 64,6,16384
rda 68,6,17408
rda 72,6,18432
rda 76,6,19456
rda 80,6,20480
rda 84,6,21504
rda 88,6,22528
rda 92,6,23552
rda 96,6,24576
rda 100,6,25600
rda 104,6,26624
rda 108,6,27648
rda 112,6,28672
rda 116,6,29696
rda 120,6,30720
rda 124,6,31744
s_sub_u32 s60, 33, s83
s_sub_u32 s60, s60, s58
s_mul_i32 s64, s60, 525312
s_lshl_b32 s68, s56, 14
s_add_u32 s64, s64, s68
s_sub_u32 s64, s64, 2048
s_mov_b32 s80, 2
s_add_u32 s81, s81, 1
s_cmp_eq_u32 s57, 7
s_waitcnt lgkmcnt(0)
s_cbranch_scc0 L_c_e16
v_lshrrev_b32 v3, 3, v0
v_bfe_u32 v4, v0, 1, 2
v_lshrrev_b32 v5, 4, v0
v_xor_b32 v4, v4, v5
v_lshlrev_b32 v4, 5, v4
v_lshl_add_u32 v3, v3, 10, v4
v_and_b32 v4, 1, v0
v_lshl_add_u32 v2, v4, 4, v3
v_add_u32 v3, 7168, v2
v_add_u32 v4, 14336, v2
v_add_u32 v5, 21504, v2
s_waitcnt vmcnt(0)
s_branch L_c_e0
.p2align 6
L_stub16:
s_cbranch_execz L_walk_a4
s_nop 0
L_c_de:
v_mfma_f32_16x16x32_bf16 v[32:35], a[0:3], v[64:67], v[12:15]
v_exp_f32 v44, v44
mav 32,4,80
mav 32,8,96
s_waitcnt vmcnt(0) lgkmcnt(0)
s_barrier
v_exp_f32 v45, v45
mav 32,12,112
rda 128,7,0
v_cvt_pk_bf16_f32 v62, v44, v45
s_add_u32 m0, s63, 0
v_exp_f32 v46, v46
global_load_lds_dwordx4 v1, s[88:89] offset:0 sc1
s_add_u32 s90, s88, 4096
v_exp_f32 v47, v47
rda 132,7,1024
v_cvt_pk_bf16_f32 v63, v46, v47
s_addc_u32 s91, s89, 0
v_exp_f32 v32, v32
global_load_lds_dwordx4 v1, s[88:89] offset:1024 sc1
v_exp_f32 v33, v33
rda 136,7,2048
v_cvt_pk_bf16_f32 v48, v32, v33
v_exp_f32 v34, v34
global_load_lds_dwordx4 v1, s[88:89] offset:2048 sc1
v_mov_b64 v[32:33], 0
v_exp_f32 v35, v35
rda 140,7,3072
v_cvt_pk_bf16_f32 v49, v34, v35
v_smfmac_f32_16x16x64_bf16 v[32:35], v[24:27], v[56:63], v11
mav 224,192,56
mav 224,196,60
global_load_lds_dwordx4 v1, s[88:89] offset:3072 sc1
mav 228,204,60
mav 228,200,56
rda 144,7,4096
v_mov_b32 v50, 0
mav 232,208,56
s_add_u32 m0, s63, 4096
mav 232,212,60
global_load_lds_dwordx4 v1, s[90:91] offset:0 sc1
mav 236,220,60
s_add_u32 s88, s90, 4096
mav 236,216,56
rda 148,7,5120
v_mov_b32 v51, 0
mav 240,224,56
s_addc_u32 s89, s91, 0
mav 240,228,60
global_load_lds_dwordx4 v1, s[90:91] offset:1024 sc1
v_add_f32 v23, v23, v32
mav 244,236,60
mav 244,232,56
rda 152,7,6144
mav 248,240,56
mav 248,244,60
global_load_lds_dwordx4 v1, s[90:91] offset:2048 sc1
v_add_f32 v23, v23, v33
mav 252,252,60
mav 252,248,56
rda 156,7,7168
mav0 32,0,68
mav 32,4,84
global_load_lds_dwordx4 v1, s[90:91] offset:3072 sc1
mav 32,8,100
L_stub17:
s_cbranch_execz L_walk_a4
mav 32,12,116
rda 160,7,8192
v_mfma_f32_16x16x32_bf16 v[36:39], a[28:31], v[116:119], v[12:15]
s_add_u32 m0, s63, 8192
mav 36,24,100
global_load_lds_dwordx4 v1, s[88:89] offset:0 sc1
mav 36,20,84
s_add_u32 s90, s88, 4096
mav 36,16,68
rda 164,7,9216
s_addc_u32 s91, s89, 0
v_exp_f32 v32, v32
global_load_lds_dwordx4 v1, s[88:89] offset:1024 sc1
v_exp_f32 v33, v33
rda 168,7,10240
v_cvt_pk_bf16_f32 v56, v32, v33
v_exp_f32 v34, v34
global_load_lds_dwordx4 v1, s[88:89] offset:2048 sc1
v_exp_f32 v35, v35
rda 172,7,11264
v_cvt_pk_bf16_f32 v57, v34, v35
mvv0 32,24,48
mav 128,64,48
v_exp_f32 v36, v36
global_load_lds_dwordx4 v1, s[88:89] offset:3072 sc1
v_exp_f32 v37, v37
mav 132,72,48
rda 176,7,12288
v_cvt_pk_bf16_f32 v58, v36, v37
mav 136,80,48
s_add_u32 m0, s63, 12288
v_exp_f32 v38, v38
global_load_lds_dwordx4 v1, s[90:91] offset:0 sc1
v_add_f32 v20, v20, v32
s_add_u32 s88, s90, 53248
v_exp_f32 v39, v39
mav 140,88,48
rda 180,7,13312
v_cvt_pk_bf16_f32 v59, v38, v39
mav 144,96,48
s_addc_u32 s89, s91, 0
global_load_lds_dwordx4 v1, s[90:91] offset:1024 sc1
mav 148,104,48
rda 184,7,14336
mav 152,112,48
global_load_lds_dwordx4 v1, s[90:91] offset:2048 sc1
mav 156,120,48
rda 188,7,15360
mav0 32,0,72
mav 32,4,88
global_load_lds_dwordx4 v1, s[90:91] offset:3072 sc1
mav 32,8,104
mav 32,12,120
rda 192,7,16384
mav0 36,28,120
mav 36,24,104
mav 36,20,88
mav 36,16,72
rda 196,7,17408
v_mfma_f32_16x16x32_bf16 v[40:43], a[32:35], v[72:75], v[12:15]
s_nop 0
v_exp_f32 v32, v32
mav 40,36,88
mav 40,40,104
v_exp_f32 v33, v33
mav 40,44,120
rda 200,7,18432
v_cvt_pk_bf16_f32 v48, v32, v33
v_exp_f32 v34, v34
v_exp_f32 v35, v35
rda 204,7,19456
v_cvt_pk_bf16_f32 v49, v34, v35
mvv0 32,24,56
mav 160,64,56
v_exp_f32 v36, v36
v_exp_f32 v37, v37
mav 164,72,56
rda 208,7,20480
v_cvt_pk_bf16_f32 v50, v36, v37
mav 168,80,56
v_exp_f32 v38, v38
v_add_f32 v21, v21, v32
v_exp_f32 v39, v39
mav 172,88,56
rda 212,7,21504
v_cvt_pk_bf16_f32 v51, v38, v39
mav 176,96,56
v_exp_f32 v40, v40
v_exp_f32 v41, v41
mav 180,104,56
rda 216,7,22528
v_cvt_pk_bf16_f32 v52, v40, v41
mav 184,112,56
v_exp_f32 v42, v42
v_exp_f32 v43, v43
mav 188,120,56
rda 220,7,23552
v_cvt_pk_bf16_f32 v53, v42, v43
mav0 32,0,76
mav 32,4,92
rda 224,7,24576
mav 32,8,108
mav 32,12,124
rda 228,7,25600
v_mov_b32 v54, 0
mav0 36,28,124
s_add_u32 s81, s81, 1
mav 36,24,108
mav 36,20,92
mav 36,16,76
rda 232,7,26624
v_mov_b32 v55, 0
mav0 40,32,76
v_exp_f32 v32, v32
mav 40,36,92
mav 40,40,108
v_exp_f32 v33, v33
mav 40,44,124
rda 236,7,27648
v_cvt_pk_bf16_f32 v56, v32, v33
v_mfma_f32_16x16x32_bf16 v[44:47], a[60:63], v[124:127], v[12:15]
v_exp_f32 v34, v34
mav 44,56,108
v_mov_b64 v[32:33], 0
mav 44,52,92
v_exp_f32 v35, v35
mav 44,48,76
rda 240,7,28672
v_cvt_pk_bf16_f32 v57, v34, v35
v_smfmac_f32_16x16x64_bf16 v[32:35], v[24:27], v[48:55], v11
mav 192,64,48
v_exp_f32 v36, v36
mav 192,68,52
mav 196,76,52
v_exp_f32 v37, v37
mav 196,72,48
rda 244,7,29696
v_cvt_pk_bf16_f32 v58, v36, v37
mav 200,80,48
v_exp_f32 v38, v38
mav 200,84,52
mav 204,92,52
v_exp_f32 v39, v39
mav 204,88,48
rda 248,7,30720
v_cvt_pk_bf16_f32 v59, v38, v39
mav 208,96,48
s_waitcnt lgkmcnt(7)
v_exp_f32 v40, v40
mav 208,100,52
v_add_f32 v22, v22, v32
mav 212,108,52
v_exp_f32 v41, v41
mav 212,104,48
rda 252,7,31744
v_cvt_pk_bf16_f32 v60, v40, v41
mav 216,112,48
v_exp_f32 v42, v42
mav 216,116,52
v_add_f32 v22, v22, v33
mav 220,124,52
v_exp_f32 v43, v43
mav 220,120,48
v_cvt_pk_bf16_f32 v61, v42, v43
s_mov_b64 exec, 0
s_cmp_eq_u32 s58, 0
s_cbranch_scc1 L_stub18
s_cmp_eq_u32 s58, 1
s_cbranch_scc1 L_stub19
L_walk_b:
s_mov_b64 exec, -1
s_cmp_lg_u32 s81, s61
s_cbranch_scc1 L_c_o16
L_c_o0:
mav0 32,128,64
v_exp_f32 v44, v44
mav 32,132,80
mav 32,136,96
s_waitcnt vmcnt(0) lgkmcnt(0)
s_barrier
v_exp_f32 v45, v45
mav 32,140,112
rda 0,6,0
v_cvt_pk_bf16_f32 v62, v44, v45
mav0 36,156,112
v_exp_f32 v46, v46
mav 36,152,96
buffer_load_dwordx2 v[18:19], v8, s[48:51], 0 offen offset:256 sc1
mav 36,148,80
v_exp_f32 v47, v47
mav 36,144,64
rda 4,6,1024
v_cvt_pk_bf16_f32 v63, v46, v47
mav0 40,160,64
v_exp_f32 v32, v32
mav 40,164,80
v_min_u32 v9, 31, v0
v_lshl_add_u32 v9, v9, 7, s43
mav 40,168,96
v_exp_f32 v33, v33
mav 40,172,112
rda 8,6,2048
v_cvt_pk_bf16_f32 v48, v32, v33
mav0 44,188,112
v_exp_f32 v34, v34
mav 44,184,96
buffer_load_dword v28, v9, s[36:39], s41 offen
v_lshl_add_u32 v9, v0, 7, s43
v_mov_b64 v[32:33], 0
mav 44,180,80
v_exp_f32 v35, v35
mav 44,176,64
rda 12,6,3072
v_cvt_pk_bf16_f32 v49, v34, v35
v_smfmac_f32_16x16x64_bf16 v[32:35], v[24:27], v[56:63], v11
mav 224,64,56
v_exp_f32 v36, v36
mav 224,68,60
buffer_load_dword v28, v9, s[24:27], s42 offen
v_min_u32 v9, 9, v0
mav 228,76,60
v_exp_f32 v37, v37
mav 228,72,56
rda 16,6,4096
v_cvt_pk_bf16_f32 v50, v36, v37
mav 232,80,56
v_exp_f32 v38, v38
mav 232,84,60
v_lshl_add_u32 v9, v9, 7, s43
mav 236,92,60
v_exp_f32 v39, v39
mav 236,88,56
rda 20,6,5120
v_cvt_pk_bf16_f32 v51, v38, v39
mav 240,96,56
v_exp_f32 v40, v40
mav 240,100,60
buffer_load_dword v28, v9, s[24:27], s20 offen
v_add_f32 v23, v23, v32
mav 244,108,60
v_exp_f32 v41, v41
mav 244,104,56
rda 24,6,6144
v_cvt_pk_bf16_f32 v52, v40, v41
mav 248,112,56
v_exp_f32 v42, v42
mav 248,116,60
v_add_f32 v23, v23, v33
v_lshrrev_b32 v3, 3, v0
mav 252,124,60
v_exp_f32 v43, v43
mav 252,120,56
rda 28,6,7168
v_cvt_pk_bf16_f32 v53, v42, v43
mav0 32,128,68
v_exp_f32 v44, v44
mav 32,132,84
v_bfe_u32 v4, v0, 1, 2
v_lshrrev_b32 v5, 4, v0
mav 32,136,100
v_exp_f32 v45, v45
mav 32,140,116
rda 32,6,8192
v_cvt_pk_bf16_f32 v54, v44, v45
mav0 36,156,116
v_exp_f32 v46, v46
mav 36,152,100
v_xor_b32 v4, v4, v5
v_lshlrev_b32 v4, 5, v4
mav 36,148,84
v_exp_f32 v47, v47
mav 36,144,68
rda 36,6,9216
v_cvt_pk_bf16_f32 v55, v46, v47
mav0 40,160,68
v_exp_f32 v32, v32
mav 40,164,84
v_lshl_add_u32 v3, v3, 10, v4
v_and_b32 v4, 1, v0
mav 40,168,100
v_exp_f32 v33, v33
mav 40,172,116
rda 40,6,10240
v_cvt_pk_bf16_f32 v56, v32, v33
mav0 44,188,116
v_exp_f32 v34, v34
mav 44,184,100
v_mov_b64 v[32:33], 0
v_lshl_add_u32 v2, v4, 4, v3
mav 44,180,84
v_exp_f32 v35, v35
mav 44,176,68
rda 44,6,11264
v_cvt_pk_bf16_f32 v57, v34, v35
v_smfmac_f32_16x16x64_bf16 v[32:35], v[24:27], v[48:55], v11
mav 128,192,48
v_exp_f32 v36, v36
mav 128,196,52
v_add_u32 v3, 7168, v2
v_add_u32 v4, 14336, v2
mav 132,204,52
v_exp_f32 v37, v37
mav 132,200,48
rda 48,6,12288
v_cvt_pk_bf16_f32 v58, v36, v37
mav 136,208,48
v_exp_f32 v38, v38
mav 136,212,52
v_add_u32 v5, 21504, v2
mav 140,220,52
v_exp_f32 v39, v39
mav 140,216,48
rda 52,6,13312
v_cvt_pk_bf16_f32 v59, v38, v39
mav 144,224,48
v_exp_f32 v40, v40
mav 144,228,52
v_add_f32 v20, v20, v32
mav 148,236,52
v_exp_f32 v41, v41
mav 148,232,48
rda 56,6,14336
v_cvt_pk_bf16_f32 v60, v40, v41
mav 152,240,48
v_exp_f32 v42, v42
mav 152,244,52
v_add_f32 v20, v20, v33
mav 156,252,52
v_exp_f32 v43, v43
mav 156,248,48
rda 60,6,15360
v_cvt_pk_bf16_f32 v61, v42, v43
mav0 32,128,72
v_exp_f32 v44, v44
mav 32,132,88
mav 32,136,104
v_exp_f32 v45, v45
mav 32,140,120
rda 64,6,16384
v_cvt_pk_bf16_f32 v62, v44, v45
mav0 36,156,120
v_exp_f32 v46, v46
mav 36,152,104
mav 36,148,88
v_exp_f32 v47, v47
mav 36,144,72
rda 68,6,17408
v_cvt_pk_bf16_f32 v63, v46, v47
mav0 40,160,72
v_exp_f32 v32, v32
mav 40,164,88
mav 40,168,104
v_exp_f32 v33, v33
mav 40,172,120
rda 72,6,18432
v_cvt_pk_bf16_f32 v48, v32, v33
mav0 44,188,120
v_exp_f32 v34, v34
mav 44,184,104
v_mov_b64 v[32:33], 0
mav 44,180,88
v_exp_f32 v35, v35
mav 44,176,72
rda 76,6,19456
v_cvt_pk_bf16_f32 v49, v34, v35
v_smfmac_f32_16x16x64_bf16 v[32:35], v[24:27], v[56:63], v11
mav 160,192,56
v_exp_f32 v36, v36
mav 160,196,60
mav 164,204,60
v_exp_f32 v37, v37
mav 164,200,56
rda 80,6,20480
v_cvt_pk_bf16_f32 v50, v36, v37
mav 168,208,56
v_exp_f32 v38, v38
mav 168,212,60
mav 172,220,60
v_exp_f32 v39, v39
mav 172,216,56
rda 84,6,21504
v_cvt_pk_bf16_f32 v51, v38, v39
mav 176,224,56
v_exp_f32 v40, v40
mav 176,228,60
v_add_f32 v21, v21, v32
mav 180,236,60
v_exp_f32 v41, v41
mav 180,232,56
rda 88,6,22528
v_cvt_pk_bf16_f32 v52, v40, v41
mav 184,240,56
v_exp_f32 v42, v42
mav 184,244,60
v_add_f32 v21, v21, v33
mav 188,252,60
v_exp_f32 v43, v43
mav 188,248,56
rda 92,6,23552
v_cvt_pk_bf16_f32 v53, v42, v43
mav0 32,128,76
v_exp_f32 v44, v44
mav 32,132,92
rda 96,6,24576
mav 32,136,108
v_exp_f32 v45, v45
mav 32,140,124
rda 100,6,25600
v_cvt_pk_bf16_f32 v54, v44, v45
mav0 36,156,124
s_add_u32 s81, s81, 1
v_exp_f32 v46, v46
mav 36,152,108
mav 36,148,92
s_cmp_eq_u32 s81, s82
v_exp_f32 v47, v47
mav 36,144,76
rda 104,6,26624
v_cvt_pk_bf16_f32 v55, v46, v47
mav0 40,160,76
v_exp_f32 v32, v32
mav 40,164,92
mav 40,168,108
v_exp_f32 v33, v33
mav 40,172,124
rda 108,6,27648
v_cvt_pk_bf16_f32 v56, v32, v33
mav0 44,188,124
v_exp_f32 v34, v34
mav 44,184,108
v_mov_b64 v[32:33], 0
mav 44,180,92
v_exp_f32 v35, v35
mav 44,176,76
rda 112,6,28672
v_cvt_pk_bf16_f32 v57, v34, v35
v_smfmac_f32_16x16x64_bf16 v[32:35], v[24:27], v[48:55], v11
mav 192,192,48
v_exp_f32 v36, v36
mav 192,196,52
mav 196,204,52
v_exp_f32 v37, v37
mav 196,200,48
rda 116,6,29696
v_cvt_pk_bf16_f32 v58, v36, v37
mav 200,208,48
v_exp_f32 v38, v38
mav 200,212,52
mav 204,220,52
v_exp_f32 v39, v39
mav 204,216,48
rda 120,6,30720
v_cvt_pk_bf16_f32 v59, v38, v39
mav 208,224,48
s_waitcnt lgkmcnt(7)
v_exp_f32 v40, v40
mav 208,228,52
v_add_f32 v22, v22, v32
mav 212,236,52
v_exp_f32 v41, v41
mav 212,232,48
rda 124,6,31744
v_cvt_pk_bf16_f32 v60, v40, v41
mav 216,240,48
v_exp_f32 v42, v42
mav 216,244,52
v_add_f32 v22, v22, v33
mav 220,252,52
v_exp_f32 v43, v43
mav 220,248,48
v_cvt_pk_bf16_f32 v61, v42, v43
s_cbranch_scc1 L_c_de0
L_c_e0:
mav0 32,0,64
v_exp_f32 v44, v44
mav 32,4,80
mav 32,8,96
s_waitcnt vmcnt(3) lgkmcnt(0)
s_cmp_lg_u32 s58, 2
s_cbranch_scc1 L_slot_back
v_cmp_eq_u64 s[92:93], v[18:19], v[16:17]
s_nop 3
s_cmp_eq_u32 s92, 0xffffffff
s_cbranch_scc0 L_slot_spin
L_slot_back:
s_barrier
v_exp_f32 v45, v45
mav 32,12,112
v_cvt_pk_bf16_f32 v62, v44, v45
mav0 36,28,112
s_add_u32 m0, s17, 0
v_exp_f32 v46, v46
mav 36,24,96
buffer_load_dwordx4 v1, s[48:51], s11 offen offset:0 sc1 lds
mav 36,20,80
v_exp_f32 v47, v47
mav 36,16,64
v_cvt_pk_bf16_f32 v63, v46, v47
mav0 40,32,64
v_exp_f32 v32, v32
mav 40,36,80
buffer_load_dwordx4 v1, s[48:51], s11 offen offset:1024 sc1 lds
mav 40,40,96
v_exp_f32 v33, v33
mav 40,44,112
v_cvt_pk_bf16_f32 v48, v32, v33
mav0 44,60,112
v_exp_f32 v34, v34
mav 44,56,96
buffer_load_dwordx4 v1, s[48:51], s11 offen offset:2048 sc1 lds
v_mov_b64 v[32:33], 0
mav 44,52,80
v_exp_f32 v35, v35
mav 44,48,64
v_cvt_pk_bf16_f32 v49, v34, v35
v_smfmac_f32_16x16x64_bf16 v[32:35], v[24:27], v[56:63], v11
mav 224,192,56
v_exp_f32 v36, v36
mav 224,196,60
buffer_load_dwordx4 v1, s[48:51], s11 offen offset:3072 sc1 lds
mav 228,204,60
s_add_u32 s11, s11, 8192
v_exp_f32 v37, v37
mav 228,200,56
v_cvt_pk_bf16_f32 v50, v36, v37
mav 232,208,56
s_add_u32 m0, s17, 16384
v_exp_f32 v38, v38
mav 232,212,60
buffer_load_dwordx4 v2, s[36:39], s16 offen offset:0 lds
mav 236,220,60
v_exp_f32 v39, v39
mav 236,216,56
v_cvt_pk_bf16_f32 v51, v38, v39
mav 240,224,56
v_exp_f32 v40, v40
mav 240,228,60
buffer_load_dwordx4 v3, s[36:39], s16 offen offset:1024 lds
v_add_f32 v23, v23, v32
mav 244,236,60
v_exp_f32 v41, v41
mav 244,232,56
v_cvt_pk_bf16_f32 v52, v40, v41
mav 248,240,56
v_exp_f32 v42, v42
mav 248,244,60
buffer_load_dwordx4 v4, s[36:39], s16 offen offset:2048 lds
v_add_f32 v23, v23, v33
mav 252,252,60
v_exp_f32 v43, v43
mav 252,248,56
v_cvt_pk_bf16_f32 v53, v42, v43
mav0 32,0,68
v_exp_f32 v44, v44
mav 32,4,84
buffer_load_dwordx4 v5, s[36:39], s16 offen offset:3072 lds
mav 32,8,100
s_add_u32 s16, s16, 65536
v_exp_f32 v45, v45
mav 32,12,116
v_cvt_pk_bf16_f32 v54, v44, v45
mav0 36,28,116
s_add_u32 m0, s17, 32768
v_exp_f32 v46, v46
mav 36,24,100
buffer_load_dwordx4 v1, s[48:51], s11 offen offset:0 sc1 lds
mav 36,20,84
v_exp_f32 v47, v47
mav 36,16,68
v_cvt_pk_bf16_f32 v55, v46, v47
mav0 40,32,68
v_exp_f32 v32, v32
mav 40,36,84
buffer_load_dwordx4 v1, s[48:51], s11 offen offset:1024 sc1 lds
mav 40,40,100
v_exp_f32 v33, v33
mav 40,44,116
v_cvt_pk_bf16_f32 v56, v32, v33
mav0 44,60,116
v_exp_f32 v34, v34
mav 44,56,100
buffer_load_dwordx4 v1, s[48:51], s11 offen offset:2048 sc1 lds
v_mov_b64 v[32:33], 0
mav 44,52,84
v_exp_f32 v35, v35
mav 44,48,68
v_cvt_pk_bf16_f32 v57, v34, v35
v_smfmac_f32_16x16x64_bf16 v[32:35], v[24:27], v[48:55], v11
mav 128,64,48
v_exp_f32 v36, v36
mav 128,68,52
buffer_load_dwordx4 v1, s[48:51], s11 offen offset:3072 sc1 lds
mav 132,76,52
s_add_u32 s11, s11, 8192
v_exp_f32 v37, v37
mav 132,72,48
v_cvt_pk_bf16_f32 v58, v36, v37
mav 136,80,48
s_add_u32 m0, s17, 49152
v_exp_f32 v38, v38
mav 136,84,52
buffer_load_dwordx4 v2, s[36:39], s16 offen offset:0 lds
mav 140,92,52
v_exp_f32 v39, v39
mav 140,88,48
L_stub18:
s_cbranch_execz L_stub20
v_cvt_pk_bf16_f32 v59, v38, v39
mav 144,96,48
v_exp_f32 v40, v40
mav 144,100,52
buffer_load_dwordx4 v3, s[36:39], s16 offen offset:1024 lds
v_add_f32 v20, v20, v32
mav 148,108,52
v_exp_f32 v41, v41
mav 148,104,48
v_cvt_pk_bf16_f32 v60, v40, v41
mav 152,112,48
v_exp_f32 v42, v42
mav 152,116,52
buffer_load_dwordx4 v4, s[36:39], s16 offen offset:2048 lds
v_add_f32 v20, v20, v33
mav 156,124,52
v_exp_f32 v43, v43
mav 156,120,48
v_cvt_pk_bf16_f32 v61, v42, v43
mav0 32,0,72
v_exp_f32 v44, v44
mav 32,4,88
buffer_load_dwordx4 v5, s[36:39], s16 offen offset:3072 lds
mav 32,8,104
s_add_u32 s16, s16, 65536
v_exp_f32 v45, v45
mav 32,12,120
v_cvt_pk_bf16_f32 v62, v44, v45
mav0 36,28,120
v_exp_f32 v46, v46
mav 36,24,104
v_add_u32 v18, s23, v1
v_add_u32 v19, s40, v1
mav 36,20,88
s_lshr_b32 s65, s58, 1
v_exp_f32 v47, v47
mav 36,16,72
s_and_b32 s66, s58, 1
v_cvt_pk_bf16_f32 v63, v46, v47
mav0 40,32,72
s_lshl_b32 s67, s65, 13
v_exp_f32 v32, v32
mav 40,36,88
v_add_u32 v9, s67, v1
v_lshrrev_b32 v6, 2, v0
mav 40,40,104
v_exp_f32 v33, v33
mav 40,44,120
v_cvt_pk_bf16_f32 v48, v32, v33
mav0 44,60,120
v_exp_f32 v34, v34
mav 44,56,104
v_mov_b64 v[32:33], 0
v_lshlrev_b32 v6, 7, v6
mav 44,52,88
v_exp_f32 v35, v35
mav 44,48,72
v_cvt_pk_bf16_f32 v49, v34, v35
v_smfmac_f32_16x16x64_bf16 v[32:35], v[24:27], v[56:63], v11
mav 160,64,56
v_exp_f32 v36, v36
mav 160,68,60
v_and_b32 v7, 3, v0
v_lshl_add_u32 v6, v7, 3, v6
mav 164,76,60
v_exp_f32 v37, v37
mav 164,72,56
v_cvt_pk_bf16_f32 v50, v36, v37
mav 168,80,56
v_exp_f32 v38, v38
mav 168,84,60
v_bfe_u32 v7, v0, 3, 2
v_lshl_add_u32 v6, v7, 5, v6
mav 172,92,60
s_lshl_b32 s67, s66, 13
v_exp_f32 v39, v39
mav 172,88,56
s_add_u32 s67, s67, 16384
v_cvt_pk_bf16_f32 v51, v38, v39
mav 176,96,56
v_exp_f32 v40, v40
mav 176,100,60
v_add_f32 v21, v21, v32
v_add_u32 v6, s67, v6
mav 180,108,60
v_exp_f32 v41, v41
mav 180,104,56
v_cvt_pk_bf16_f32 v52, v40, v41
mav 184,112,56
v_exp_f32 v42, v42
mav 184,116,60
v_add_f32 v21, v21, v33
v_xor_b32 v7, 32, v6
mav 188,124,60
v_exp_f32 v43, v43
mav 188,120,56
ds_write_b64 v19, v[20:21]
v_cvt_pk_bf16_f32 v53, v42, v43
mav0 32,0,76
v_exp_f32 v44, v44
mav 32,4,92
ds_write_b128 v18, v[128:131] offset:0
mav 32,8,108
v_exp_f32 v45, v45
mav 32,12,124
ds_write_b128 v18, v[132:135] offset:1024
v_cvt_pk_bf16_f32 v54, v44, v45
mav0 36,28,124
s_add_u32 s81, s81, 1
v_exp_f32 v46, v46
mav 36,24,108
ds_write_b128 v18, v[136:139] offset:2048
mav 36,20,92
v_exp_f32 v47, v47
mav 36,16,76
ds_write_b128 v18, v[140:143] offset:3072
v_cvt_pk_bf16_f32 v55, v46, v47
mav0 40,32,76
v_exp_f32 v32, v32
mav 40,36,92
ds_write_b128 v18, v[144:147] offset:4096
mav 40,40,108
v_exp_f32 v33, v33
mav 40,44,124
ds_write_b128 v18, v[148:151] offset:5120
v_cvt_pk_bf16_f32 v56, v32, v33
mav0 44,60,124
v_exp_f32 v34, v34
mav 44,56,108
ds_write_b128 v18, v[152:155] offset:6144
v_mov_b64 v[32:33], 0
mav 44,52,92
v_exp_f32 v35, v35
mav 44,48,76
ds_write_b128 v18, v[156:159] offset:7168
v_cvt_pk_bf16_f32 v57, v34, v35
v_smfmac_f32_16x16x64_bf16 v[32:35], v[24:27], v[48:55], v11
mav 192,64,48
v_exp_f32 v36, v36
mav 192,68,52
ds_write_b128 v18, v[160:163] offset:8192
mav 196,76,52
v_exp_f32 v37, v37
mav 196,72,48
ds_write_b128 v18, v[164:167] offset:9216
v_cvt_pk_bf16_f32 v58, v36, v37
mav 200,80,48
v_exp_f32 v38, v38
mav 200,84,52
ds_write_b128 v18, v[168:171] offset:10240
mav 204,92,52
v_exp_f32 v39, v39
mav 204,88,48
ds_write_b128 v18, v[172:175] offset:11264
v_cvt_pk_bf16_f32 v59, v38, v39
mav 208,96,48
v_exp_f32 v40, v40
mav 208,100,52
ds_write_b128 v18, v[176:179] offset:12288
v_add_f32 v22, v22, v32
mav 212,108,52
v_exp_f32 v41, v41
mav 212,104,48
ds_write_b128 v18, v[180:183] offset:13312
v_cvt_pk_bf16_f32 v60, v40, v41
mav 216,112,48
v_exp_f32 v42, v42
mav 216,116,52
ds_write_b128 v18, v[184:187] offset:14336
v_add_f32 v22, v22, v33
mav 220,124,52
v_exp_f32 v43, v43
mav 220,120,48
ds_write_b128 v18, v[188:191] offset:15360
v_cvt_pk_bf16_f32 v61, v42, v43
L_c_fin:
v_exp_f32 v44, v44
v_exp_f32 v45, v45
v_exp_f32 v46, v46
v_exp_f32 v47, v47
v_mov_b64 v[32:33], 0
v_cvt_pk_bf16_f32 v62, v44, v45
v_cvt_pk_bf16_f32 v63, v46, v47
s_nop 1
v_smfmac_f32_16x16x64_bf16 v[32:35], v[24:27], v[56:63], v11
v_add_u32 v37, s22, v1
v_add_u32 v36, s21, v1
s_waitcnt lgkmcnt(0)
s_barrier
ds_read_b64 v[20:21], v37
mav 224,64,56
ds_read_b128 v[128:131], v36 offset:0
s_add_u32 m0, s17, 131072
mav 224,68,60
buffer_load_dwordx4 v1, s[48:51], s11 offen offset:0 sc1 lds
ds_read_b128 v[132:135], v36 offset:1024
mav 228,76,60
ds_read_b128 v[136:139], v36 offset:2048
mav 228,72,56
buffer_load_dwordx4 v1, s[48:51], s11 offen offset:1024 sc1 lds
ds_read_b128 v[140:143], v36 offset:3072
mav 232,80,56
ds_read_b128 v[144:147], v36 offset:4096
s_waitcnt lgkmcnt(5)
mav 232,84,60
buffer_load_dwordx4 v1, s[48:51], s11 offen offset:2048 sc1 lds
ds_read_b128 v[148:151], v36 offset:5120
mav 236,92,60
ds_read_b128 v[152:155], v36 offset:6144
v_add_f32 v22, v22, v20
mav 236,88,56
buffer_load_dwordx4 v1, s[48:51], s11 offen offset:3072 sc1 lds
ds_read_b128 v[156:159], v36 offset:7168
mav 240,96,56
ds_read_b128 v[160:163], v36 offset:8192
s_add_u32 s11, s11, 8192
mav 240,100,60
ds_read_b128 v[164:167], v36 offset:9216
s_add_u32 m0, s17, 147456
s_nop 0
buffer_load_dwordx4 v2, s[36:39], s16 offen offset:0 lds
mav 244,108,60
ds_read_b128 v[168:171], v36 offset:10240
v_add_f32 v23, v23, v21
mav 244,104,56
buffer_load_dwordx4 v3, s[36:39], s16 offen offset:1024 lds
ds_read_b128 v[172:175], v36 offset:11264
mav 248,112,56
ds_read_b128 v[176:179], v36 offset:12288
v_add_f32 v23, v23, v32
mav 248,116,60
buffer_load_dwordx4 v4, s[36:39], s16 offen offset:2048 lds
ds_read_b128 v[180:183], v36 offset:13312
mav 252,124,60
ds_read_b128 v[184:187], v36 offset:14336
v_add_f32 v23, v23, v33
mav 252,120,56
buffer_load_dwordx4 v5, s[36:39], s16 offen offset:3072 lds
s_add_u32 s16, s16, 65536
ds_read_b128 v[188:191], v36 offset:15360
s_mov_b32 s65, 0x1f800000
v_mov_b32 v42, 0x5f800000
v_med3_f32 v38, v22, s65, v42
v_med3_f32 v39, v23, s65, v42
v_cmp_neq_f32 vcc, v38, v22
v_cmp_neq_f32 s[94:95], v39, v23
s_nop 3
s_or_b64 vcc, vcc, s[94:95]
s_cbranch_scc1 L_fin_redo
L_fin_ok:
v_rcp_f32 v22, v22
v_rcp_f32 v23, v23
s_waitcnt vmcnt(8) lgkmcnt(0)
s_barrier
v_xor_b32 v27, 64, v6
v_xor_b32 v28, 96, v6
s_add_u32 m0, s17, 65536
s_nop 0
buffer_load_dwordx4 v1, s[48:51], s11 offen offset:0 sc1 lds
buffer_load_dwordx4 v1, s[48:51], s11 offen offset:1024 sc1 lds
rda 128,9,0
rda 132,9,4096
rda 136,9,1024
s_add_u32 s65, s64, 0
v_pk_add_f32 v[192:193], v[192:193], v[128:129]
v_pk_add_f32 v[194:195], v[194:195], v[130:131]
v_pk_add_f32 v[196:197], v[196:197], v[132:133]
v_pk_add_f32 v[198:199], v[198:199], v[134:135]
v_pk_mul_f32 v[192:193], v[192:193], v[22:23] op_sel:[0,0] op_sel_hi:[1,0]
v_pk_mul_f32 v[194:195], v[194:195], v[22:23] op_sel:[0,0] op_sel_hi:[1,0]
v_pk_mul_f32 v[196:197], v[196:197], v[22:23] op_sel:[0,0] op_sel_hi:[1,0]
v_pk_mul_f32 v[198:199], v[198:199], v[22:23] op_sel:[0,0] op_sel_hi:[1,0]
v_cvt_pk_bf16_f32 v192, v192, v193
v_cvt_pk_bf16_f32 v193, v194, v195
v_cvt_pk_bf16_f32 v194, v196, v197
v_cvt_pk_bf16_f32 v195, v198, v199
buffer_store_dwordx4 v[192:195], v1, s[48:51], s65 offen offset:2048 sc1
buffer_load_dwordx4 v1, s[48:51], s11 offen offset:2048 sc1 lds
buffer_load_dwordx4 v1, s[48:51], s11 offen offset:3072 sc1 lds
s_add_u32 s11, s11, 8192
rda 140,9,5120
rda 144,9,2048
rda 148,9,6144
s_add_u32 s65, s64, 4096
v_pk_add_f32 v[200:201], v[200:201], v[136:137]
v_pk_add_f32 v[202:203], v[202:203], v[138:139]
v_pk_add_f32 v[204:205], v[204:205], v[140:141]
v_pk_add_f32 v[206:207], v[206:207], v[142:143]
v_pk_mul_f32 v[200:201], v[200:201], v[22:23] op_sel:[0,0] op_sel_hi:[1,0]
v_pk_mul_f32 v[202:203], v[202:203], v[22:23] op_sel:[0,0] op_sel_hi:[1,0]
v_pk_mul_f32 v[204:205], v[204:205], v[22:23] op_sel:[0,0] op_sel_hi:[1,0]
v_pk_mul_f32 v[206:207], v[206:207], v[22:23] op_sel:[0,0] op_sel_hi:[1,0]
v_cvt_pk_bf16_f32 v200, v200, v201
v_cvt_pk_bf16_f32 v201, v202, v203
v_cvt_pk_bf16_f32 v202, v204, v205
v_cvt_pk_bf16_f32 v203, v206, v207
buffer_store_dwordx4 v[200:203], v1, s[48:51], s65 offen offset:2048 sc1
s_add_u32 m0, s17, 81920
s_nop 0
buffer_load_dwordx4 v2, s[36:39], s16 offen offset:0 lds
buffer_load_dwordx4 v3, s[36:39], s16 offen offset:1024 lds
rda 152,9,3072
rda 156,9,7168
tra 160,6,0
s_add_u32 s65, s64, 8192
v_pk_add_f32 v[208:209], v[208:209], v[144:145]
v_pk_add_f32 v[210:211], v[210:211], v[146:147]
v_pk_add_f32 v[212:213], v[212:213], v[148:149]
v_pk_add_f32 v[214:215], v[214:215], v[150:151]
v_pk_mul_f32 v[208:209], v[208:209], v[22:23] op_sel:[0,0] op_sel_hi:[1,0]
v_pk_mul_f32 v[210:211], v[210:211], v[22:23] op_sel:[0,0] op_sel_hi:[1,0]
v_pk_mul_f32 v[212:213], v[212:213], v[22:23] op_sel:[0,0] op_sel_hi:[1,0]
v_pk_mul_f32 v[214:215], v[214:215], v[22:23] op_sel:[0,0] op_sel_hi:[1,0]
v_cvt_pk_bf16_f32 v208, v208, v209
v_cvt_pk_bf16_f32 v209, v210, v211
v_cvt_pk_bf16_f32 v210, v212, v213
v_cvt_pk_bf16_f32 v211, v214, v215
buffer_store_dwordx4 v[208:211], v1, s[48:51], s65 offen offset:2048 sc1
buffer_load_dwordx4 v4, s[36:39], s16 offen offset:2048 lds
buffer_load_dwordx4 v5, s[36:39], s16 offen offset:3072 lds
s_add_u32 s16, s16, 65536
tra 162,6,2048
tra 164,6,4096
tra 166,6,6144
s_add_u32 s65, s64, 12288
v_pk_add_f32 v[216:217], v[216:217], v[152:153]
v_pk_add_f32 v[218:219], v[218:219], v[154:155]
v_pk_add_f32 v[220:221], v[220:221], v[156:157]
v_pk_add_f32 v[222:223], v[222:223], v[158:159]
v_pk_mul_f32 v[216:217], v[216:217], v[22:23] op_sel:[0,0] op_sel_hi:[1,0]
v_pk_mul_f32 v[218:219], v[218:219], v[22:23] op_sel:[0,0] op_sel_hi:[1,0]
v_pk_mul_f32 v[220:221], v[220:221], v[22:23] op_sel:[0,0] op_sel_hi:[1,0]
v_pk_mul_f32 v[222:223], v[222:223], v[22:23] op_sel:[0,0] op_sel_hi:[1,0]
v_cvt_pk_bf16_f32 v216, v216, v217
v_cvt_pk_bf16_f32 v217, v218, v219
v_cvt_pk_bf16_f32 v218, v220, v221
v_cvt_pk_bf16_f32 v219, v222, v223
buffer_store_dwordx4 v[216:219], v1, s[48:51], s65 offen offset:2048 sc1
tra 168,7,0
tra 170,7,2048
tra 172,7,4096
tra 174,7,6144
s_add_u32 s65, s64, 0
v_pk_add_f32 v[224:225], v[224:225], v[160:161]
v_pk_add_f32 v[226:227], v[226:227], v[162:163]
v_pk_add_f32 v[228:229], v[228:229], v[164:165]
v_pk_add_f32 v[230:231], v[230:231], v[166:167]
v_pk_mul_f32 v[224:225], v[224:225], v[22:23] op_sel:[0,1] op_sel_hi:[1,1]
v_pk_mul_f32 v[226:227], v[226:227], v[22:23] op_sel:[0,1] op_sel_hi:[1,1]
v_pk_mul_f32 v[228:229], v[228:229], v[22:23] op_sel:[0,1] op_sel_hi:[1,1]
v_pk_mul_f32 v[230:231], v[230:231], v[22:23] op_sel:[0,1] op_sel_hi:[1,1]
v_cvt_pk_bf16_f32 v224, v224, v225
v_cvt_pk_bf16_f32 v225, v226, v227
v_cvt_pk_bf16_f32 v226, v228, v229
v_cvt_pk_bf16_f32 v227, v230, v231
buffer_store_dwordx4 v[224:227], v1, s[48:51], s65 offen offset:3072 sc1
tra 176,27,0
tra 178,27,2048
tra 180,27,4096
tra 182,27,6144
s_add_u32 s65, s64, 4096
v_pk_add_f32 v[232:233], v[232:233], v[168:169]
v_pk_add_f32 v[234:235], v[234:235], v[170:171]
v_pk_add_f32 v[236:237], v[236:237], v[172:173]
v_pk_add_f32 v[238:239], v[238:239], v[174:175]
v_pk_mul_f32 v[232:233], v[232:233], v[22:23] op_sel:[0,1] op_sel_hi:[1,1]
v_pk_mul_f32 v[234:235], v[234:235], v[22:23] op_sel:[0,1] op_sel_hi:[1,1]
v_pk_mul_f32 v[236:237], v[236:237], v[22:23] op_sel:[0,1] op_sel_hi:[1,1]
v_pk_mul_f32 v[238:239], v[238:239], v[22:23] op_sel:[0,1] op_sel_hi:[1,1]
v_cvt_pk_bf16_f32 v232, v232, v233
v_cvt_pk_bf16_f32 v233, v234, v235
v_cvt_pk_bf16_f32 v234, v236, v237
v_cvt_pk_bf16_f32 v235, v238, v239
buffer_store_dwordx4 v[232:235], v1, s[48:51], s65 offen offset:3072 sc1
tra 184,28,0
tra 186,28,2048
tra 188,28,4096
tra 190,28,6144
s_add_u32 s65, s64, 8192
v_pk_add_f32 v[240:241], v[240:241], v[176:177]
v_pk_add_f32 v[242:243], v[242:243], v[178:179]
v_pk_add_f32 v[244:245], v[244:245], v[180:181]
v_pk_add_f32 v[246:247], v[246:247], v[182:183]
v_pk_mul_f32 v[240:241], v[240:241], v[22:23] op_sel:[0,1] op_sel_hi:[1,1]
v_pk_mul_f32 v[242:243], v[242:243], v[22:23] op_sel:[0,1] op_sel_hi:[1,1]
v_pk_mul_f32 v[244:245], v[244:245], v[22:23] op_sel:[0,1] op_sel_hi:[1,1]
v_pk_mul_f32 v[246:247], v[246:247], v[22:23] op_sel:[0,1] op_sel_hi:[1,1]
v_cvt_pk_bf16_f32 v240, v240, v241
v_cvt_pk_bf16_f32 v241, v242, v243
v_cvt_pk_bf16_f32 v242, v244, v245
v_cvt_pk_bf16_f32 v243, v246, v247
buffer_store_dwordx4 v[240:243], v1, s[48:51], s65 offen offset:3072 sc1
s_add_u32 s65, s64, 12288
v_pk_add_f32 v[248:249], v[248:249], v[184:185]
v_pk_add_f32 v[250:251], v[250:251], v[186:187]
v_pk_add_f32 v[252:253], v[252:253], v[188:189]
v_pk_add_f32 v[254:255], v[254:255], v[190:191]
v_pk_mul_f32 v[248:249], v[248:249], v[22:23] op_sel:[0,1] op_sel_hi:[1,1]
v_pk_mul_f32 v[250:251], v[250:251], v[22:23] op_sel:[0,1] op_sel_hi:[1,1]
v_pk_mul_f32 v[252:253], v[252:253], v[22:23] op_sel:[0,1] op_sel_hi:[1,1]
v_pk_mul_f32 v[254:255], v[254:255], v[22:23] op_sel:[0,1] op_sel_hi:[1,1]
v_cvt_pk_bf16_f32 v248, v248, v249
v_cvt_pk_bf16_f32 v249, v250, v251
v_cvt_pk_bf16_f32 v250, v252, v253
v_cvt_pk_bf16_f32 v251, v254, v255
buffer_store_dwordx4 v[248:251], v1, s[48:51], s65 offen offset:3072 sc1
s_waitcnt lgkmcnt(0)
maa0 192,160,128
tra 224,6,32768
s_add_u32 m0, s17, 98304
maa 192,164,132
tra 226,6,34816
v_add_u32 v33, 0x20000, v9
maa0 196,164,140
tra 228,6,36864
v_add_u32 v40, 0x20000, v6
maa 196,160,136
tra 230,6,38912
v_add_u32 v41, 0x20000, v7
maa0 200,160,144
rda 192,9,32768
v_add_u32 v42, 0x20000, v27
maa 200,164,148
rda 196,9,36864
v_add_u32 v43, 0x20000, v28
maa0 204,164,156
rda 200,9,33792
v_add_u32 v32, 0x10000, v9
maa 204,160,152
rda 204,9,37888
v_add_u32 v36, 0x10000, v6
maa0 220,168,152
rda 208,9,34816
v_add_u32 v37, 0x10000, v7
maa 220,172,156
rda 212,9,38912
v_add_u32 v38, 0x10000, v27
maa0 216,172,148
rda 216,9,35840
v_add_u32 v39, 0x10000, v28
maa 216,168,144
rda 220,9,39936
v_lshrrev_b32 v18, 3, v0
maa0 212,168,136
tra 232,7,32768
v_lshlrev_b32 v8, 10, v0
maa 212,172,140
tra 234,7,34816
v_lshl_add_u32 v8, v18, 27, v8
maa0 208,172,132
tra 236,7,36864
v_xor_b32 v8, s59, v8
maa 208,168,128
tra 238,7,38912
s_lshr_b32 s65, s58, 1
maa0 224,176,128
tra 240,27,32768
s_lshl_b32 s67, s8, 1
maa 224,180,132
buffer_load_dwordx4 v1, s[48:51], s11 offen offset:0 sc1 lds
maa0 228,180,140
tra 242,27,34816
s_add_u32 s67, s67, s65
maa 228,176,136
tra 244,27,36864
s_mul_i32 s65, s67, 525312
maa0 232,176,144
tra 246,27,38912
v_add_u32 v34, s65, v1
maa 232,180,148
buffer_load_dwordx4 v1, s[48:51], s11 offen offset:1024 sc1 lds
maa0 236,180,156
tra 248,28,32768
s_lshl_b32 s67, s67, 8
maa 236,176,152
tra 250,28,34816
s_add_u32 s84, s67, 58720256
maa0 252,184,152
tra 252,28,36864
v_and_b32 v60, 15, v0
maa 252,188,156
buffer_load_dwordx4 v1, s[48:51], s11 offen offset:2048 sc1 lds
maa0 248,188,148
tra 254,28,38912
v_lshlrev_b32 v61, 2, v60
maa 248,184,144
maa0 244,184,136
maa 244,188,140
buffer_load_dwordx4 v1, s[48:51], s11 offen offset:3072 sc1 lds
maa0 240,188,132
s_add_u32 s11, s11, 8192
s_add_u32 m0, s17, 114688
maa 240,184,128
s_waitcnt vmcnt(20) lgkmcnt(0)
s_barrier
maa 192,224,192
tra 160,40,0
tra 162,40,2048
maa 192,228,196
buffer_load_dwordx4 v2, s[36:39], s16 offen offset:0 lds
maa 196,228,204
tra 164,40,4096
tra 166,40,6144
maa 196,224,200
rda 128,33,0
maa 200,224,208
rda 132,33,4096
maa 200,228,212
buffer_load_dwordx4 v3, s[36:39], s16 offen offset:1024 lds
maa 204,228,220
rda 136,33,1024
maa 204,224,216
rda 140,33,5120
maa 220,232,216
rda 144,33,2048
maa 220,236,220
buffer_load_dwordx4 v4, s[36:39], s16 offen offset:2048 lds
maa 216,236,212
rda 148,33,6144
maa 216,232,208
rda 152,33,3072
maa 212,232,200
rda 156,33,7168
maa 212,236,204
buffer_load_dwordx4 v5, s[36:39], s16 offen offset:3072 lds
maa 208,236,196
tra 168,41,0
s_add_u32 s16, s16, 65536
maa 208,232,192
tra 170,41,2048
s_add_u32 m0, s17, 0
maa 224,240,192
tra 172,41,4096
maa 224,244,196
buffer_load_dwordx4 v1, s[48:51], s11 offen offset:0 sc1 lds
maa 228,244,204
tra 174,41,6144
tra 176,42,0
maa 228,240,200
tra 178,42,2048
tra 180,42,4096
maa 232,240,208
tra 182,42,6144
maa 232,244,212
buffer_load_dwordx4 v1, s[48:51], s11 offen offset:1024 sc1 lds
maa 236,244,220
tra 184,43,0
maa 236,240,216
tra 186,43,2048
maa 252,248,216
tra 188,43,4096
maa 252,252,220
buffer_load_dwordx4 v1, s[48:51], s11 offen offset:2048 sc1 lds
maa 248,252,212
tra 190,43,6144
maa 248,248,208
maa 244,248,200
maa 244,252,204
buffer_load_dwordx4 v1, s[48:51], s11 offen offset:3072 sc1 lds
maa 240,252,196
s_add_u32 s11, s11, 8192
maa 240,248,192
s_waitcnt vmcnt(12) lgkmcnt(0)
s_barrier
maa 192,160,128
tra 224,36,0
tra 226,36,2048
maa 192,164,132
buffer_store_dwordx2 v[16:17], v29, s[48:51], 0 offen offset:0 sc1
maa 196,164,140
tra 228,36,4096
L_stub19:
s_cbranch_execz L_stub21
tra 230,36,6144
maa 196,160,136
s_add_u32 m0, s17, 16384
s_nop 0
buffer_load_dwordx4 v2, s[36:39], s16 offen offset:0 lds
maa 200,160,144
rda 192,32,0
maa 200,164,148
buffer_load_dwordx4 v3, s[36:39], s16 offen offset:1024 lds
maa 204,164,156
rda 196,32,4096
maa 204,160,152
rda 200,32,1024
maa 220,168,152
buffer_load_dwordx4 v4, s[36:39], s16 offen offset:2048 lds
maa 220,172,156
rda 204,32,5120
maa 216,172,148
buffer_load_dwordx4 v5, s[36:39], s16 offen offset:3072 lds
maa 216,168,144
rda 208,32,2048
s_add_u32 s16, s16, 65536
maa 212,168,136
s_add_u32 m0, s17, 32768
s_nop 0
buffer_load_dwordx4 v1, s[48:51], s11 offen offset:0 sc1 lds
maa 212,172,140
rda 212,32,6144
maa 208,172,132
rda 216,32,3072
maa 208,168,128
buffer_load_dwordx4 v1, s[48:51], s11 offen offset:1024 sc1 lds
maa 224,176,128
rda 220,32,7168
maa 224,180,132
buffer_load_dwordx4 v1, s[48:51], s11 offen offset:2048 sc1 lds
maa 228,180,140
tra 232,37,0
tra 234,37,2048
maa 228,176,136
buffer_load_dwordx4 v1, s[48:51], s11 offen offset:3072 sc1 lds
maa 232,176,144
tra 236,37,4096
tra 238,37,6144
maa 232,180,148
tra 240,38,0
tra 242,38,2048
maa 236,180,156
s_add_u32 m0, s17, 49152
s_nop 0
buffer_load_dwordx4 v2, s[36:39], s16 offen offset:0 lds
maa 236,176,152
tra 244,38,4096
tra 246,38,6144
maa 252,184,152
buffer_load_dwordx4 v3, s[36:39], s16 offen offset:1024 lds
maa 252,188,156
tra 248,39,0
tra 250,39,2048
maa 248,188,148
buffer_load_dwordx4 v4, s[36:39], s16 offen offset:2048 lds
maa 248,184,144
tra 252,39,4096
tra 254,39,6144
maa 244,184,136
maa 244,188,140
buffer_load_dwordx4 v5, s[36:39], s16 offen offset:3072 lds
maa 240,188,132
s_add_u32 m0, s17, 131072
maa 240,184,128
s_waitcnt vmcnt(17) lgkmcnt(0)
s_barrier
maa 192,224,192
tra 160,36,32768
tra 162,36,34816
maa 192,228,196
buffer_load_dwordx4 v34, s[48:51], s18 offen offset:0 sc1 lds
maa 196,228,204
tra 164,36,36864
tra 166,36,38912
maa 196,224,200
buffer_load_dwordx4 v34, s[48:51], s18 offen offset:1024 sc1 lds
maa 200,224,208
rda 128,32,32768
maa 200,228,212
rda 132,32,36864
maa 204,228,220
buffer_load_dwordx4 v34, s[48:51], s18 offen offset:2048 sc1 lds
maa 204,224,216
rda 136,32,33792
maa 220,232,216
buffer_load_dwordx4 v34, s[48:51], s18 offen offset:3072 sc1 lds
maa 220,236,220
rda 140,32,37888
s_xor_b32 s18, s18, 0x2000
maa 216,236,212
rda 144,32,34816
s_add_u32 m0, s17, 147456
maa 216,232,208
buffer_load_dwordx4 v2, s[24:27], s19 offen offset:0 lds
maa 212,232,200
rda 148,32,38912
maa 212,236,204
buffer_load_dwordx4 v3, s[24:27], s19 offen offset:1024 lds
maa 208,236,196
rda 152,32,35840
maa 208,232,192
rda 156,32,39936
maa 224,240,192
buffer_load_dwordx4 v4, s[24:27], s19 offen offset:2048 lds
maa 224,244,196
tra 168,37,32768
tra 170,37,34816
maa 228,244,204
buffer_load_dwordx4 v5, s[24:27], s19 offen offset:3072 lds
maa 228,240,200
tra 172,37,36864
tra 174,37,38912
maa 232,240,208
tra 176,38,32768
tra 178,38,34816
maa 232,244,212
s_xor_b32 s19, s19, 0x10000
s_add_u32 m0, s17, 65536
s_nop 0
buffer_load_dwordx4 v34, s[48:51], s18 offen offset:0 sc1 lds
maa 236,244,220
tra 180,38,36864
tra 182,38,38912
maa 236,240,216
buffer_load_dwordx4 v34, s[48:51], s18 offen offset:1024 sc1 lds
maa 252,248,216
tra 184,39,32768
tra 186,39,34816
maa 252,252,220
tra 188,39,36864
tra 190,39,38912
maa 248,252,212
buffer_load_dwordx4 v34, s[48:51], s18 offen offset:2048 sc1 lds
maa 248,248,208
maa 244,248,200
maa 244,252,204
buffer_load_dwordx4 v34, s[48:51], s18 offen offset:3072 sc1 lds
maa 240,252,196
s_xor_b32 s18, s18, 0x6000
s_add_u32 m0, s17, 81920
maa 240,248,192
s_waitcnt vmcnt(20) lgkmcnt(0)
s_barrier
maa 192,160,128
tra 224,6,0
tra 226,6,2048
maa 192,164,132
buffer_load_dwordx4 v2, s[24:27], s19 offen offset:0 lds
maa 196,164,140
tra 228,6,4096
tra 230,6,6144
maa 196,160,136
rda 192,9,0
maa 200,160,144
rda 196,9,4096
maa 200,164,148
buffer_load_dwordx4 v3, s[24:27], s19 offen offset:1024 lds
maa 204,164,156
rda 200,9,1024
maa 204,160,152
rda 204,9,5120
maa 220,168,152
rda 208,9,2048
maa 220,172,156
buffer_load_dwordx4 v4, s[24:27], s19 offen offset:2048 lds
maa 216,172,148
rda 212,9,6144
maa 216,168,144
rda 216,9,3072
maa 212,168,136
rda 220,9,7168
maa 212,172,140
buffer_load_dwordx4 v5, s[24:27], s19 offen offset:3072 lds
maa 208,172,132
tra 232,7,0
s_xor_b32 s19, s19, 0x30000
maa 208,168,128
tra 234,7,2048
s_add_u32 m0, s17, 114688
maa 224,176,128
tra 236,7,4096
maa 224,180,132
buffer_load_dwordx4 v2, s[24:27], s19 offen offset:0 lds
maa 228,180,140
tra 238,7,6144
tra 240,27,0
maa 228,176,136
tra 242,27,2048
tra 244,27,4096
maa 232,176,144
tra 246,27,6144
maa 232,180,148
buffer_load_dwordx4 v3, s[24:27], s19 offen offset:1024 lds
maa 236,180,156
tra 248,28,0
maa 236,176,152
tra 250,28,2048
maa 252,184,152
tra 252,28,4096
maa 252,188,156
buffer_load_dwordx4 v4, s[24:27], s19 offen offset:2048 lds
maa 248,188,148
tra 254,28,6144
maa 248,184,144
maa 244,184,136
maa 244,188,140
buffer_load_dwordx4 v5, s[24:27], s19 offen offset:3072 lds
maa 240,188,132
s_xor_b32 s19, s19, 0x10000
maa 240,184,128
s_waitcnt vmcnt(20) lgkmcnt(0)
s_barrier
maa 192,224,192
tra 160,6,32768
tra 162,6,34816
maa 192,228,196
buffer_load_dwordx2 v[18:19], v8, s[48:51], 0 offen offset:0 sc1
maa 196,228,204
tra 164,6,36864
tra 166,6,38912
maa 196,224,200
rda 128,9,32768
s_add_u32 m0, s17, 16384
maa 200,224,208
buffer_load_dwordx4 v2, s[24:27], s19 offen offset:0 lds
maa 200,228,212
rda 132,9,36864
maa 204,228,220
rda 136,9,33792
maa 204,224,216
rda 140,9,37888
maa 220,232,216
buffer_load_dwordx4 v3, s[24:27], s19 offen offset:1024 lds
maa 220,236,220
rda 144,9,34816
maa 216,236,212
rda 148,9,38912
maa 216,232,208
buffer_load_dwordx4 v4, s[24:27], s19 offen offset:2048 lds
maa 212,232,200
rda 152,9,35840
maa 212,236,204
rda 156,9,39936
maa 208,236,196
tra 168,7,32768
tra 170,7,34816
maa 208,232,192
buffer_load_dwordx4 v5, s[24:27], s19 offen offset:3072 lds
maa 224,240,192
tra 172,7,36864
tra 174,7,38912
maa 224,244,196
tra 176,27,32768
tra 178,27,34816
maa 228,244,204
s_xor_b32 s19, s19, 0x70000
buffer_load_dword v52, v61, s[48:51], s84 offen offset:0 sc1
maa 228,240,200
tra 180,27,36864
maa 232,240,208
tra 182,27,38912
maa 232,244,212
tra 184,28,32768
maa 236,244,220
buffer_load_dword v53, v61, s[48:51], s84 offen offset:64 sc1
maa 236,240,216
tra 186,28,34816
maa 252,248,216
tra 188,28,36864
maa 252,252,220
buffer_load_dword v54, v61, s[48:51], s84 offen offset:128 sc1
maa 248,252,212
tra 190,28,38912
maa 248,248,208
maa 244,248,200
maa 244,252,204
buffer_load_dword v55, v61, s[48:51], s84 offen offset:192 sc1
maa 240,252,196
s_add_u32 m0, s17, 98304
maa 240,248,192
s_waitcnt vmcnt(8) lgkmcnt(0)
s_cmp_lg_u32 s58, 2
s_cbranch_scc1 L_ctx_back
v_cmp_eq_u64 s[92:93], v[18:19], v[16:17]
s_nop 3
s_cmp_eq_u32 s92, 0xff
s_cbranch_scc0 L_ctx_spin
L_ctx_back:
s_barrier
maa 192,160,128
tra 224,40,0
tra 226,40,2048
maa 192,164,132
buffer_load_dwordx4 v34, s[48:51], s18 offen offset:0 sc1 lds
maa 196,164,140
tra 228,40,4096
tra 230,40,6144
maa 196,160,136
buffer_load_dwordx4 v34, s[48:51], s18 offen offset:1024 sc1 lds
maa 200,160,144
rda 192,33,0
maa 200,164,148
rda 196,33,4096
maa 204,164,156
buffer_load_dwordx4 v34, s[48:51], s18 offen offset:2048 sc1 lds
maa 204,160,152
rda 200,33,1024
maa 220,168,152
buffer_load_dwordx4 v34, s[48:51], s18 offen offset:3072 sc1 lds
maa 220,172,156
rda 204,33,5120
s_xor_b32 s18, s18, 0x2000
maa 216,172,148
rda 208,33,2048
s_add_u32 m0, s17, 0
maa 216,168,144
buffer_load_dwordx4 v34, s[48:51], s18 offen offset:0 sc1 lds
maa 212,168,136
rda 212,33,6144
maa 212,172,140
buffer_load_dwordx4 v34, s[48:51], s18 offen offset:1024 sc1 lds
maa 208,172,132
rda 216,33,3072
maa 208,168,128
rda 220,33,7168
maa 224,176,128
buffer_load_dwordx4 v34, s[48:51], s18 offen offset:2048 sc1 lds
maa 224,180,132
tra 232,41,0
tra 234,41,2048
maa 228,180,140
buffer_load_dwordx4 v34, s[48:51], s18 offen offset:3072 sc1 lds
maa 228,176,136
tra 236,41,4096
tra 238,41,6144
maa 232,176,144
tra 240,42,0
tra 242,42,2048
maa 232,180,148
s_xor_b32 s18, s18, 0xe000
s_add_u32 m0, s17, 32768
s_nop 0
buffer_load_dwordx4 v34, s[48:51], s18 offen offset:0 sc1 lds
maa 236,180,156
tra 244,42,4096
tra 246,42,6144
maa 236,176,152
buffer_load_dwordx4 v34, s[48:51], s18 offen offset:1024 sc1 lds
maa 252,184,152
tra 248,43,0
tra 250,43,2048
maa 252,188,156
tra 252,43,4096
tra 254,43,6144
maa 248,188,148
buffer_load_dwordx4 v34, s[48:51], s18 offen offset:2048 sc1 lds
maa 248,184,144
maa 244,184,136
maa 244,188,140
buffer_load_dwordx4 v34, s[48:51], s18 offen offset:3072 sc1 lds
maa 240,188,132
s_xor_b32 s18, s18, 0x2000
s_add_u32 m0, s17, 49152
maa 240,184,128
s_waitcnt lgkmcnt(0)
s_barrier
maa0 128,224,192
tra 160,36,0
tra 162,36,2048
maa 128,228,196
buffer_load_dwordx4 v2, s[24:27], s19 offen offset:0 lds
maa0 132,228,204
tra 164,36,4096
tra 166,36,6144
maa 132,224,200
buffer_load_dwordx4 v3, s[24:27], s19 offen offset:1024 lds
maa0 136,224,208
rda 128,32,0
maa 136,228,212
rda 132,32,4096
maa0 140,228,220
buffer_load_dwordx4 v4, s[24:27], s19 offen offset:2048 lds
maa 140,224,216
rda 136,32,1024
maa0 156,232,216
buffer_load_dwordx4 v5, s[24:27], s19 offen offset:3072 lds
maa 156,236,220
rda 140,32,5120
s_xor_b32 s19, s19, 0x10000
maa0 152,236,212
rda 144,32,2048
s_add_u32 m0, s17, 131072
maa 152,232,208
buffer_load_dwordx4 v34, s[48:51], s18 offen offset:0 sc1 lds
maa0 148,232,200
rda 148,32,6144
maa 148,236,204
buffer_load_dwordx4 v34, s[48:51], s18 offen offset:1024 sc1 lds
maa0 144,236,196
rda 152,32,3072
maa 144,232,192
rda 156,32,7168
maa0 160,240,192
buffer_load_dwordx4 v34, s[48:51], s18 offen offset:2048 sc1 lds
maa 160,244,196
tra 168,37,0
tra 170,37,2048
maa0 164,244,204
buffer_load_dwordx4 v34, s[48:51], s18 offen offset:3072 sc1 lds
maa 164,240,200
tra 172,37,4096
tra 174,37,6144
maa0 168,240,208
tra 176,38,0
tra 178,38,2048
maa 168,244,212
s_xor_b32 s18, s18, 0x6000
s_add_u32 m0, s17, 147456
s_nop 0
buffer_load_dwordx4 v2, s[24:27], s19 offen offset:0 lds
maa0 172,244,220
tra 180,38,4096
tra 182,38,6144
maa 172,240,216
buffer_load_dwordx4 v3, s[24:27], s19 offen offset:1024 lds
maa0 188,248,216
tra 184,39,0
tra 186,39,2048
maa 188,252,220
tra 188,39,4096
tra 190,39,6144
maa0 184,252,212
buffer_load_dwordx4 v4, s[24:27], s19 offen offset:2048 lds
maa 184,248,208
maa0 180,248,200
maa 180,252,204
buffer_load_dwordx4 v5, s[24:27], s19 offen offset:3072 lds
maa0 176,252,196
s_xor_b32 s19, s19, 0x30000
s_add_u32 m0, s17, 65536
maa 176,248,192
s_waitcnt vmcnt(20) lgkmcnt(0)
s_barrier
maa 128,160,128
tra 224,36,32768
tra 226,36,34816
maa 128,164,132
buffer_load_dwordx4 v34, s[48:51], s18 offen offset:0 sc1 lds
maa 132,164,140
tra 228,36,36864
tra 230,36,38912
maa 132,160,136
rda 192,32,32768
maa 136,160,144
rda 196,32,36864
maa 136,164,148
buffer_load_dwordx4 v34, s[48:51], s18 offen offset:1024 sc1 lds
maa 140,164,156
rda 200,32,33792
maa 140,160,152
rda 204,32,37888
maa 156,168,152
rda 208,32,34816
maa 156,172,156
buffer_load_dwordx4 v34, s[48:51], s18 offen offset:2048 sc1 lds
maa 152,172,148
rda 212,32,38912
maa 152,168,144
rda 216,32,35840
maa 148,168,136
rda 220,32,39936
maa 148,172,140
buffer_load_dwordx4 v34, s[48:51], s18 offen offset:3072 sc1 lds
maa 144,172,132
tra 232,37,32768
s_xor_b32 s18, s18, 0x2000
maa 144,168,128
tra 234,37,34816
s_add_u32 m0, s17, 81920
maa 160,176,128
tra 236,37,36864
maa 160,180,132
buffer_load_dwordx4 v2, s[24:27], s19 offen offset:0 lds
maa 164,180,140
tra 238,37,38912
tra 240,38,32768
maa 164,176,136
tra 242,38,34816
tra 244,38,36864
maa 168,176,144
tra 246,38,38912
maa 168,180,148
buffer_load_dwordx4 v3, s[24:27], s19 offen offset:1024 lds
maa 172,180,156
tra 248,39,32768
maa 172,176,152
tra 250,39,34816
maa 188,184,152
tra 252,39,36864
maa 188,188,156
buffer_load_dwordx4 v4, s[24:27], s19 offen offset:2048 lds
maa 184,188,148
tra 254,39,38912
maa 184,184,144
maa 180,184,136
maa 180,188,140
buffer_load_dwordx4 v5, s[24:27], s19 offen offset:3072 lds
maa 176,188,132
s_xor_b32 s19, s19, 0x10000
s_add_u32 m0, s17, 98304
maa 176,184,128
s_waitcnt vmcnt(24) lgkmcnt(0)
s_barrier
maa 128,224,192
tra 160,6,0
tra 162,6,2048
maa 128,228,196
buffer_load_dwordx4 v34, s[48:51], s18 offen offset:0 sc1 lds
maa 132,228,204
L_stub20:
s_cbranch_execz L_stub22
tra 164,6,4096
tra 166,6,6144
maa 132,224,200
rda 128,9,0
maa 136,224,208
rda 132,9,4096
maa 136,228,212
buffer_load_dwordx4 v34, s[48:51], s18 offen offset:1024 sc1 lds
maa 140,228,220
rda 136,9,1024
maa 140,224,216
rda 140,9,5120
maa 156,232,216
rda 144,9,2048
maa 156,236,220
buffer_load_dwordx4 v34, s[48:51], s18 offen offset:2048 sc1 lds
maa 152,236,212
rda 148,9,6144
maa 152,232,208
rda 152,9,3072
maa 148,232,200
rda 156,9,7168
maa 148,236,204
buffer_load_dwordx4 v34, s[48:51], s18 offen offset:3072 sc1 lds
maa 144,236,196
tra 168,7,0
s_xor_b32 s18, s18, 0x1e000
maa 144,232,192
tra 170,7,2048
s_add_u32 m0, s17, 114688
maa 160,240,192
tra 172,7,4096
maa 160,244,196
buffer_load_dwordx4 v2, s[24:27], s19 offen offset:0 lds
maa 164,244,204
tra 174,7,6144
tra 176,27,0
maa 164,240,200
tra 178,27,2048
tra 180,27,4096
maa 168,240,208
tra 182,27,6144
maa 168,244,212
buffer_load_dwordx4 v3, s[24:27], s19 offen offset:1024 lds
maa 172,244,220
tra 184,28,0
maa 172,240,216
tra 186,28,2048
maa 188,248,216
tra 188,28,4096
maa 188,252,220
buffer_load_dwordx4 v4, s[24:27], s19 offen offset:2048 lds
maa 184,252,212
tra 190,28,6144
maa 184,248,208
maa 180,248,200
maa 180,252,204
buffer_load_dwordx4 v5, s[24:27], s19 offen offset:3072 lds
maa 176,252,196
s_xor_b32 s19, s19, 0xf0000
s_add_u32 m0, s17, 0
maa 176,248,192
s_waitcnt vmcnt(24) lgkmcnt(0)
s_barrier
maa 128,160,128
tra 224,6,32768
tra 226,6,34816
maa 128,164,132
buffer_load_dwordx4 v34, s[48:51], s18 offen offset:0 sc1 lds
maa 132,164,140
tra 228,6,36864
tra 230,6,38912
maa 132,160,136
rda 192,9,32768
v_sub_f32 v56, 1.0, v52
maa 136,160,144
rda 196,9,36864
v_sub_f32 v57, 1.0, v53
maa 136,164,148
buffer_load_dwordx4 v34, s[48:51], s18 offen offset:1024 sc1 lds
maa 140,164,156
rda 200,9,33792
v_sub_f32 v58, 1.0, v54
maa 140,160,152
rda 204,9,37888
v_sub_f32 v59, 1.0, v55
maa 156,168,152
rda 208,9,34816
v_mul_f32 v192, v56, v192
maa 156,172,156
buffer_load_dwordx4 v34, s[48:51], s18 offen offset:2048 sc1 lds
maa 152,172,148
rda 212,9,38912
v_mul_f32 v193, v56, v193
maa 152,168,144
rda 216,9,35840
v_mul_f32 v194, v56, v194
maa 148,168,136
rda 220,9,39936
v_mul_f32 v195, v56, v195
maa 148,172,140
buffer_load_dwordx4 v34, s[48:51], s18 offen offset:3072 sc1 lds
maa 144,172,132
tra 232,7,32768
s_xor_b32 s18, s18, 0x2000
maa 144,168,128
tra 234,7,34816
s_add_u32 m0, s17, 16384
maa 160,176,128
tra 236,7,36864
v_mul_f32 v196, v57, v196
maa 160,180,132
buffer_load_dwordx4 v2, s[24:27], s19 offen offset:0 lds
maa 164,180,140
tra 238,7,38912
tra 240,27,32768
maa 164,176,136
tra 242,27,34816
tra 244,27,36864
maa 168,176,144
tra 246,27,38912
v_mul_f32 v197, v57, v197
maa 168,180,148
buffer_load_dwordx4 v3, s[24:27], s19 offen offset:1024 lds
maa 172,180,156
tra 248,28,32768
v_mul_f32 v198, v57, v198
maa 172,176,152
tra 250,28,34816
v_mul_f32 v199, v57, v199
maa 188,184,152
tra 252,28,36864
v_mul_f32 v200, v58, v200
maa 188,188,156
buffer_load_dwordx4 v4, s[24:27], s19 offen offset:2048 lds
maa 184,188,148
tra 254,28,38912
v_mul_f32 v201, v58, v201
maa 184,184,144
v_mul_f32 v202, v58, v202
v_mul_f32 v203, v58, v203
maa 180,184,136
v_mul_f32 v204, v59, v204
v_mul_f32 v205, v59, v205
maa 180,188,140
buffer_load_dwordx4 v5, s[24:27], s19 offen offset:3072 lds
maa 176,188,132
s_xor_b32 s19, s19, 0x10000
s_add_u32 m0, s17, 32768
v_mul_f32 v206, v59, v206
maa 176,184,128
s_waitcnt vmcnt(24) lgkmcnt(0)
s_barrier
v_mul_f32 v207, v59, v207
maa 128,224,192
tra 160,40,0
tra 162,40,2048
maa 128,228,196
buffer_load_dwordx4 v34, s[48:51], s18 offen offset:0 sc1 lds
maa 132,228,204
tra 164,40,4096
tra 166,40,6144
maa 132,224,200
rda 128,33,0
v_mul_f32 v208, v56, v208
maa 136,224,208
rda 132,33,4096
v_mul_f32 v209, v56, v209
maa 136,228,212
buffer_load_dwordx4 v34, s[48:51], s18 offen offset:1024 sc1 lds
maa 140,228,220
rda 136,33,1024
v_mul_f32 v210, v56, v210
maa 140,224,216
rda 140,33,5120
v_mul_f32 v211, v56, v211
maa 156,232,216
rda 144,33,2048
v_mul_f32 v212, v57, v212
maa 156,236,220
buffer_load_dwordx4 v34, s[48:51], s18 offen offset:2048 sc1 lds
maa 152,236,212
rda 148,33,6144
v_mul_f32 v213, v57, v213
maa 152,232,208
rda 152,33,3072
v_mul_f32 v214, v57, v214
maa 148,232,200
rda 156,33,7168
v_mul_f32 v215, v57, v215
maa 148,236,204
buffer_load_dwordx4 v34, s[48:51], s18 offen offset:3072 sc1 lds
maa 144,236,196
tra 168,41,0
s_xor_b32 s18, s18, 0x6000
maa 144,232,192
tra 170,41,2048
s_add_u32 m0, s17, 49152
maa 160,240,192
tra 172,41,4096
v_mul_f32 v216, v58, v216
maa 160,244,196
buffer_load_dwordx4 v2, s[24:27], s19 offen offset:0 lds
maa 164,244,204
tra 174,41,6144
tra 176,42,0
maa 164,240,200
tra 178,42,2048
tra 180,42,4096
maa 168,240,208
tra 182,42,6144
v_mul_f32 v217, v58, v217
maa 168,244,212
buffer_load_dwordx4 v3, s[24:27], s19 offen offset:1024 lds
maa 172,244,220
tra 184,43,0
v_mul_f32 v218, v58, v218
maa 172,240,216
tra 186,43,2048
v_mul_f32 v219, v58, v219
maa 188,248,216
tra 188,43,4096
v_mul_f32 v220, v59, v220
maa 188,252,220
buffer_load_dwordx4 v4, s[24:27], s19 offen offset:2048 lds
maa 184,252,212
tra 190,43,6144
v_mul_f32 v221, v59, v221
maa 184,248,208
v_mul_f32 v222, v59, v222
v_mul_f32 v223, v59, v223
maa 180,248,200
v_mul_f32 v224, v56, v224
v_mul_f32 v225, v56, v225
maa 180,252,204
buffer_load_dwordx4 v5, s[24:27], s19 offen offset:3072 lds
maa 176,252,196
s_xor_b32 s19, s19, 0x30000
s_add_u32 m0, s17, 131072
v_mul_f32 v226, v56, v226
maa 176,248,192
s_waitcnt vmcnt(24) lgkmcnt(0)
s_barrier
v_mul_f32 v227, v56, v227
maa 128,160,128
tra 224,36,0
tra 226,36,2048
maa 128,164,132
buffer_load_dwordx4 v34, s[48:51], s18 offen offset:0 sc1 lds
maa 132,164,140
tra 228,36,4096
tra 230,36,6144
maa 132,160,136
rda 192,32,0
v_mul_f32 v228, v57, v228
maa 136,160,144
rda 196,32,4096
v_mul_f32 v229, v57, v229
maa 136,164,148
buffer_load_dwordx4 v34, s[48:51], s18 offen offset:1024 sc1 lds
maa 140,164,156
rda 200,32,1024
v_mul_f32 v230, v57, v230
maa 140,160,152
rda 204,32,5120
v_mul_f32 v231, v57, v231
maa 156,168,152
rda 208,32,2048
v_mul_f32 v232, v58, v232
maa 156,172,156
buffer_load_dwordx4 v34, s[48:51], s18 offen offset:2048 sc1 lds
maa 152,172,148
rda 212,32,6144
v_mul_f32 v233, v58, v233
maa 152,168,144
rda 216,32,3072
v_mul_f32 v234, v58, v234
maa 148,168,136
rda 220,32,7168
v_mul_f32 v235, v58, v235
maa 148,172,140
buffer_load_dwordx4 v34, s[48:51], s18 offen offset:3072 sc1 lds
maa 144,172,132
tra 232,37,0
s_xor_b32 s18, s18, 0x2000
maa 144,168,128
tra 234,37,2048
s_add_u32 m0, s17, 147456
maa 160,176,128
tra 236,37,4096
v_mul_f32 v236, v59, v236
maa 160,180,132
buffer_load_dwordx4 v2, s[24:27], s19 offen offset:0 lds
maa 164,180,140
tra 238,37,6144
tra 240,38,0
maa 164,176,136
tra 242,38,2048
tra 244,38,4096
maa 168,176,144
tra 246,38,6144
v_mul_f32 v237, v59, v237
maa 168,180,148
buffer_load_dwordx4 v3, s[24:27], s19 offen offset:1024 lds
maa 172,180,156
tra 248,39,0
v_mul_f32 v238, v59, v238
maa 172,176,152
tra 250,39,2048
v_mul_f32 v239, v59, v239
maa 188,184,152
tra 252,39,4096
v_mul_f32 v240, v56, v240
maa 188,188,156
buffer_load_dwordx4 v4, s[24:27], s19 offen offset:2048 lds
maa 184,188,148
tra 254,39,6144
v_mul_f32 v241, v56, v241
maa 184,184,144
v_mul_f32 v242, v56, v242
v_mul_f32 v243, v56, v243
maa 180,184,136
v_mul_f32 v244, v57, v244
v_mul_f32 v245, v57, v245
maa 180,188,140
buffer_load_dwordx4 v5, s[24:27], s19 offen offset:3072 lds
maa 176,188,132
s_xor_b32 s19, s19, 0x10000
s_add_u32 m0, s17, 65536
v_mul_f32 v246, v57, v246
maa 176,184,128
s_waitcnt vmcnt(24) lgkmcnt(0)
s_barrier
v_mul_f32 v247, v57, v247
maa 128,224,192
tra 160,36,32768
tra 162,36,34816
maa 128,228,196
buffer_load_dwordx4 v34, s[48:51], s18 offen offset:0 sc1 lds
maa 132,228,204
tra 164,36,36864
tra 166,36,38912
maa 132,224,200
rda 128,32,32768
v_mul_f32 v248, v58, v248
maa 136,224,208
rda 132,32,36864
v_mul_f32 v249, v58, v249
maa 136,228,212
buffer_load_dwordx4 v34, s[48:51], s18 offen offset:1024 sc1 lds
maa 140,228,220
rda 136,32,33792
v_mul_f32 v250, v58, v250
maa 140,224,216
rda 140,32,37888
v_mul_f32 v251, v58, v251
maa 156,232,216
rda 144,32,34816
v_mul_f32 v252, v59, v252
maa 156,236,220
buffer_load_dwordx4 v34, s[48:51], s18 offen offset:2048 sc1 lds
maa 152,236,212
rda 148,32,38912
v_mul_f32 v253, v59, v253
maa 152,232,208
rda 152,32,35840
v_mul_f32 v254, v59, v254
maa 148,232,200
rda 156,32,39936
v_mul_f32 v255, v59, v255
maa 148,236,204
buffer_load_dwordx4 v34, s[48:51], s18 offen offset:3072 sc1 lds
maa 144,236,196
tra 168,37,32768
s_xor_b32 s18, s18, 0xe000
maa 144,232,192
tra 170,37,34816
s_add_u32 m0, s17, 81920
maa 160,240,192
tra 172,37,36864
v_mov_b64 v[44:45], 0
maa 160,244,196
buffer_load_dwordx4 v2, s[24:27], s19 offen offset:0 lds
maa 164,244,204
tra 174,37,38912
tra 176,38,32768
maa 164,240,200
tra 178,38,34816
tra 180,38,36864
maa 168,240,208
tra 182,38,38912
v_mov_b64 v[48:49], 0
maa 168,244,212
buffer_load_dwordx4 v3, s[24:27], s19 offen offset:1024 lds
maa 172,244,220
tra 184,39,32768
v_bfe_u32 v46, v0, 2, 2
maa 172,240,216
tra 186,39,34816
v_lshrrev_b32 v47, 4, v0
maa 188,248,216
tra 188,39,36864
v_xor_b32 v46, v46, v47
maa 188,252,220
buffer_load_dwordx4 v4, s[24:27], s19 offen offset:2048 lds
maa 184,252,212
tra 190,39,38912
v_min_u32 v46, 1, v46
maa 184,248,208
v_lshlrev_b32 v46, 4, v46
v_mov_b32 v47, 0x3f80
maa 180,248,200
v_lshrrev_b32 v46, v46, v47
v_mov_b32 v47, 0
maa 180,252,204
buffer_load_dwordx4 v5, s[24:27], s19 offen offset:3072 lds
maa 176,252,196
s_xor_b32 s19, s19, 0x70000
s_add_u32 m0, s17, 98304
v_and_b32 v50, 3, v0
maa 176,248,192
s_waitcnt vmcnt(24) lgkmcnt(0)
s_barrier
v_lshlrev_b32 v50, 4, v50
maa 128,160,128
tra 224,6,0
tra 226,6,2048
maa 128,164,132
buffer_load_dwordx4 v34, s[48:51], s18 offen offset:0 sc1 lds
maa 132,164,140
tra 228,6,4096
tra 230,6,6144
maa 132,160,136
rda 192,9,0
v_lshlrev_b64 v[46:47], v50, v[46:47]
maa 136,160,144
rda 196,9,4096
s_sub_u32 s65, s74, 59768832
maa 136,164,148
buffer_load_dwordx4 v34, s[48:51], s18 offen offset:1024 sc1 lds
maa 140,164,156
rda 200,9,1024
s_lshl_b32 s65, s65, 6
maa 140,160,152
rda 204,9,5120
s_add_u32 s65, s65, 60817408
maa 156,168,152
rda 208,9,2048
s_lshr_b32 s66, s2, 3
maa 156,172,156
buffer_load_dwordx4 v34, s[48:51], s18 offen offset:2048 sc1 lds
maa 152,172,148
rda 212,9,6144
s_lshl_b32 s66, s66, 10
maa 152,168,144
rda 216,9,3072
s_add_u32 s65, s65, s66
maa 148,168,136
rda 220,9,7168
v_mov_b32 v35, v1
maa 148,172,140
buffer_load_dwordx4 v34, s[48:51], s18 offen offset:3072 sc1 lds
maa 144,172,132
tra 232,7,0
s_xor_b32 s18, s18, 0x2000
maa 144,168,128
tra 234,7,2048
s_add_u32 m0, s17, 114688
maa 160,176,128
tra 236,7,4096
s_lshl_b32 s66, s58, 13
maa 160,180,132
buffer_load_dwordx4 v2, s[24:27], s19 offen offset:0 lds
maa 164,180,140
tra 238,7,6144
tra 240,27,0
maa 164,176,136
tra 242,27,2048
tra 244,27,4096
maa 168,176,144
tra 246,27,6144
s_add_u32 s96, s65, s66
maa 168,180,148
buffer_load_dwordx4 v3, s[24:27], s19 offen offset:1024 lds
maa 172,180,156
tra 248,28,0
s_add_u32 s97, s96, 2048
maa 172,176,152
tra 250,28,2048
s_add_u32 s98, s96, 4096
maa 188,184,152
tra 252,28,4096
s_add_u32 s99, s96, 6144
maa 188,188,156
buffer_load_dwordx4 v4, s[24:27], s19 offen offset:2048 lds
maa 184,188,148
tra 254,28,6144
s_lshl_b32 s66, s10, 13
maa 184,184,144
s_add_u32 s16, s65, s66
s_lshl_b32 s66, s58, 11
s_add_u32 s16, s16, s66
maa 180,184,136
s_xor_b32 s82, s16, 0x80000
s_xor_b32 s83, s16, 0x100000
s_xor_b32 s81, s16, 0x180000
maa 180,188,140
buffer_load_dwordx4 v5, s[24:27], s19 offen offset:3072 lds
maa 176,188,132
s_xor_b32 s19, s19, 0x10000
s_add_u32 m0, s17, 0
s_lshl_b32 s66, s58, 7
maa 176,184,128
s_waitcnt vmcnt(24) lgkmcnt(0)
s_barrier
s_add_u32 s66, s66, s74
maa 128,224,192
tra 160,6,32768
tra 162,6,34816
maa 128,228,196
buffer_load_dwordx4 v34, s[48:51], s18 offen offset:0 sc1 lds
maa 132,228,204
tra 164,6,36864
tra 166,6,38912
maa 132,224,200
rda 128,9,32768
v_min_u32 v62, 1, v0
maa 136,224,208
rda 132,9,36864
v_lshl_add_u32 v62, v62, 28, s66
maa 136,228,212
buffer_load_dwordx4 v34, s[48:51], s18 offen offset:1024 sc1 lds
maa 140,228,220
rda 136,9,33792
s_lshl_b32 s66, s10, 7
maa 140,224,216
rda 140,9,37888
s_add_u32 s65, s74, s66
maa 156,232,216
rda 144,9,34816
v_and_b32 v63, 3, v0
maa 156,236,220
buffer_load_dwordx4 v34, s[48:51], s18 offen offset:2048 sc1 lds
maa 152,236,212
rda 148,9,38912
v_max_u32 v63, 1, v63
maa 152,232,208
rda 152,9,35840
v_lshlrev_b32 v63, 13, v63
maa 148,232,200
rda 156,9,39936
v_xor_b32 v63, s65, v63
maa 148,236,204
buffer_load_dwordx4 v34, s[48:51], s18 offen offset:3072 sc1 lds
maa 144,236,196
tra 168,7,32768
s_xor_b32 s18, s18, 0x6000
maa 144,232,192
tra 170,7,34816
s_add_u32 m0, s17, 16384
maa 160,240,192
tra 172,7,36864
v_lshrrev_b32 v24, 2, v0
maa 160,244,196
buffer_load_dwordx4 v2, s[24:27], s19 offen offset:0 lds
maa 164,244,204
tra 174,7,38912
tra 176,27,32768
L_stub21:
s_cbranch_execz L_walk_b
maa 164,240,200
tra 178,27,34816
tra 180,27,36864
maa 168,240,208
tra 182,27,38912
v_min_u32 v24, 1, v24
maa 168,244,212
buffer_load_dwordx4 v3, s[24:27], s19 offen offset:1024 lds
maa 172,244,220
tra 184,28,32768
v_lshl_add_u32 v63, v24, 28, v63
maa 172,240,216
tra 186,28,34816
v_add_u32 v24, s17, v1
maa 188,248,216
tra 188,28,36864
s_lshl_b32 s65, s8, 1
maa 188,252,220
buffer_load_dwordx4 v4, s[24:27], s19 offen offset:2048 lds
maa 184,252,212
tra 190,28,38912
s_lshr_b32 s66, s10, 1
maa 184,248,208
s_add_u32 s65, s65, s66
s_lshl_b32 s65, s65, 2
s_add_u32 s65, s65, s58
maa 180,248,200
s_lshl_b32 s65, s65, 14
s_lshl_b32 s66, s9, 1
s_and_b32 s67, s10, 1
maa 180,252,204
buffer_load_dwordx4 v5, s[24:27], s19 offen offset:3072 lds
maa 176,252,196
s_xor_b32 s19, s19, 0x30000
s_add_u32 m0, s17, 32768
s_add_u32 s66, s66, s67
maa 176,248,192
s_waitcnt vmcnt(24) lgkmcnt(0)
s_barrier
s_lshl_b32 s66, s66, 7
maa 128,160,128
tra 224,40,0
tra 226,40,2048
maa 128,164,132
buffer_load_dwordx4 v34, s[48:51], s18 offen offset:0 sc1 lds
maa 132,164,140
tra 228,40,4096
tra 230,40,6144
maa 132,160,136
rda 192,33,0
s_add_u32 s84, s65, s66
maa 136,160,144
rda 196,33,4096
s_add_u32 s65, s17, 32768
maa 136,164,148
buffer_load_dwordx4 v34, s[48:51], s18 offen offset:1024 sc1 lds
maa 140,164,156
rda 200,33,1024
v_mul_u32_u24 v25, 144, v60
maa 140,160,152
rda 204,33,5120
v_lshrrev_b32 v61, 4, v0
maa 156,168,152
rda 208,33,2048
v_lshl_add_u32 v25, v61, 3, v25
maa 156,172,156
buffer_load_dwordx4 v34, s[48:51], s18 offen offset:2048 sc1 lds
maa 152,172,148
rda 212,33,6144
v_add_u32 v25, s65, v25
maa 152,168,144
rda 216,33,3072
v_lshrrev_b32 v61, 3, v0
maa 148,168,136
rda 220,33,7168
v_lshl_add_u32 v26, v61, 4, v1
maa 148,172,140
buffer_load_dwordx4 v34, s[48:51], s18 offen offset:3072 sc1 lds
maa 144,172,132
tra 232,41,0
s_xor_b32 s18, s18, 0x2000
maa 144,168,128
tra 234,41,2048
s_add_u32 m0, s17, 49152
maa 160,176,128
tra 236,41,4096
v_add_u32 v26, s65, v26
maa 160,180,132
buffer_load_dwordx4 v2, s[24:27], s19 offen offset:0 lds
maa 164,180,140
tra 238,41,6144
tra 240,42,0
maa 164,176,136
tra 242,42,2048
tra 244,42,4096
maa 168,176,144
tra 246,42,6144
v_mul_u32_u24 v61, 896, v61
maa 168,180,148
buffer_load_dwordx4 v3, s[24:27], s19 offen offset:1024 lds
maa 172,180,156
tra 248,43,0
v_add_u32 v61, v61, v1
maa 172,176,152
tra 250,43,2048
maa 188,184,152
tra 252,43,4096
maa 188,188,156
buffer_load_dwordx4 v4, s[24:27], s19 offen offset:2048 lds
maa 184,188,148
tra 254,43,6144
maa 184,184,144
maa 180,184,136
maa 180,188,140
buffer_load_dwordx4 v5, s[24:27], s19 offen offset:3072 lds
maa 176,188,132
s_xor_b32 s19, s19, 0x10000
s_add_u32 m0, s17, 131072
maa 176,184,128
s_waitcnt vmcnt(24) lgkmcnt(0)
s_barrier
maa 128,224,192
tra 160,36,0
tra 162,36,2048
maa 128,228,196
buffer_load_dwordx4 v34, s[48:51], s18 offen offset:0 sc1 lds
maa 132,228,204
tra 164,36,4096
tra 166,36,6144
maa 132,224,200
rda 128,32,0
maa 136,224,208
rda 132,32,4096
maa 136,228,212
buffer_load_dwordx4 v34, s[48:51], s18 offen offset:1024 sc1 lds
maa 140,228,220
rda 136,32,1024
maa 140,224,216
rda 140,32,5120
maa 156,232,216
rda 144,32,2048
maa 156,236,220
buffer_load_dwordx4 v34, s[48:51], s18 offen offset:2048 sc1 lds
maa 152,236,212
rda 148,32,6144
maa 152,232,208
rda 152,32,3072
maa 148,232,200
rda 156,32,7168
maa 148,236,204
buffer_load_dwordx4 v34, s[48:51], s18 offen offset:3072 sc1 lds
maa 144,236,196
tra 168,37,0
s_add_u32 m0, s17, 147456
maa 144,232,192
tra 170,37,2048
maa 160,240,192
tra 172,37,4096
maa 160,244,196
buffer_load_dwordx4 v2, s[24:27], s19 offen offset:0 lds
maa 164,244,204
tra 174,37,6144
tra 176,38,0
maa 164,240,200
tra 178,38,2048
tra 180,38,4096
maa 168,240,208
tra 182,38,6144
maa 168,244,212
buffer_load_dwordx4 v3, s[24:27], s19 offen offset:1024 lds
maa 172,244,220
tra 184,39,0
maa 172,240,216
tra 186,39,2048
maa 188,248,216
tra 188,39,4096
maa 188,252,220
buffer_load_dwordx4 v4, s[24:27], s19 offen offset:2048 lds
maa 184,252,212
tra 190,39,6144
maa 184,248,208
maa 180,248,200
maa 180,252,204
buffer_load_dwordx4 v5, s[24:27], s19 offen offset:3072 lds
maa 176,252,196
maa 176,248,192
s_waitcnt vmcnt(24) lgkmcnt(0)
s_barrier
maa 128,160,128
tra 224,36,32768
maa 128,164,132
tra 226,36,34816
maa 132,164,140
tra 228,36,36864
maa 132,160,136
tra 230,36,38912
maa 136,160,144
rda 192,32,32768
maa 136,164,148
rda 196,32,36864
maa 140,164,156
rda 200,32,33792
maa 140,160,152
rda 204,32,37888
maa 156,168,152
rda 208,32,34816
maa 156,172,156
rda 212,32,38912
maa 152,172,148
rda 216,32,35840
maa 152,168,144
rda 220,32,39936
maa 148,168,136
tra 232,37,32768
maa 148,172,140
tra 234,37,34816
maa 144,172,132
tra 236,37,36864
maa 144,168,128
tra 238,37,38912
maa 160,176,128
tra 240,38,32768
maa 160,180,132
tra 242,38,34816
maa 164,180,140
tra 244,38,36864
maa 164,176,136
tra 246,38,38912
maa 168,176,144
tra 248,39,32768
maa 168,180,148
tra 250,39,34816
maa 172,180,156
tra 252,39,36864
maa 172,176,152
tra 254,39,38912
maa 188,184,152
maa 188,188,156
maa 184,188,148
maa 184,184,144
maa 180,184,136
maa 180,188,140
maa 176,188,132
maa 176,184,128
s_waitcnt vmcnt(16) lgkmcnt(0)
s_barrier
maa 128,224,192
tra 160,6,0
maa 128,228,196
tra 162,6,2048
maa 132,228,204
tra 164,6,4096
maa 132,224,200
tra 166,6,6144
maa 136,224,208
rda 128,9,0
maa 136,228,212
rda 132,9,4096
maa 140,228,220
rda 136,9,1024
maa 140,224,216
rda 140,9,5120
maa 156,232,216
rda 144,9,2048
maa 156,236,220
rda 148,9,6144
maa 152,236,212
rda 152,9,3072
maa 152,232,208
rda 156,9,7168
maa 148,232,200
tra 168,7,0
maa 148,236,204
tra 170,7,2048
maa 144,236,196
tra 172,7,4096
maa 144,232,192
tra 174,7,6144
maa 160,240,192
tra 176,27,0
maa 160,244,196
tra 178,27,2048
maa 164,244,204
tra 180,27,4096
maa 164,240,200
tra 182,27,6144
maa 168,240,208
tra 184,28,0
maa 168,244,212
tra 186,28,2048
maa 172,244,220
tra 188,28,4096
maa 172,240,216
tra 190,28,6144
maa 188,248,216
maa 188,252,220
maa 184,252,212
maa 184,248,208
maa 180,248,200
maa 180,252,204
maa 176,252,196
maa 176,248,192
s_waitcnt vmcnt(0) lgkmcnt(0)
s_barrier
maa 128,160,128
tra 224,6,32768
tra 226,6,34816
maa 128,164,132
tra 228,6,36864
tra 230,6,38912
maa 132,164,140
rda 192,9,32768
rda 196,9,36864
maa 132,160,136
rda 200,9,33792
maa 136,160,144
rda 204,9,37888
rda 208,9,34816
maa 136,164,148
rda 212,9,38912
rda 216,9,35840
maa 140,164,156
rda 220,9,39936
tra 232,7,32768
maa 140,160,152
tra 234,7,34816
maa 156,168,152
tra 236,7,36864
tra 238,7,38912
maa 156,172,156
tra 240,27,32768
tra 242,27,34816
maa 152,172,148
tra 244,27,36864
tra 246,27,38912
maa 152,168,144
tra 248,28,32768
maa 148,168,136
tra 250,28,34816
tra 252,28,36864
maa 148,172,140
tra 254,28,38912
rda 0,33,0
maa 144,172,132
rda 4,33,4096
rda 8,33,1024
maa 144,168,128
rda 12,33,5120
maa 160,176,128
rda 16,33,2048
rda 20,33,6144
maa 160,180,132
rda 24,33,3072
rda 28,33,7168
maa 164,180,140
tra 32,40,0
tra 34,40,2048
maa 164,176,136
tra 36,40,4096
maa 168,176,144
tra 38,40,6144
tra 40,41,0
maa 168,180,148
tra 42,41,2048
tra 44,41,4096
maa 172,180,156
tra 46,41,6144
tra 48,42,0
maa 172,176,152
tra 50,42,2048
maa 188,184,152
tra 52,42,4096
tra 54,42,6144
maa 188,188,156
tra 56,43,0
tra 58,43,2048
maa 184,188,148
tra 60,43,4096
maa 184,184,144
tra 62,43,6144
maa 180,184,136
maa 180,188,140
maa 176,188,132
maa 176,184,128
s_waitcnt lgkmcnt(0)
s_barrier
s_cmp_eq_u32 s58, s10
s_cbranch_scc1 L_d_own
maa 128,224,192
maa 128,228,196
maa 128,32,0
maa 128,36,4
maa 144,44,4
maa 144,40,0
s_nop 2
maa 144,236,196
s_nop 2
maa 144,232,192
v_fma_f32 v128, v52, v128, v192
v_fma_f32 v129, v52, v129, v193
maa 148,232,200
v_fma_f32 v130, v52, v130, v194
v_fma_f32 v131, v52, v131, v195
maa 148,236,204
v_cvt_pk_bf16_f32 v80, v128, v129
v_cvt_pk_bf16_f32 v81, v130, v131
maa 148,40,8
v_fma_f32 v144, v52, v144, v208
v_fma_f32 v145, v52, v145, v209
maa 148,44,12
v_fma_f32 v146, v52, v146, v210
v_fma_f32 v147, v52, v147, v211
maa 132,36,12
v_cvt_pk_bf16_f32 v82, v144, v145
v_cvt_pk_bf16_f32 v83, v146, v147
maa 132,32,8
buffer_store_dwordx4 v[80:83], v35, s[48:51], s96 offen offset:0 sc1
maa 132,228,204
v_fma_f32 v148, v53, v148, v212
v_fma_f32 v149, v53, v149, v213
maa 132,224,200
v_fma_f32 v150, v53, v150, v214
v_fma_f32 v151, v53, v151, v215
maa 136,224,208
v_cvt_pk_bf16_f32 v86, v148, v149
v_cvt_pk_bf16_f32 v87, v150, v151
maa 136,228,212
s_nop 2
maa 136,32,16
v_fma_f32 v132, v53, v132, v196
v_fma_f32 v133, v53, v133, v197
maa 136,36,20
v_fma_f32 v134, v53, v134, v198
v_fma_f32 v135, v53, v135, v199
maa 152,44,20
v_cvt_pk_bf16_f32 v84, v132, v133
v_cvt_pk_bf16_f32 v85, v134, v135
maa 152,40,16
buffer_store_dwordx4 v[84:87], v35, s[48:51], s97 offen offset:0 sc1
maa 152,236,212
v_fma_f32 v136, v54, v136, v200
v_fma_f32 v137, v54, v137, v201
maa 152,232,208
v_fma_f32 v138, v54, v138, v202
v_fma_f32 v139, v54, v139, v203
maa 156,232,216
v_cvt_pk_bf16_f32 v88, v136, v137
v_cvt_pk_bf16_f32 v89, v138, v139
maa 156,236,220
s_nop 2
maa 156,40,24
v_fma_f32 v152, v54, v152, v216
v_fma_f32 v153, v54, v153, v217
maa 156,44,28
v_fma_f32 v154, v54, v154, v218
v_fma_f32 v155, v54, v155, v219
maa 140,36,28
v_cvt_pk_bf16_f32 v90, v152, v153
v_cvt_pk_bf16_f32 v91, v154, v155
maa 140,32,24
buffer_store_dwordx4 v[88:91], v35, s[48:51], s98 offen offset:0 sc1
maa 140,228,220
v_fma_f32 v156, v55, v156, v220
v_fma_f32 v157, v55, v157, v221
maa 140,224,216
v_fma_f32 v158, v55, v158, v222
v_fma_f32 v159, v55, v159, v223
maa 160,240,192
v_cvt_pk_bf16_f32 v94, v156, v157
v_cvt_pk_bf16_f32 v95, v158, v159
maa 160,244,196
s_nop 2
maa 160,48,0
v_fma_f32 v140, v55, v140, v204
v_fma_f32 v141, v55, v141, v205
maa 160,52,4
v_fma_f32 v142, v55, v142, v206
v_fma_f32 v143, v55, v143, v207
maa 176,60,4
v_cvt_pk_bf16_f32 v92, v140, v141
v_cvt_pk_bf16_f32 v93, v142, v143
maa 176,56,0
buffer_store_dwordx4 v[92:95], v35, s[48:51], s99 offen offset:0 sc1
maa 176,252,196
v_fma_f32 v160, v52, v160, v224
v_fma_f32 v161, v52, v161, v225
maa 176,248,192
v_fma_f32 v162, v52, v162, v226
v_fma_f32 v163, v52, v163, v227
maa 180,248,200
v_cvt_pk_bf16_f32 v80, v160, v161
v_cvt_pk_bf16_f32 v81, v162, v163
maa 180,252,204
s_nop 2
maa 180,56,8
v_fma_f32 v176, v52, v176, v240
v_fma_f32 v177, v52, v177, v241
maa 180,60,12
v_fma_f32 v178, v52, v178, v242
v_fma_f32 v179, v52, v179, v243
maa 164,52,12
v_cvt_pk_bf16_f32 v82, v176, v177
v_cvt_pk_bf16_f32 v83, v178, v179
maa 164,48,8
buffer_store_dwordx4 v[80:83], v35, s[48:51], s96 offen offset:1024 sc1
maa 164,244,204
v_fma_f32 v180, v53, v180, v244
v_fma_f32 v181, v53, v181, v245
maa 164,240,200
v_fma_f32 v182, v53, v182, v246
v_fma_f32 v183, v53, v183, v247
maa 168,240,208
v_cvt_pk_bf16_f32 v86, v180, v181
v_cvt_pk_bf16_f32 v87, v182, v183
maa 168,244,212
s_nop 2
maa 168,48,16
v_fma_f32 v164, v53, v164, v228
v_fma_f32 v165, v53, v165, v229
maa 168,52,20
v_fma_f32 v166, v53, v166, v230
v_fma_f32 v167, v53, v167, v231
maa 184,60,20
v_cvt_pk_bf16_f32 v84, v164, v165
v_cvt_pk_bf16_f32 v85, v166, v167
maa 184,56,16
buffer_store_dwordx4 v[84:87], v35, s[48:51], s97 offen offset:1024 sc1
maa 184,252,212
L_stub22:
s_cbranch_execz L_walk_b
v_fma_f32 v168, v54, v168, v232
v_fma_f32 v169, v54, v169, v233
maa 184,248,208
v_fma_f32 v170, v54, v170, v234
v_fma_f32 v171, v54, v171, v235
maa 188,248,216
v_cvt_pk_bf16_f32 v88, v168, v169
v_cvt_pk_bf16_f32 v89, v170, v171
maa 188,252,220
s_nop 2
maa 188,56,24
v_fma_f32 v184, v54, v184, v248
v_fma_f32 v185, v54, v185, v249
maa 188,60,28
v_fma_f32 v186, v54, v186, v250
v_fma_f32 v187, v54, v187, v251
maa 172,52,28
v_cvt_pk_bf16_f32 v90, v184, v185
v_cvt_pk_bf16_f32 v91, v186, v187
maa 172,48,24
buffer_store_dwordx4 v[88:91], v35, s[48:51], s98 offen offset:1024 sc1
maa 172,244,220
v_fma_f32 v188, v55, v188, v252
v_fma_f32 v189, v55, v189, v253
maa 172,240,216
v_fma_f32 v190, v55, v190, v254
v_fma_f32 v191, v55, v191, v255
v_cvt_pk_bf16_f32 v94, v188, v189
v_cvt_pk_bf16_f32 v95, v190, v191
s_nop 3
v_fma_f32 v172, v55, v172, v236
v_fma_f32 v173, v55, v173, v237
v_fma_f32 v174, v55, v174, v238
v_fma_f32 v175, v55, v175, v239
v_cvt_pk_bf16_f32 v92, v172, v173
v_cvt_pk_bf16_f32 v93, v174, v175
buffer_store_dwordx4 v[92:95], v35, s[48:51], s99 offen offset:1024 sc1
v_mov_b32 v8, 0
s_barrier
ds_read_b128 v[64:67], v24 offset:0
ds_read_b128 v[68:71], v24 offset:1024
ds_read_b128 v[72:75], v24 offset:2048
ds_read_b128 v[76:79], v24 offset:3072
s_mov_b32 s65, 0
s_waitcnt vmcnt(0)
buffer_store_dwordx2 v[16:17], v62, s[48:51], 0 offen offset:512 sc1
L_oth:
ds_read_b32 v18, v8 offset:49152
s_add_u32 s3, s3, 1
s_cmp_gt_u32 s3, 0x2000000
s_cbranch_scc1 L_part_end
s_waitcnt lgkmcnt(0)
v_readfirstlane_b32 s67, v18
s_nop 3
s_andn2_b32 s66, s67, s65
s_cbranch_scc0 L_oth
s_or_b32 s65, s65, s66
s_bitcmp1_b32 s66, 1
s_cbranch_scc0 L_oth1
buffer_load_dwordx4 v[80:83], v35, s[48:51], s82 offen offset:0 sc1
buffer_load_dwordx4 v[84:87], v35, s[48:51], s82 offen offset:1024 sc1
L_oth1:
s_bitcmp1_b32 s66, 2
s_cbranch_scc0 L_oth2
buffer_load_dwordx4 v[96:99], v35, s[48:51], s83 offen offset:0 sc1
buffer_load_dwordx4 v[100:103], v35, s[48:51], s83 offen offset:1024 sc1
L_oth2:
s_bitcmp1_b32 s66, 3
s_cbranch_scc0 L_oth3
buffer_load_dwordx4 v[112:115], v35, s[48:51], s81 offen offset:0 sc1
buffer_load_dwordx4 v[116:119], v35, s[48:51], s81 offen offset:1024 sc1
L_oth3:
s_cmp_lg_u32 s65, 14
s_cbranch_scc1 L_oth
s_branch L_part_end
L_d_own:
maa 128,224,192
maa 128,228,196
maa 128,32,0
maa 128,36,4
maa 144,44,4
maa 144,40,0
s_nop 2
maa 144,236,196
s_nop 2
maa 144,232,192
v_fma_f32 v128, v52, v128, v192
v_fma_f32 v129, v52, v129, v193
maa 148,232,200
v_fma_f32 v130, v52, v130, v194
v_fma_f32 v131, v52, v131, v195
maa 148,236,204
ds_write_b128 v1, v[128:131] offset:0
maa 148,40,8
v_fma_f32 v144, v52, v144, v208
v_fma_f32 v145, v52, v145, v209
maa 148,44,12
v_fma_f32 v146, v52, v146, v210
v_fma_f32 v147, v52, v147, v211
maa 132,36,12
maa 132,32,8
ds_write_b128 v1, v[144:147] offset:1024
maa 132,228,204
s_nop 2
maa 132,224,200
v_fma_f32 v148, v53, v148, v212
v_fma_f32 v149, v53, v149, v213
maa 136,224,208
v_fma_f32 v150, v53, v150, v214
v_fma_f32 v151, v53, v151, v215
maa 136,228,212
ds_write_b128 v1, v[148:151] offset:5120
maa 136,32,16
v_fma_f32 v132, v53, v132, v196
v_fma_f32 v133, v53, v133, v197
maa 136,36,20
v_fma_f32 v134, v53, v134, v198
v_fma_f32 v135, v53, v135, v199
maa 152,44,20
maa 152,40,16
ds_write_b128 v1, v[132:135] offset:4096
maa 152,236,212
s_nop 2
maa 152,232,208
v_fma_f32 v136, v54, v136, v200
v_fma_f32 v137, v54, v137, v201
maa 156,232,216
v_fma_f32 v138, v54, v138, v202
v_fma_f32 v139, v54, v139, v203
maa 156,236,220
ds_write_b128 v1, v[136:139] offset:8192
maa 156,40,24
v_fma_f32 v152, v54, v152, v216
v_fma_f32 v153, v54, v153, v217
maa 156,44,28
v_fma_f32 v154, v54, v154, v218
v_fma_f32 v155, v54, v155, v219
maa 140,36,28
maa 140,32,24
ds_write_b128 v1, v[152:155] offset:9216
maa 140,228,220
s_nop 2
maa 140,224,216
v_fma_f32 v156, v55, v156, v220
v_fma_f32 v157, v55, v157, v221
maa 160,240,192
v_fma_f32 v158, v55, v158, v222
v_fma_f32 v159, v55, v159, v223
maa 160,244,196
ds_write_b128 v1, v[156:159] offset:13312
maa 160,48,0
v_fma_f32 v140, v55, v140, v204
v_fma_f32 v141, v55, v141, v205
maa 160,52,4
v_fma_f32 v142, v55, v142, v206
v_fma_f32 v143, v55, v143, v207
maa 176,60,4
maa 176,56,0
ds_write_b128 v1, v[140:143] offset:12288
maa 176,252,196
s_nop 2
maa 176,248,192
v_fma_f32 v160, v52, v160, v224
v_fma_f32 v161, v52, v161, v225
maa 180,248,200
v_fma_f32 v162, v52, v162, v226
v_fma_f32 v163, v52, v163, v227
maa 180,252,204
ds_write_b128 v1, v[160:163] offset:2048
maa 180,56,8
v_fma_f32 v176, v52, v176, v240
v_fma_f32 v177, v52, v177, v241
maa 180,60,12
v_fma_f32 v178, v52, v178, v242
v_fma_f32 v179, v52, v179, v243
maa 164,52,12
maa 164,48,8
ds_write_b128 v1, v[176:179] offset:3072
maa 164,244,204
s_nop 2
maa 164,240,200
v_fma_f32 v180, v53, v180, v244
v_fma_f32 v181, v53, v181, v245
maa 168,240,208
v_fma_f32 v182, v53, v182, v246
v_fma_f32 v183, v53, v183, v247
maa 168,244,212
ds_write_b128 v1, v[180:183] offset:7168
maa 168,48,16
v_fma_f32 v164, v53, v164, v228
v_fma_f32 v165, v53, v165, v229
maa 168,52,20
v_fma_f32 v166, v53, v166, v230
v_fma_f32 v167, v53, v167, v231
maa 184,60,20
maa 184,56,16
ds_write_b128 v1, v[164:167] offset:6144
maa 184,252,212
s_nop 2
maa 184,248,208
v_fma_f32 v168, v54, v168, v232
v_fma_f32 v169, v54, v169, v233
maa 188,248,216
v_fma_f32 v170, v54, v170, v234
v_fma_f32 v171, v54, v171, v235
maa 188,252,220
ds_write_b128 v1, v[168:171] offset:10240
maa 188,56,24
v_fma_f32 v184, v54, v184, v248
v_fma_f32 v185, v54, v185, v249
maa 188,60,28
v_fma_f32 v186, v54, v186, v250
v_fma_f32 v187, v54, v187, v251
maa 172,52,28
maa 172,48,24
ds_write_b128 v1, v[184:187] offset:11264
maa 172,244,220
s_nop 2
maa 172,240,216
v_fma_f32 v188, v55, v188, v252
v_fma_f32 v189, v55, v189, v253
v_fma_f32 v190, v55, v190, v254
v_fma_f32 v191, v55, v191, v255
ds_write_b128 v1, v[188:191] offset:15360
s_nop 2
v_fma_f32 v172, v55, v172, v236
v_fma_f32 v173, v55, v173, v237
v_fma_f32 v174, v55, v174, v238
v_fma_f32 v175, v55, v175, v239
ds_write_b128 v1, v[172:175] offset:14336
v_mov_b32 v8, 0
ds_write_b32 v8, v8 offset:49152
s_waitcnt lgkmcnt(0)
s_barrier
ds_read_b128 v[64:67], v24 offset:0
ds_read_b128 v[68:71], v24 offset:1024
ds_read_b128 v[72:75], v24 offset:2048
ds_read_b128 v[76:79], v24 offset:3072
s_mov_b32 s65, 0
L_own:
buffer_load_dwordx2 v[18:19], v63, s[48:51], 0 offen offset:512 sc1
s_add_u32 s3, s3, 1
s_cmp_gt_u32 s3, 0x200000
s_cbranch_scc1 L_part_end
s_waitcnt vmcnt(0)
v_cmp_eq_u64 vcc, v[18:19], v[16:17]
s_nop 3
s_and_b32 s67, vcc_lo, 14
s_andn2_b32 s66, s67, s65
s_cbranch_scc0 L_own
s_or_b32 s65, s65, s66
v_mov_b32 v18, s65
ds_write_b32 v8, v18 offset:49152
s_bitcmp1_b32 s66, 1
s_cbranch_scc0 L_own1
buffer_load_dwordx4 v[80:83], v35, s[48:51], s82 offen offset:0 sc1
buffer_load_dwordx4 v[84:87], v35, s[48:51], s82 offen offset:1024 sc1
L_own1:
s_bitcmp1_b32 s66, 2
s_cbranch_scc0 L_own2
buffer_load_dwordx4 v[96:99], v35, s[48:51], s83 offen offset:0 sc1
buffer_load_dwordx4 v[100:103], v35, s[48:51], s83 offen offset:1024 sc1
L_own2:
s_bitcmp1_b32 s66, 3
s_cbranch_scc0 L_own3
buffer_load_dwordx4 v[112:115], v35, s[48:51], s81 offen offset:0 sc1
buffer_load_dwordx4 v[116:119], v35, s[48:51], s81 offen offset:1024 sc1
L_own3:
s_cmp_lg_u32 s65, 14
s_cbranch_scc1 L_own
L_part_end:
s_waitcnt vmcnt(0) lgkmcnt(0)
mvv 64,46,80
mvv 64,46,96
mvv 64,46,112
mvv 68,44,80
mvv 68,44,96
mvv 68,44,112
mvv 72,46,84
mvv 72,46,100
mvv 72,46,116
mvv 76,44,84
mvv 76,44,100
mvv 76,44,116
v_cvt_pk_bf16_f32 v64, v64, v65
v_cvt_pk_bf16_f32 v65, v66, v67
ds_write_b64 v25, v[64:65] offset:0
v_cvt_pk_bf16_f32 v66, v68, v69
v_cvt_pk_bf16_f32 v67, v70, v71
ds_write_b64 v25, v[66:67] offset:32
v_cvt_pk_bf16_f32 v68, v72, v73
v_cvt_pk_bf16_f32 v69, v74, v75
ds_write_b64 v25, v[68:69] offset:64
v_cvt_pk_bf16_f32 v70, v76, v77
v_cvt_pk_bf16_f32 v71, v78, v79
ds_write_b64 v25, v[70:71] offset:96
ds_read_b128 v[72:75], v26 offset:0
ds_read_b128 v[76:79], v26 offset:1152
s_add_u32 s65, s84, 8192
s_waitcnt lgkmcnt(1)
buffer_store_dwordx4 v[72:75], v61, s[44:47], s84 offen
s_waitcnt lgkmcnt(0)
buffer_store_dwordx4 v[76:79], v61, s[44:47], s65 offen
s_endpgm
L_c_de0:
v_mfma_f32_16x16x32_bf16 v[32:35], a[0:3], v[64:67], v[12:15]
v_exp_f32 v44, v44
mav 32,4,80
mav 32,8,96
s_waitcnt vmcnt(3) lgkmcnt(0)
s_barrier
v_exp_f32 v45, v45
mav 32,12,112
v_cvt_pk_bf16_f32 v62, v44, v45
s_add_u32 m0, s17, 0
v_exp_f32 v46, v46
buffer_load_dwordx4 v1, s[48:51], s11 offen offset:0 sc1 lds
v_exp_f32 v47, v47
s_nop 0
v_cvt_pk_bf16_f32 v63, v46, v47
s_nop 0
v_exp_f32 v32, v32
buffer_load_dwordx4 v1, s[48:51], s11 offen offset:1024 sc1 lds
v_exp_f32 v33, v33
s_nop 0
v_cvt_pk_bf16_f32 v48, v32, v33
v_exp_f32 v34, v34
buffer_load_dwordx4 v1, s[48:51], s11 offen offset:2048 sc1 lds
v_mov_b64 v[32:33], 0
v_exp_f32 v35, v35
s_nop 0
v_cvt_pk_bf16_f32 v49, v34, v35
v_smfmac_f32_16x16x64_bf16 v[32:35], v[24:27], v[56:63], v11
mav 224,192,56
mav 224,196,60
buffer_load_dwordx4 v1, s[48:51], s11 offen offset:3072 sc1 lds
mav 228,204,60
s_add_u32 s11, s11, 8192
mav 228,200,56
v_mov_b32 v50, 0
mav 232,208,56
s_add_u32 m0, s17, 16384
mav 232,212,60
buffer_load_dwordx4 v2, s[36:39], s16 offen offset:0 lds
mav 236,220,60
mav 236,216,56
v_mov_b32 v51, 0
mav 240,224,56
mav 240,228,60
buffer_load_dwordx4 v3, s[36:39], s16 offen offset:1024 lds
v_add_f32 v23, v23, v32
mav 244,236,60
mav 244,232,56
mav 248,240,56
mav 248,244,60
buffer_load_dwordx4 v4, s[36:39], s16 offen offset:2048 lds
v_add_f32 v23, v23, v33
mav 252,252,60
mav 252,248,56
mav0 32,0,68
mav 32,4,84
buffer_load_dwordx4 v5, s[36:39], s16 offen offset:3072 lds
mav 32,8,100
s_add_u32 s16, s16, 65536
mav 32,12,116
v_mfma_f32_16x16x32_bf16 v[36:39], a[28:31], v[116:119], v[12:15]
s_add_u32 m0, s17, 32768
mav 36,24,100
buffer_load_dwordx4 v1, s[48:51], s11 offen offset:0 sc1 lds
mav 36,20,84
mav 36,16,68
s_nop 1
v_exp_f32 v32, v32
buffer_load_dwordx4 v1, s[48:51], s11 offen offset:1024 sc1 lds
v_exp_f32 v33, v33
s_nop 0
v_cvt_pk_bf16_f32 v56, v32, v33
v_exp_f32 v34, v34
buffer_load_dwordx4 v1, s[48:51], s11 offen offset:2048 sc1 lds
v_exp_f32 v35, v35
s_nop 0
v_cvt_pk_bf16_f32 v57, v34, v35
mvv0 32,24,48
mav 128,64,48
v_exp_f32 v36, v36
buffer_load_dwordx4 v1, s[48:51], s11 offen offset:3072 sc1 lds
s_add_u32 s11, s11, 8192
v_exp_f32 v37, v37
mav 132,72,48
v_cvt_pk_bf16_f32 v58, v36, v37
mav 136,80,48
s_add_u32 m0, s17, 49152
v_exp_f32 v38, v38
buffer_load_dwordx4 v2, s[36:39], s16 offen offset:0 lds
v_add_f32 v20, v20, v32
v_exp_f32 v39, v39
mav 140,88,48
v_cvt_pk_bf16_f32 v59, v38, v39
mav 144,96,48
buffer_load_dwordx4 v3, s[36:39], s16 offen offset:1024 lds
mav 148,104,48
mav 152,112,48
buffer_load_dwordx4 v4, s[36:39], s16 offen offset:2048 lds
mav 156,120,48
mav0 32,0,72
mav 32,4,88
buffer_load_dwordx4 v5, s[36:39], s16 offen offset:3072 lds
mav 32,8,104
s_add_u32 s16, s16, 65536
mav 32,12,120
mav0 36,28,120
mav 36,24,104
v_add_u32 v18, s23, v1
v_add_u32 v19, s40, v1
mav 36,20,88
s_lshr_b32 s65, s58, 1
mav 36,16,72
s_and_b32 s66, s58, 1
v_mfma_f32_16x16x32_bf16 v[40:43], a[32:35], v[72:75], v[12:15]
s_lshl_b32 s67, s65, 13
v_exp_f32 v32, v32
mav 40,36,88
v_add_u32 v9, s67, v1
v_lshrrev_b32 v6, 2, v0
mav 40,40,104
v_exp_f32 v33, v33
mav 40,44,120
v_cvt_pk_bf16_f32 v48, v32, v33
v_exp_f32 v34, v34
v_lshlrev_b32 v6, 7, v6
v_and_b32 v7, 3, v0
v_exp_f32 v35, v35
s_nop 0
v_cvt_pk_bf16_f32 v49, v34, v35
mvv0 32,24,56
mav 160,64,56
v_exp_f32 v36, v36
v_lshl_add_u32 v6, v7, 3, v6
v_bfe_u32 v7, v0, 3, 2
v_exp_f32 v37, v37
mav 164,72,56
v_cvt_pk_bf16_f32 v50, v36, v37
mav 168,80,56
v_exp_f32 v38, v38
v_add_f32 v21, v21, v32
v_lshl_add_u32 v6, v7, 5, v6
s_lshl_b32 s67, s66, 13
v_exp_f32 v39, v39
mav 172,88,56
s_add_u32 s67, s67, 16384
v_cvt_pk_bf16_f32 v51, v38, v39
mav 176,96,56
v_exp_f32 v40, v40
v_add_u32 v6, s67, v6
v_xor_b32 v7, 32, v6
v_exp_f32 v41, v41
mav 180,104,56
v_cvt_pk_bf16_f32 v52, v40, v41
mav 184,112,56
v_exp_f32 v42, v42
v_exp_f32 v43, v43
mav 188,120,56
ds_write_b64 v19, v[20:21]
v_cvt_pk_bf16_f32 v53, v42, v43
mav0 32,0,76
mav 32,4,92
ds_write_b128 v18, v[128:131] offset:0
mav 32,8,108
mav 32,12,124
ds_write_b128 v18, v[132:135] offset:1024
v_mov_b32 v54, 0
mav0 36,28,124
s_add_u32 s81, s81, 1
mav 36,24,108
ds_write_b128 v18, v[136:139] offset:2048
mav 36,20,92
mav 36,16,76
ds_write_b128 v18, v[140:143] offset:3072
v_mov_b32 v55, 0
mav0 40,32,76
v_exp_f32 v32, v32
mav 40,36,92
ds_write_b128 v18, v[144:147] offset:4096
mav 40,40,108
v_exp_f32 v33, v33
mav 40,44,124
ds_write_b128 v18, v[148:151] offset:5120
v_cvt_pk_bf16_f32 v56, v32, v33
v_mfma_f32_16x16x32_bf16 v[44:47], a[60:63], v[124:127], v[12:15]
v_exp_f32 v34, v34
mav 44,56,108
ds_write_b128 v18, v[152:155] offset:6144
v_mov_b64 v[32:33], 0
mav 44,52,92
v_exp_f32 v35, v35
mav 44,48,76
ds_write_b128 v18, v[156:159] offset:7168
v_cvt_pk_bf16_f32 v57, v34, v35
v_smfmac_f32_16x16x64_bf16 v[32:35], v[24:27], v[48:55], v11
mav 192,64,48
v_exp_f32 v36, v36
mav 192,68,52
ds_write_b128 v18, v[160:163] offset:8192
mav 196,76,52
v_exp_f32 v37, v37
mav 196,72,48
ds_write_b128 v18, v[164:167] offset:9216
v_cvt_pk_bf16_f32 v58, v36, v37
mav 200,80,48
v_exp_f32 v38, v38
mav 200,84,52
ds_write_b128 v18, v[168:171] offset:10240
mav 204,92,52
v_exp_f32 v39, v39
mav 204,88,48
ds_write_b128 v18, v[172:175] offset:11264
v_cvt_pk_bf16_f32 v59, v38, v39
mav 208,96,48
v_exp_f32 v40, v40
mav 208,100,52
ds_write_b128 v18, v[176:179] offset:12288
v_add_f32 v22, v22, v32
mav 212,108,52
v_exp_f32 v41, v41
mav 212,104,48
ds_write_b128 v18, v[180:183] offset:13312
v_cvt_pk_bf16_f32 v60, v40, v41
mav 216,112,48
v_exp_f32 v42, v42
mav 216,116,52
ds_write_b128 v18, v[184:187] offset:14336
v_add_f32 v22, v22, v33
mav 220,124,52
v_exp_f32 v43, v43
mav 220,120,48
ds_write_b128 v18, v[188:191] offset:15360
v_cvt_pk_bf16_f32 v61, v42, v43
s_branch L_c_fin
L_c_ie0:
v_lshrrev_b32 v3, 3, v0
v_bfe_u32 v4, v0, 1, 2
v_lshrrev_b32 v5, 4, v0
v_xor_b32 v4, v4, v5
v_lshlrev_b32 v4, 5, v4
v_lshl_add_u32 v3, v3, 10, v4
v_and_b32 v4, 1, v0
v_lshl_add_u32 v2, v4, 4, v3
v_add_u32 v3, 7168, v2
v_add_u32 v4, 14336, v2
v_add_u32 v5, 21504, v2
s_add_u32 m0, s17, 0
s_nop 0
buffer_load_dwordx4 v1, s[48:51], s11 offen offset:0 sc1 lds
s_add_u32 s65, s64, 0
v_pk_mul_f32 v[128:129], v[128:129], v[20:21] op_sel:[0,0] op_sel_hi:[1,0]
v_pk_mul_f32 v[130:131], v[130:131], v[20:21] op_sel:[0,0] op_sel_hi:[1,0]
v_pk_mul_f32 v[132:133], v[132:133], v[20:21] op_sel:[0,0] op_sel_hi:[1,0]
v_pk_mul_f32 v[134:135], v[134:135], v[20:21] op_sel:[0,0] op_sel_hi:[1,0]
v_cvt_pk_bf16_f32 v128, v128, v129
v_cvt_pk_bf16_f32 v129, v130, v131
v_cvt_pk_bf16_f32 v130, v132, v133
v_cvt_pk_bf16_f32 v131, v134, v135
buffer_store_dwordx4 v[128:131], v1, s[48:51], s65 offen offset:0 sc1
buffer_load_dwordx4 v1, s[48:51], s11 offen offset:1024 sc1 lds
s_add_u32 s65, s64, 4096
v_pk_mul_f32 v[136:137], v[136:137], v[20:21] op_sel:[0,0] op_sel_hi:[1,0]
v_pk_mul_f32 v[138:139], v[138:139], v[20:21] op_sel:[0,0] op_sel_hi:[1,0]
v_pk_mul_f32 v[140:141], v[140:141], v[20:21] op_sel:[0,0] op_sel_hi:[1,0]
v_pk_mul_f32 v[142:143], v[142:143], v[20:21] op_sel:[0,0] op_sel_hi:[1,0]
v_cvt_pk_bf16_f32 v136, v136, v137
v_cvt_pk_bf16_f32 v137, v138, v139
v_cvt_pk_bf16_f32 v138, v140, v141
v_cvt_pk_bf16_f32 v139, v142, v143
buffer_store_dwordx4 v[136:139], v1, s[48:51], s65 offen offset:0 sc1
buffer_load_dwordx4 v1, s[48:51], s11 offen offset:2048 sc1 lds
s_add_u32 s65, s64, 8192
v_pk_mul_f32 v[144:145], v[144:145], v[20:21] op_sel:[0,0] op_sel_hi:[1,0]
v_pk_mul_f32 v[146:147], v[146:147], v[20:21] op_sel:[0,0] op_sel_hi:[1,0]
v_pk_mul_f32 v[148:149], v[148:149], v[20:21] op_sel:[0,0] op_sel_hi:[1,0]
v_pk_mul_f32 v[150:151], v[150:151], v[20:21] op_sel:[0,0] op_sel_hi:[1,0]
v_cvt_pk_bf16_f32 v144, v144, v145
v_cvt_pk_bf16_f32 v145, v146, v147
v_cvt_pk_bf16_f32 v146, v148, v149
v_cvt_pk_bf16_f32 v147, v150, v151
buffer_store_dwordx4 v[144:147], v1, s[48:51], s65 offen offset:0 sc1
buffer_load_dwordx4 v1, s[48:51], s11 offen offset:3072 sc1 lds
s_add_u32 s11, s11, 8192
s_add_u32 s65, s64, 12288
v_pk_mul_f32 v[152:153], v[152:153], v[20:21] op_sel:[0,0] op_sel_hi:[1,0]
v_pk_mul_f32 v[154:155], v[154:155], v[20:21] op_sel:[0,0] op_sel_hi:[1,0]
v_pk_mul_f32 v[156:157], v[156:157], v[20:21] op_sel:[0,0] op_sel_hi:[1,0]
v_pk_mul_f32 v[158:159], v[158:159], v[20:21] op_sel:[0,0] op_sel_hi:[1,0]
v_cvt_pk_bf16_f32 v152, v152, v153
v_cvt_pk_bf16_f32 v153, v154, v155
v_cvt_pk_bf16_f32 v154, v156, v157
v_cvt_pk_bf16_f32 v155, v158, v159
buffer_store_dwordx4 v[152:155], v1, s[48:51], s65 offen offset:0 sc1
s_add_u32 m0, s17, 16384
s_nop 0
buffer_load_dwordx4 v2, s[36:39], s16 offen offset:0 lds
s_add_u32 s65, s64, 0
v_pk_mul_f32 v[160:161], v[160:161], v[20:21] op_sel:[0,1] op_sel_hi:[1,1]
v_pk_mul_f32 v[162:163], v[162:163], v[20:21] op_sel:[0,1] op_sel_hi:[1,1]
v_pk_mul_f32 v[164:165], v[164:165], v[20:21] op_sel:[0,1] op_sel_hi:[1,1]
v_pk_mul_f32 v[166:167], v[166:167], v[20:21] op_sel:[0,1] op_sel_hi:[1,1]
v_cvt_pk_bf16_f32 v160, v160, v161
v_cvt_pk_bf16_f32 v161, v162, v163
v_cvt_pk_bf16_f32 v162, v164, v165
v_cvt_pk_bf16_f32 v163, v166, v167
buffer_store_dwordx4 v[160:163], v1, s[48:51], s65 offen offset:1024 sc1
buffer_load_dwordx4 v3, s[36:39], s16 offen offset:1024 lds
s_add_u32 s65, s64, 4096
v_pk_mul_f32 v[168:169], v[168:169], v[20:21] op_sel:[0,1] op_sel_hi:[1,1]
v_pk_mul_f32 v[170:171], v[170:171], v[20:21] op_sel:[0,1] op_sel_hi:[1,1]
v_pk_mul_f32 v[172:173], v[172:173], v[20:21] op_sel:[0,1] op_sel_hi:[1,1]
v_pk_mul_f32 v[174:175], v[174:175], v[20:21] op_sel:[0,1] op_sel_hi:[1,1]
v_cvt_pk_bf16_f32 v168, v168, v169
v_cvt_pk_bf16_f32 v169, v170, v171
v_cvt_pk_bf16_f32 v170, v172, v173
v_cvt_pk_bf16_f32 v171, v174, v175
buffer_store_dwordx4 v[168:171], v1, s[48:51], s65 offen offset:1024 sc1
buffer_load_dwordx4 v4, s[36:39], s16 offen offset:2048 lds
s_add_u32 s65, s64, 8192
v_pk_mul_f32 v[176:177], v[176:177], v[20:21] op_sel:[0,1] op_sel_hi:[1,1]
v_pk_mul_f32 v[178:179], v[178:179], v[20:21] op_sel:[0,1] op_sel_hi:[1,1]
v_pk_mul_f32 v[180:181], v[180:181], v[20:21] op_sel:[0,1] op_sel_hi:[1,1]
v_pk_mul_f32 v[182:183], v[182:183], v[20:21] op_sel:[0,1] op_sel_hi:[1,1]
v_cvt_pk_bf16_f32 v176, v176, v177
v_cvt_pk_bf16_f32 v177, v178, v179
v_cvt_pk_bf16_f32 v178, v180, v181
v_cvt_pk_bf16_f32 v179, v182, v183
buffer_store_dwordx4 v[176:179], v1, s[48:51], s65 offen offset:1024 sc1
buffer_load_dwordx4 v5, s[36:39], s16 offen offset:3072 lds
s_add_u32 s16, s16, 65536
s_add_u32 s65, s64, 12288
v_pk_mul_f32 v[184:185], v[184:185], v[20:21] op_sel:[0,1] op_sel_hi:[1,1]
v_pk_mul_f32 v[186:187], v[186:187], v[20:21] op_sel:[0,1] op_sel_hi:[1,1]
v_pk_mul_f32 v[188:189], v[188:189], v[20:21] op_sel:[0,1] op_sel_hi:[1,1]
v_pk_mul_f32 v[190:191], v[190:191], v[20:21] op_sel:[0,1] op_sel_hi:[1,1]
v_cvt_pk_bf16_f32 v184, v184, v185
v_cvt_pk_bf16_f32 v185, v186, v187
v_cvt_pk_bf16_f32 v186, v188, v189
v_cvt_pk_bf16_f32 v187, v190, v191
buffer_store_dwordx4 v[184:187], v1, s[48:51], s65 offen offset:1024 sc1
s_add_u32 m0, s17, 32768
s_nop 0
buffer_load_dwordx4 v1, s[48:51], s11 offen offset:0 sc1 lds
s_add_u32 s65, s64, 0
v_pk_mul_f32 v[192:193], v[192:193], v[22:23] op_sel:[0,0] op_sel_hi:[1,0]
v_pk_mul_f32 v[194:195], v[194:195], v[22:23] op_sel:[0,0] op_sel_hi:[1,0]
v_pk_mul_f32 v[196:197], v[196:197], v[22:23] op_sel:[0,0] op_sel_hi:[1,0]
v_pk_mul_f32 v[198:199], v[198:199], v[22:23] op_sel:[0,0] op_sel_hi:[1,0]
v_cvt_pk_bf16_f32 v192, v192, v193
v_cvt_pk_bf16_f32 v193, v194, v195
v_cvt_pk_bf16_f32 v194, v196, v197
v_cvt_pk_bf16_f32 v195, v198, v199
buffer_store_dwordx4 v[192:195], v1, s[48:51], s65 offen offset:2048 sc1
buffer_load_dwordx4 v1, s[48:51], s11 offen offset:1024 sc1 lds
s_add_u32 s65, s64, 4096
v_pk_mul_f32 v[200:201], v[200:201], v[22:23] op_sel:[0,0] op_sel_hi:[1,0]
v_pk_mul_f32 v[202:203], v[202:203], v[22:23] op_sel:[0,0] op_sel_hi:[1,0]
v_pk_mul_f32 v[204:205], v[204:205], v[22:23] op_sel:[0,0] op_sel_hi:[1,0]
v_pk_mul_f32 v[206:207], v[206:207], v[22:23] op_sel:[0,0] op_sel_hi:[1,0]
v_cvt_pk_bf16_f32 v200, v200, v201
v_cvt_pk_bf16_f32 v201, v202, v203
v_cvt_pk_bf16_f32 v202, v204, v205
v_cvt_pk_bf16_f32 v203, v206, v207
buffer_store_dwordx4 v[200:203], v1, s[48:51], s65 offen offset:2048 sc1
buffer_load_dwordx4 v1, s[48:51], s11 offen offset:2048 sc1 lds
s_add_u32 s65, s64, 8192
v_pk_mul_f32 v[208:209], v[208:209], v[22:23] op_sel:[0,0] op_sel_hi:[1,0]
v_pk_mul_f32 v[210:211], v[210:211], v[22:23] op_sel:[0,0] op_sel_hi:[1,0]
v_pk_mul_f32 v[212:213], v[212:213], v[22:23] op_sel:[0,0] op_sel_hi:[1,0]
v_pk_mul_f32 v[214:215], v[214:215], v[22:23] op_sel:[0,0] op_sel_hi:[1,0]
v_cvt_pk_bf16_f32 v208, v208, v209
v_cvt_pk_bf16_f32 v209, v210, v211
v_cvt_pk_bf16_f32 v210, v212, v213
v_cvt_pk_bf16_f32 v211, v214, v215
buffer_store_dwordx4 v[208:211], v1, s[48:51], s65 offen offset:2048 sc1
buffer_load_dwordx4 v1, s[48:51], s11 offen offset:3072 sc1 lds
s_add_u32 s11, s11, 8192
s_add_u32 s65, s64, 12288
v_pk_mul_f32 v[216:217], v[216:217], v[22:23] op_sel:[0,0] op_sel_hi:[1,0]
v_pk_mul_f32 v[218:219], v[218:219], v[22:23] op_sel:[0,0] op_sel_hi:[1,0]
v_pk_mul_f32 v[220:221], v[220:221], v[22:23] op_sel:[0,0] op_sel_hi:[1,0]
v_pk_mul_f32 v[222:223], v[222:223], v[22:23] op_sel:[0,0] op_sel_hi:[1,0]
v_cvt_pk_bf16_f32 v216, v216, v217
v_cvt_pk_bf16_f32 v217, v218, v219
v_cvt_pk_bf16_f32 v218, v220, v221
v_cvt_pk_bf16_f32 v219, v222, v223
buffer_store_dwordx4 v[216:219], v1, s[48:51], s65 offen offset:2048 sc1
s_add_u32 m0, s17, 49152
s_nop 0
buffer_load_dwordx4 v2, s[36:39], s16 offen offset:0 lds
s_add_u32 s65, s64, 0
v_pk_mul_f32 v[224:225], v[224:225], v[22:23] op_sel:[0,1] op_sel_hi:[1,1]
v_pk_mul_f32 v[226:227], v[226:227], v[22:23] op_sel:[0,1] op_sel_hi:[1,1]
v_pk_mul_f32 v[228:229], v[228:229], v[22:23] op_sel:[0,1] op_sel_hi:[1,1]
v_pk_mul_f32 v[230:231], v[230:231], v[22:23] op_sel:[0,1] op_sel_hi:[1,1]
v_cvt_pk_bf16_f32 v224, v224, v225
v_cvt_pk_bf16_f32 v225, v226, v227
v_cvt_pk_bf16_f32 v226, v228, v229
v_cvt_pk_bf16_f32 v227, v230, v231
buffer_store_dwordx4 v[224:227], v1, s[48:51], s65 offen offset:3072 sc1
buffer_load_dwordx4 v3, s[36:39], s16 offen offset:1024 lds
s_add_u32 s65, s64, 4096
v_pk_mul_f32 v[232:233], v[232:233], v[22:23] op_sel:[0,1] op_sel_hi:[1,1]
v_pk_mul_f32 v[234:235], v[234:235], v[22:23] op_sel:[0,1] op_sel_hi:[1,1]
v_pk_mul_f32 v[236:237], v[236:237], v[22:23] op_sel:[0,1] op_sel_hi:[1,1]
v_pk_mul_f32 v[238:239], v[238:239], v[22:23] op_sel:[0,1] op_sel_hi:[1,1]
v_cvt_pk_bf16_f32 v232, v232, v233
v_cvt_pk_bf16_f32 v233, v234, v235
v_cvt_pk_bf16_f32 v234, v236, v237
v_cvt_pk_bf16_f32 v235, v238, v239
buffer_store_dwordx4 v[232:235], v1, s[48:51], s65 offen offset:3072 sc1
buffer_load_dwordx4 v4, s[36:39], s16 offen offset:2048 lds
s_add_u32 s65, s64, 8192
v_pk_mul_f32 v[240:241], v[240:241], v[22:23] op_sel:[0,1] op_sel_hi:[1,1]
v_pk_mul_f32 v[242:243], v[242:243], v[22:23] op_sel:[0,1] op_sel_hi:[1,1]
v_pk_mul_f32 v[244:245], v[244:245], v[22:23] op_sel:[0,1] op_sel_hi:[1,1]
v_pk_mul_f32 v[246:247], v[246:247], v[22:23] op_sel:[0,1] op_sel_hi:[1,1]
v_cvt_pk_bf16_f32 v240, v240, v241
v_cvt_pk_bf16_f32 v241, v242, v243
v_cvt_pk_bf16_f32 v242, v244, v245
v_cvt_pk_bf16_f32 v243, v246, v247
buffer_store_dwordx4 v[240:243], v1, s[48:51], s65 offen offset:3072 sc1
buffer_load_dwordx4 v5, s[36:39], s16 offen offset:3072 lds
s_add_u32 s16, s16, 65536
s_add_u32 s65, s64, 12288
v_pk_mul_f32 v[248:249], v[248:249], v[22:23] op_sel:[0,1] op_sel_hi:[1,1]
v_pk_mul_f32 v[250:251], v[250:251], v[22:23] op_sel:[0,1] op_sel_hi:[1,1]
v_pk_mul_f32 v[252:253], v[252:253], v[22:23] op_sel:[0,1] op_sel_hi:[1,1]
v_pk_mul_f32 v[254:255], v[254:255], v[22:23] op_sel:[0,1] op_sel_hi:[1,1]
v_cvt_pk_bf16_f32 v248, v248, v249
v_cvt_pk_bf16_f32 v249, v250, v251
v_cvt_pk_bf16_f32 v250, v252, v253
v_cvt_pk_bf16_f32 v251, v254, v255
buffer_store_dwordx4 v[248:251], v1, s[48:51], s65 offen offset:3072 sc1
v_mov_b64 v[20:21], 0
v_mov_b64 v[22:23], 0
v_mov_b32 v44, 0xf149f2ca
v_mov_b32 v45, 0xf149f2ca
v_mov_b32 v46, 0xf149f2ca
v_mov_b32 v47, 0xf149f2ca
v_mov_b64 v[56:57], 0
v_mov_b64 v[58:59], 0
v_mov_b64 v[60:61], 0
ds_read_b128 v[64:67], v10 offset:2048
ds_read_b128 v[68:71], v10 offset:3072
ds_read_b128 v[72:75], v10 offset:0
ds_read_b128 v[76:79], v10 offset:1024
v_mfma_f32_32x32x16_bf16 v[192:207], v[56:59], v[56:59], 0
ds_read_b128 v[80:83], v10 offset:6144
ds_read_b128 v[84:87], v10 offset:7168
ds_read_b128 v[88:91], v10 offset:4096
ds_read_b128 v[92:95], v10 offset:5120
v_mfma_f32_32x32x16_bf16 v[208:223], v[56:59], v[56:59], 0
ds_read_b128 v[96:99], v10 offset:10240
ds_read_b128 v[100:103], v10 offset:11264
ds_read_b128 v[104:107], v10 offset:8192
ds_read_b128 v[108:111], v10 offset:9216
v_mfma_f32_32x32x16_bf16 v[224:239], v[56:59], v[56:59], 0
ds_read_b128 v[112:115], v10 offset:14336
ds_read_b128 v[116:119], v10 offset:15360
ds_read_b128 v[120:123], v10 offset:12288
ds_read_b128 v[124:127], v10 offset:13312
v_mfma_f32_32x32x16_bf16 v[240:255], v[56:59], v[56:59], 0
s_lshr_b32 s65, s58, 1
s_and_b32 s66, s58, 1
s_lshl_b32 s67, s65, 13
v_add_u32 v9, s67, v1
v_lshrrev_b32 v6, 2, v0
v_lshlrev_b32 v6, 7, v6
v_and_b32 v7, 3, v0
v_lshl_add_u32 v6, v7, 3, v6
v_bfe_u32 v7, v0, 3, 2
v_lshl_add_u32 v6, v7, 5, v6
s_lshl_b32 s67, s66, 13
s_add_u32 s67, s67, 16384
v_add_u32 v6, s67, v6
v_xor_b32 v7, 32, v6
s_sub_u32 s60, 33, s83
s_sub_u32 s60, s60, s58
s_mul_i32 s64, s60, 525312
s_lshl_b32 s68, s56, 14
s_add_u32 s64, s64, s68
s_sub_u32 s64, s64, 2048
s_mov_b32 s80, 2
s_branch L_c_fin
L_s7_end:
L_noffn:
buffer_load_dwordx4 v10, s[4:7], s69 offen offset:0 lds
rda 132,6,2048
s_bfe_i32 s65, s56, 0x10002
rda 148,7,2048
v_cvt_pk_bf16_f32 v120, v240, v241
v_cvt_pk_bf16_f32 v121, v242, v243
buffer_store_dwordx4 v[64:67], v1, s[48:51], s96 offen offset:0 sc1
v_cvt_pk_bf16_f32 v122, v244, v245
v_cvt_pk_bf16_f32 v123, v246, v247
s_and_b32 s65, s65, 15
s_xor_b32 s8, s65, s57
s_lshr_b32 s10, s56, 3
s_and_b32 s9, s56, 3
buffer_load_dwordx4 v11, s[4:7], s69 offen offset:1024 lds
s_waitcnt lgkmcnt(0)
s_add_u32 m0, s71, 2048
s_add_u32 s69, s79, 16384
s_lshl_b32 s17, s58, 12
s_lshr_b32 s65, s58, 1
s_and_b32 s66, s58, 1
buffer_load_dwordx4 v10, s[4:7], s69 offen offset:0 lds
s_waitcnt lgkmcnt(0)
s_lshl_b32 s67, s8, 1
s_add_u32 s67, s67, s65
s_mul_i32 s68, s10, 14
s_add_u32 s68, s68, s66
buffer_load_dwordx4 v11, s[4:7], s69 offen offset:1024 lds
s_mul_i32 s11, s67, 230400
s_lshl_b32 s16, s68, 12
s_add_u32 s11, s11, s16
s_waitcnt vmcnt(30)
rda 136,6,4096
s_add_u32 s11, s11, 50331648
rda 152,7,4096
s_lshl_b32 s16, s68, 15
s_lshl_b32 s68, s56, 2
s_add_u32 s68, s68, s66
buffer_store_dwordx4 v[68:71], v1, s[48:51], s96 offen offset:1024 sc1
s_lshl_b32 s18, s68, 12
s_lshl_b32 s19, s68, 15
s_lshl_b32 s68, s9, 1
s_waitcnt lgkmcnt(0)
s_add_u32 m0, s71, 4096
s_add_u32 s69, s79, 32768
s_add_u32 s68, s68, s65
s_lshl_b32 s68, s68, 7
s_add_u32 s16, s16, s68
s_waitcnt lgkmcnt(0)
s_add_u32 s19, s19, s68
s_sub_u32 s65, 7, s58
s_lshl_b32 s23, s65, 14
buffer_load_dwordx4 v10, s[4:7], s69 offen offset:0 lds
s_add_u32 s65, s58, 4
s_lshl_b32 s21, s65, 14
s_sub_u32 s40, 162816, s17
buffer_load_dwordx4 v11, s[4:7], s69 offen offset:1024 lds
s_add_u32 m0, s70, 49152
s_add_u32 s69, s94, 0
s_add_u32 s22, s17, 150528
buffer_load_dwordx4 v12, s[32:35], s69 offen offset:0 lds
s_lshl_b32 s65, s58, 3
s_xor_b32 s65, s65, 24
s_add_u32 s65, s65, s57
s_add_u32 s65, s65, 1
s_waitcnt vmcnt(28)
rda 140,6,6144
buffer_load_dwordx4 v13, s[32:35], s69 offen offset:1024 lds
rda 156,7,6144
s_lshr_b32 s65, s65, 5
s_waitcnt lgkmcnt(0)
s_mul_i32 s65, s65, 0x18000
s_add_u32 s21, s21, s65
s_lshr_b32 s65, s65, 2
buffer_load_dwordx4 v14, s[32:35], s69 offen offset:2048 lds
s_add_u32 s22, s22, s65
s_lshr_b32 s65, s2, 3
s_lshl_b32 s65, s65, 2
buffer_load_dwordx4 v15, s[32:35], s69 offen offset:3072 lds
s_waitcnt lgkmcnt(0)
s_add_u32 m0, s71, 6144
s_add_u32 s69, s79, 49152
buffer_load_dwordx4 v10, s[4:7], s69 offen offset:0 lds
s_add_u32 s65, s65, s58
s_mul_i32 s66, s10, 112
s_add_u32 s66, s66, s65
s_lshl_b32 s41, s66, 12
buffer_store_dwordx4 v[72:75], v1, s[48:51], s96 offen offset:2048 sc1
s_lshl_b32 s66, s10, 20
s_lshl_b32 s42, s65, 13
s_add_u32 s42, s42, s66
s_mul_i32 s20, s65, 1280
s_add_u32 s20, s20, s66
s_add_u32 s20, s20, 917504
s_waitcnt lgkmcnt(0)
s_add_u32 s43, s57, 1
s_lshr_b32 s43, s43, 3
s_lshl_b32 s43, s43, 28
s_waitcnt vmcnt(30)
buffer_load_dwordx4 v11, s[4:7], s69 offen offset:1024 lds
rda 160,6,8192
rda 176,7,8192
buffer_store_dwordx4 v[76:79], v1, s[48:51], s96 offen offset:3072 sc1
s_waitcnt lgkmcnt(0)
s_add_u32 m0, s71, 8192
s_add_u32 s69, s79, 128
s_waitcnt lgkmcnt(0)
buffer_load_dwordx4 v10, s[4:7], s69 offen offset:0 lds
buffer_load_dwordx4 v11, s[4:7], s69 offen offset:1024 lds
s_waitcnt vmcnt(27)
rda 164,6,10240
rda 180,7,10240
s_waitcnt lgkmcnt(0)
s_add_u32 m0, s71, 10240
s_add_u32 s69, s79, 16512
buffer_load_dwordx4 v10, s[4:7], s69 offen offset:0 lds
buffer_load_dwordx4 v11, s[4:7], s69 offen offset:1024 lds
s_add_u32 s72, s72, 0x100000
s_bitset0_b32 s72, 22
s_lshr_b32 s94, s72, 20
buffer_store_dwordx4 v[80:83], v1, s[48:51], s97 offen offset:0 sc1
s_mul_i32 s94, s94, 458752
s_add_u32 s94, s94, s73
s_add_u32 m0, s70, 65536
s_add_u32 s69, s94, 0
v_xor_b32 v2, 0x10000, v2
v_xor_b32 v3, 0x10000, v3
v_xor_b32 v4, 0x10000, v4
v_xor_b32 v5, 0x10000, v5
s_waitcnt lgkmcnt(0)
s_barrier
s_waitcnt vmcnt(28)
buffer_load_dwordx4 v12, s[28:31], s69 offen offset:0 lds
rda 168,6,12288
rda 184,7,12288
buffer_load_dwordx4 v13, s[28:31], s69 offen offset:1024 lds
buffer_load_dwordx4 v14, s[28:31], s69 offen offset:2048 lds
s_waitcnt lgkmcnt(0)
buffer_load_dwordx4 v15, s[28:31], s69 offen offset:3072 lds
s_add_u32 m0, s71, 12288
s_add_u32 s69, s79, 32896
buffer_load_dwordx4 v10, s[4:7], s69 offen offset:0 lds
s_waitcnt vmcnt(30)
rda 172,6,14336
buffer_load_dwordx4 v11, s[4:7], s69 offen offset:1024 lds
rda 188,7,14336
buffer_store_dwordx4 v[84:87], v1, s[48:51], s97 offen offset:1024 sc1
s_waitcnt lgkmcnt(0)
s_add_u32 m0, s71, 14336
s_add_u32 s69, s79, 49280
buffer_load_dwordx4 v10, s[4:7], s69 offen offset:0 lds
buffer_load_dwordx4 v11, s[4:7], s69 offen offset:1024 lds
s_add_u32 m0, s70, 81920
s_add_u32 s69, s94, 0
buffer_store_dwordx4 v[88:91], v1, s[48:51], s97 offen offset:2048 sc1
s_waitcnt lgkmcnt(0)
s_waitcnt vmcnt(28)
rda 192,6,0
rda 208,7,0
buffer_load_dwordx4 v12, s[32:35], s69 offen offset:0 lds
buffer_load_dwordx4 v13, s[32:35], s69 offen offset:1024 lds
s_waitcnt lgkmcnt(0)
buffer_load_dwordx4 v14, s[32:35], s69 offen offset:2048 lds
buffer_load_dwordx4 v15, s[32:35], s69 offen offset:3072 lds
s_add_u32 s72, s72, 0x100000
s_bitset0_b32 s72, 22
s_add_u32 m0, s70, 0
s_add_u32 s69, s72, 0
buffer_store_dwordx4 v[92:95], v1, s[48:51], s97 offen offset:3072 sc1
s_waitcnt lgkmcnt(0)
s_waitcnt vmcnt(31)
rda 196,6,2048
rda 212,7,2048
s_waitcnt lgkmcnt(0)
buffer_store_dwordx4 v[96:99], v1, s[48:51], s98 offen offset:0 sc1
s_waitcnt vmcnt(29)
rda 200,6,4096
rda 216,7,4096
s_waitcnt lgkmcnt(0)
buffer_store_dwordx4 v[100:103], v1, s[48:51], s98 offen offset:1024 sc1
s_waitcnt vmcnt(26) lgkmcnt(0)
s_barrier
buffer_load_dwordx4 v20, s[12:15], s69 offen offset:0 lds
buffer_load_dwordx4 v21, s[12:15], s69 offen offset:1024 lds
s_waitcnt vmcnt(25)
buffer_load_dwordx4 v22, s[12:15], s69 offen offset:2048 lds
rda 204,6,6144
rda 220,7,6144
buffer_load_dwordx4 v23, s[12:15], s69 offen offset:3072 lds
s_waitcnt lgkmcnt(0)
s_add_u32 s72, s72, 0x100000
s_bitset0_b32 s72, 22
s_add_u32 m0, s70, 16384
s_add_u32 s69, s72, 0
buffer_store_dwordx4 v[104:107], v1, s[48:51], s98 offen offset:2048 sc1
s_waitcnt lgkmcnt(0)
s_waitcnt vmcnt(25)
rda 224,6,8192
rda 240,7,8192
s_waitcnt lgkmcnt(0)
buffer_load_dwordx4 v20, s[12:15], s69 offen offset:0 lds
buffer_load_dwordx4 v21, s[12:15], s69 offen offset:1024 lds
s_waitcnt lgkmcnt(0)
buffer_load_dwordx4 v22, s[12:15], s69 offen offset:2048 lds
buffer_load_dwordx4 v23, s[12:15], s69 offen offset:3072 lds
s_add_u32 s72, s72, 0x100000
s_bitset0_b32 s72, 22
s_add_u32 m0, s70, 32768
s_add_u32 s69, s72, 0
buffer_store_dwordx4 v[108:111], v1, s[48:51], s98 offen offset:3072 sc1
s_waitcnt vmcnt(28)
rda 228,6,10240
rda 244,7,10240
s_waitcnt lgkmcnt(0)
buffer_store_dwordx4 v[112:115], v1, s[48:51], s99 offen offset:0 sc1
s_waitcnt lgkmcnt(0)
s_waitcnt vmcnt(22)
rda 232,6,12288
rda 248,7,12288
buffer_store_dwordx4 v[116:119], v1, s[48:51], s99 offen offset:1024 sc1
s_waitcnt lgkmcnt(0)
v_xor_b32 v2, 0x10000, v2
v_xor_b32 v3, 0x10000, v3
s_waitcnt vmcnt(20)
rda 236,6,14336
rda 252,7,14336
v_xor_b32 v4, 0x10000, v4
v_xor_b32 v5, 0x10000, v5
s_waitcnt vmcnt(15) lgkmcnt(0)
s_barrier
buffer_load_dwordx4 v20, s[12:15], s69 offen offset:0 lds
buffer_load_dwordx4 v21, s[12:15], s69 offen offset:1024 lds
buffer_load_dwordx4 v22, s[12:15], s69 offen offset:2048 lds
buffer_load_dwordx4 v23, s[12:15], s69 offen offset:3072 lds
s_add_u32 s72, s72, 0x100000
s_bitset0_b32 s72, 22
s_add_u32 m0, s70, 49152
s_add_u32 s69, s72, 0
s_waitcnt lgkmcnt(0)
v_mul_f32 v128, s77, v128
v_mul_f32 v129, s77, v129
buffer_store_dwordx4 v[120:123], v1, s[48:51], s99 offen offset:2048 sc1
v_exp_f32 v128, v128
v_exp_f32 v129, v129
v_add_f32 v128, 1.0, v128
v_add_f32 v129, 1.0, v129
v_rcp_f32 v128, v128
v_rcp_f32 v129, v129
v_mul_f32 v132, s77, v132
v_mul_f32 v133, s77, v133
s_waitcnt lgkmcnt(0)
v_exp_f32 v132, v132
v_mul_f32 v136, s77, v136
v_mul_f32 v137, s77, v137
v_mul_f32 v140, s77, v140
v_mul_f32 v141, s77, v141
buffer_store_dwordx4 v[124:127], v1, s[48:51], s99 offen offset:3072 sc1
v_exp_f32 v133, v133
v_exp_f32 v136, v136
v_exp_f32 v137, v137
v_exp_f32 v140, v140
v_exp_f32 v141, v141
v_add_f32 v132, 1.0, v132
v_add_f32 v133, 1.0, v133
s_waitcnt lgkmcnt(0)
v_rcp_f32 v132, v132
v_add_f32 v136, 1.0, v136
v_add_f32 v137, 1.0, v137
v_mul_f32 v128, v128, v144
v_mul_f32 v129, v129, v145
v_cvt_pk_bf16_f32 v128, v128, v129
v_mul_f32 v130, s77, v130
v_mul_f32 v131, s77, v131
v_add_f32 v140, 1.0, v140
buffer_load_dwordx4 v20, s[12:15], s69 offen offset:0 lds
v_exp_f32 v130, v130
v_exp_f32 v131, v131
buffer_load_dwordx4 v21, s[12:15], s69 offen offset:1024 lds
v_rcp_f32 v133, v133
v_rcp_f32 v136, v136
v_rcp_f32 v137, v137
s_waitcnt lgkmcnt(0)
v_add_f32 v130, 1.0, v130
v_add_f32 v131, 1.0, v131
buffer_load_dwordx4 v22, s[12:15], s69 offen offset:2048 lds
v_mul_f32 v132, v132, v148
v_mul_f32 v133, v133, v149
buffer_load_dwordx4 v23, s[12:15], s69 offen offset:3072 lds
v_cvt_pk_bf16_f32 v132, v132, v133
v_mul_f32 v134, s77, v134
v_mul_f32 v135, s77, v135
v_mul_f32 v136, v136, v152
v_mul_f32 v137, v137, v153
v_cvt_pk_bf16_f32 v136, v136, v137
v_rcp_f32 v130, v130
v_rcp_f32 v131, v131
v_exp_f32 v134, v134
v_exp_f32 v135, v135
v_mul_f32 v130, v130, v146
v_mul_f32 v131, v131, v147
s_waitcnt lgkmcnt(0)
v_cvt_pk_bf16_f32 v129, v130, v131
v_mul_f32 v160, s77, v160
v_mul_f32 v161, s77, v161
v_add_f32 v134, 1.0, v134
v_add_f32 v135, 1.0, v135
v_mul_f32 v138, s77, v138
v_mul_f32 v139, s77, v139
v_add_f32 v141, 1.0, v141
v_exp_f32 v160, v160
v_exp_f32 v161, v161
v_rcp_f32 v134, v134
v_rcp_f32 v135, v135
v_exp_f32 v138, v138
v_exp_f32 v139, v139
v_rcp_f32 v140, v140
s_waitcnt lgkmcnt(0)
v_rcp_f32 v141, v141
v_add_f32 v160, 1.0, v160
v_add_f32 v161, 1.0, v161
v_mul_f32 v134, v134, v150
v_mul_f32 v135, v135, v151
v_cvt_pk_bf16_f32 v133, v134, v135
v_mul_f32 v164, s77, v164
v_mul_f32 v165, s77, v165
v_add_f32 v138, 1.0, v138
v_rcp_f32 v160, v160
v_rcp_f32 v161, v161
v_exp_f32 v164, v164
v_exp_f32 v165, v165
v_mul_f32 v160, v160, v176
v_mul_f32 v161, v161, v177
v_cvt_pk_bf16_f32 v130, v160, v161
v_mul_f32 v162, s77, v162
v_mul_f32 v163, s77, v163
v_add_f32 v164, 1.0, v164
s_waitcnt lgkmcnt(0)
v_exp_f32 v162, v162
v_add_f32 v165, 1.0, v165
v_add_f32 v139, 1.0, v139
v_mul_f32 v140, v140, v156
v_mul_f32 v141, v141, v157
v_cvt_pk_bf16_f32 v140, v140, v141
v_mul_f32 v142, s77, v142
v_mul_f32 v143, s77, v143
v_exp_f32 v163, v163
v_rcp_f32 v164, v164
v_rcp_f32 v165, v165
v_rcp_f32 v138, v138
v_rcp_f32 v139, v139
v_exp_f32 v142, v142
v_exp_f32 v143, v143
s_waitcnt vmcnt(4) lgkmcnt(0)
s_barrier
v_xor_b32 v2, 0x10000, v2
v_xor_b32 v3, 0x10000, v3
v_xor_b32 v4, 0x10000, v4
v_xor_b32 v5, 0x10000, v5
s_branch L_noffn_end
L_guard:
s_waitcnt vmcnt(0) lgkmcnt(0)
s_nop 15
v_mov_b64 v[128:129], 0
v_mov_b64 v[130:131], 0
v_mov_b64 v[132:133], 0
v_mov_b64 v[134:135], 0
v_mov_b64 v[136:137], 0
v_mov_b64 v[138:139], 0
v_mov_b64 v[140:141], 0
v_mov_b64 v[142:143], 0
v_mov_b64 v[144:145], 0
v_mov_b64 v[146:147], 0
v_mov_b64 v[148:149], 0
v_mov_b64 v[150:151], 0
v_mov_b64 v[152:153], 0
v_mov_b64 v[154:155], 0
v_mov_b64 v[156:157], 0
v_mov_b64 v[158:159], 0
v_mov_b64 v[160:161], 0
v_mov_b64 v[162:163], 0
v_mov_b64 v[164:165], 0
v_mov_b64 v[166:167], 0
v_mov_b64 v[168:169], 0
v_mov_b64 v[170:171], 0
v_mov_b64 v[172:173], 0
v_mov_b64 v[174:175], 0
v_mov_b64 v[176:177], 0
v_mov_b64 v[178:179], 0
v_mov_b64 v[180:181], 0
v_mov_b64 v[182:183], 0
v_mov_b64 v[184:185], 0
v_mov_b64 v[186:187], 0
v_mov_b64 v[188:189], 0
v_mov_b64 v[190:191], 0
v_mov_b64 v[192:193], 0
v_mov_b64 v[194:195], 0
v_mov_b64 v[196:197], 0
v_mov_b64 v[198:199], 0
v_mov_b64 v[200:201], 0
v_mov_b64 v[202:203], 0
v_mov_b64 v[204:205], 0
v_mov_b64 v[206:207], 0
v_mov_b64 v[208:209], 0
v_mov_b64 v[210:211], 0
v_mov_b64 v[212:213], 0
v_mov_b64 v[214:215], 0
v_mov_b64 v[216:217], 0
v_mov_b64 v[218:219], 0
v_mov_b64 v[220:221], 0
v_mov_b64 v[222:223], 0
v_mov_b64 v[224:225], 0
v_mov_b64 v[226:227], 0
v_mov_b64 v[228:229], 0
v_mov_b64 v[230:231], 0
v_mov_b64 v[232:233], 0
v_mov_b64 v[234:235], 0
v_mov_b64 v[236:237], 0
v_mov_b64 v[238:239], 0
v_mov_b64 v[240:241], 0
v_mov_b64 v[242:243], 0
v_mov_b64 v[244:245], 0
v_mov_b64 v[246:247], 0
v_mov_b64 v[248:249], 0
v_mov_b64 v[250:251], 0
v_mov_b64 v[252:253], 0
v_mov_b64 v[254:255], 0
v_mov_b32 v20, 0
v_mov_b32 v56, 0xff61b1e6
v_mov_b32 v21, 0
v_mov_b32 v57, 0xff61b1e6
v_mov_b32 v22, 0
v_mov_b32 v58, 0xff61b1e6
v_mov_b32 v23, 0
v_mov_b32 v59, 0xff61b1e6
s_mov_b32 s96, 0
s_mov_b32 s97, s85
v_mov_b32 v63, 0xf149f2ca
L_guard_loop:
s_add_u32 s65, s97, 0
buffer_load_dwordx4 a[0:3], v1, s[48:51], s65 offen offset:0 sc1
buffer_load_dwordx4 a[4:7], v1, s[48:51], s65 offen offset:1024 sc1
buffer_load_dwordx4 a[8:11], v1, s[48:51], s65 offen offset:2048 sc1
buffer_load_dwordx4 a[12:15], v1, s[48:51], s65 offen offset:3072 sc1
s_add_u32 s65, s97, 4096
buffer_load_dwordx4 a[16:19], v1, s[48:51], s65 offen offset:0 sc1
buffer_load_dwordx4 a[20:23], v1, s[48:51], s65 offen offset:1024 sc1
buffer_load_dwordx4 a[24:27], v1, s[48:51], s65 offen offset:2048 sc1
buffer_load_dwordx4 a[28:31], v1, s[48:51], s65 offen offset:3072 sc1
s_add_u32 s65, s97, 8192
buffer_load_dwordx4 a[32:35], v1, s[48:51], s65 offen offset:0 sc1
buffer_load_dwordx4 a[36:39], v1, s[48:51], s65 offen offset:1024 sc1
buffer_load_dwordx4 a[40:43], v1, s[48:51], s65 offen offset:2048 sc1
buffer_load_dwordx4 a[44:47], v1, s[48:51], s65 offen offset:3072 sc1
s_add_u32 s65, s97, 12288
buffer_load_dwordx4 a[48:51], v1, s[48:51], s65 offen offset:0 sc1
buffer_load_dwordx4 a[52:55], v1, s[48:51], s65 offen offset:1024 sc1
buffer_load_dwordx4 a[56:59], v1, s[48:51], s65 offen offset:2048 sc1
buffer_load_dwordx4 a[60:63], v1, s[48:51], s65 offen offset:3072 sc1
s_add_u32 s65, s97, 16384
buffer_load_dwordx4 a[64:67], v1, s[48:51], s65 offen offset:0 sc1
buffer_load_dwordx4 a[68:71], v1, s[48:51], s65 offen offset:1024 sc1
buffer_load_dwordx4 a[72:75], v1, s[48:51], s65 offen offset:2048 sc1
buffer_load_dwordx4 a[76:79], v1, s[48:51], s65 offen offset:3072 sc1
s_add_u32 s65, s97, 20480
buffer_load_dwordx4 a[80:83], v1, s[48:51], s65 offen offset:0 sc1
buffer_load_dwordx4 a[84:87], v1, s[48:51], s65 offen offset:1024 sc1
buffer_load_dwordx4 a[88:91], v1, s[48:51], s65 offen offset:2048 sc1
buffer_load_dwordx4 a[92:95], v1, s[48:51], s65 offen offset:3072 sc1
s_add_u32 s65, s97, 24576
buffer_load_dwordx4 a[96:99], v1, s[48:51], s65 offen offset:0 sc1
buffer_load_dwordx4 a[100:103], v1, s[48:51], s65 offen offset:1024 sc1
buffer_load_dwordx4 a[104:107], v1, s[48:51], s65 offen offset:2048 sc1
buffer_load_dwordx4 a[108:111], v1, s[48:51], s65 offen offset:3072 sc1
s_add_u32 s65, s97, 28672
buffer_load_dwordx4 a[112:115], v1, s[48:51], s65 offen offset:0 sc1
buffer_load_dwordx4 a[116:119], v1, s[48:51], s65 offen offset:1024 sc1
buffer_load_dwordx4 a[120:123], v1, s[48:51], s65 offen offset:2048 sc1
buffer_load_dwordx4 a[124:127], v1, s[48:51], s65 offen offset:3072 sc1
s_waitcnt vmcnt(0)
mav0 32,0,64
mav 32,4,80
mav 32,8,96
mav 32,12,112
mav0 36,16,64
mav 36,20,80
mav 36,24,96
mav 36,28,112
mav0 40,32,64
mav 40,36,80
mav 40,40,96
mav 40,44,112
mav0 44,48,64
mav 44,52,80
mav 44,56,96
mav 44,60,112
s_sub_u32 s65, s60, s96
s_lshl_b32 s65, s65, 2
s_xor_b32 s66, s80, 0
s_add_u32 s65, s65, s66
s_lshl_b32 s65, s65, 4
v_lshrrev_b32 v60, 4, v0
v_lshlrev_b32 v60, 2, v60
v_and_or_b32 v61, v0, 15, s65
v_sub_u32 v60, v61, v60
v_cmp_gt_i32 vcc, 0, v60
s_nop 1
v_cndmask_b32 v32, v32, v63, vcc
v_cmp_gt_i32 vcc, 1, v60
s_nop 1
v_cndmask_b32 v33, v33, v63, vcc
v_cmp_gt_i32 vcc, 2, v60
s_nop 1
v_cndmask_b32 v34, v34, v63, vcc
v_cmp_gt_i32 vcc, 3, v60
s_nop 1
v_cndmask_b32 v35, v35, v63, vcc
v_cmp_gt_i32 vcc, 16, v60
s_nop 1
v_cndmask_b32 v36, v36, v63, vcc
v_cmp_gt_i32 vcc, 17, v60
s_nop 1
v_cndmask_b32 v37, v37, v63, vcc
v_cmp_gt_i32 vcc, 18, v60
s_nop 1
v_cndmask_b32 v38, v38, v63, vcc
v_cmp_gt_i32 vcc, 19, v60
s_nop 1
v_cndmask_b32 v39, v39, v63, vcc
v_cmp_gt_i32 vcc, 32, v60
s_nop 1
v_cndmask_b32 v40, v40, v63, vcc
v_cmp_gt_i32 vcc, 33, v60
s_nop 1
v_cndmask_b32 v41, v41, v63, vcc
v_cmp_gt_i32 vcc, 34, v60
s_nop 1
v_cndmask_b32 v42, v42, v63, vcc
v_cmp_gt_i32 vcc, 35, v60
s_nop 1
v_cndmask_b32 v43, v43, v63, vcc
v_cmp_gt_i32 vcc, 48, v60
s_nop 1
v_cndmask_b32 v44, v44, v63, vcc
v_cmp_gt_i32 vcc, 49, v60
s_nop 1
v_cndmask_b32 v45, v45, v63, vcc
v_cmp_gt_i32 vcc, 50, v60
s_nop 1
v_cndmask_b32 v46, v46, v63, vcc
v_cmp_gt_i32 vcc, 51, v60
s_nop 1
v_cndmask_b32 v47, v47, v63, vcc
v_max3_f32 v61, v32, v33, v56
v_max3_f32 v61, v34, v35, v61
v_max3_f32 v61, v36, v37, v61
v_max3_f32 v61, v38, v39, v61
v_max3_f32 v61, v40, v41, v61
v_max3_f32 v61, v42, v43, v61
v_max3_f32 v61, v44, v45, v61
v_max3_f32 v61, v46, v47, v61
v_mov_b32 v62, v61
s_nop 1
v_permlane32_swap_b32 v62, v61
v_max_f32 v61, v61, v62
v_mov_b32 v62, v61
s_nop 1
v_permlane16_swap_b32 v62, v61
v_max_f32 v61, v61, v62
v_sub_f32 v62, v56, v61
v_exp_f32 v62, v62
v_mov_b32 v56, v61
v_sub_f32 v32, v32, v61
v_sub_f32 v33, v33, v61
v_sub_f32 v34, v34, v61
v_sub_f32 v35, v35, v61
v_sub_f32 v36, v36, v61
v_sub_f32 v37, v37, v61
v_sub_f32 v38, v38, v61
v_sub_f32 v39, v39, v61
v_sub_f32 v40, v40, v61
v_sub_f32 v41, v41, v61
v_sub_f32 v42, v42, v61
v_sub_f32 v43, v43, v61
v_sub_f32 v44, v44, v61
v_sub_f32 v45, v45, v61
v_sub_f32 v46, v46, v61
v_sub_f32 v47, v47, v61
v_exp_f32 v32, v32
v_exp_f32 v33, v33
v_exp_f32 v34, v34
v_exp_f32 v35, v35
v_exp_f32 v36, v36
v_exp_f32 v37, v37
v_exp_f32 v38, v38
v_exp_f32 v39, v39
v_exp_f32 v40, v40
v_exp_f32 v41, v41
v_exp_f32 v42, v42
v_exp_f32 v43, v43
v_exp_f32 v44, v44
v_exp_f32 v45, v45
v_exp_f32 v46, v46
v_exp_f32 v47, v47
v_mul_f32 v20, v20, v62
v_mul_f32 v128, v128, v62
v_mul_f32 v129, v129, v62
v_mul_f32 v130, v130, v62
v_mul_f32 v131, v131, v62
v_mul_f32 v132, v132, v62
v_mul_f32 v133, v133, v62
v_mul_f32 v134, v134, v62
v_mul_f32 v135, v135, v62
v_mul_f32 v136, v136, v62
v_mul_f32 v137, v137, v62
v_mul_f32 v138, v138, v62
v_mul_f32 v139, v139, v62
v_mul_f32 v140, v140, v62
v_mul_f32 v141, v141, v62
v_mul_f32 v142, v142, v62
v_mul_f32 v143, v143, v62
v_mul_f32 v144, v144, v62
v_mul_f32 v145, v145, v62
v_mul_f32 v146, v146, v62
v_mul_f32 v147, v147, v62
v_mul_f32 v148, v148, v62
v_mul_f32 v149, v149, v62
v_mul_f32 v150, v150, v62
v_mul_f32 v151, v151, v62
v_mul_f32 v152, v152, v62
v_mul_f32 v153, v153, v62
v_mul_f32 v154, v154, v62
v_mul_f32 v155, v155, v62
v_mul_f32 v156, v156, v62
v_mul_f32 v157, v157, v62
v_mul_f32 v158, v158, v62
v_mul_f32 v159, v159, v62
v_add_f32 v20, v20, v32
v_add_f32 v20, v20, v33
v_add_f32 v20, v20, v34
v_add_f32 v20, v20, v35
v_add_f32 v20, v20, v36
v_add_f32 v20, v20, v37
v_add_f32 v20, v20, v38
v_add_f32 v20, v20, v39
v_add_f32 v20, v20, v40
v_add_f32 v20, v20, v41
v_add_f32 v20, v20, v42
v_add_f32 v20, v20, v43
v_add_f32 v20, v20, v44
v_add_f32 v20, v20, v45
v_add_f32 v20, v20, v46
v_add_f32 v20, v20, v47
v_cvt_pk_bf16_f32 v48, v32, v33
v_cvt_pk_bf16_f32 v49, v34, v35
v_cvt_pk_bf16_f32 v50, v36, v37
v_cvt_pk_bf16_f32 v51, v38, v39
v_cvt_pk_bf16_f32 v52, v40, v41
v_cvt_pk_bf16_f32 v53, v42, v43
v_cvt_pk_bf16_f32 v54, v44, v45
v_cvt_pk_bf16_f32 v55, v46, v47
mav 128,64,48
s_nop 0
mav 128,68,52
mav 132,76,52
mav 132,72,48
mav 136,80,48
mav 136,84,52
mav 140,92,52
mav 140,88,48
mav 144,96,48
mav 144,100,52
mav 148,108,52
mav 148,104,48
mav 152,112,48
mav 152,116,52
mav 156,124,52
mav 156,120,48
mav0 32,0,68
mav 32,4,84
mav 32,8,100
mav 32,12,116
mav0 36,16,68
mav 36,20,84
mav 36,24,100
mav 36,28,116
mav0 40,32,68
mav 40,36,84
mav 40,40,100
mav 40,44,116
mav0 44,48,68
mav 44,52,84
mav 44,56,100
mav 44,60,116
s_sub_u32 s65, s60, s96
s_lshl_b32 s65, s65, 2
s_xor_b32 s66, s80, 1
s_add_u32 s65, s65, s66
s_lshl_b32 s65, s65, 4
v_lshrrev_b32 v60, 4, v0
v_lshlrev_b32 v60, 2, v60
v_and_or_b32 v61, v0, 15, s65
v_sub_u32 v60, v61, v60
v_cmp_gt_i32 vcc, 0, v60
s_nop 1
v_cndmask_b32 v32, v32, v63, vcc
v_cmp_gt_i32 vcc, 1, v60
s_nop 1
v_cndmask_b32 v33, v33, v63, vcc
v_cmp_gt_i32 vcc, 2, v60
s_nop 1
v_cndmask_b32 v34, v34, v63, vcc
v_cmp_gt_i32 vcc, 3, v60
s_nop 1
v_cndmask_b32 v35, v35, v63, vcc
v_cmp_gt_i32 vcc, 16, v60
s_nop 1
v_cndmask_b32 v36, v36, v63, vcc
v_cmp_gt_i32 vcc, 17, v60
s_nop 1
v_cndmask_b32 v37, v37, v63, vcc
v_cmp_gt_i32 vcc, 18, v60
s_nop 1
v_cndmask_b32 v38, v38, v63, vcc
v_cmp_gt_i32 vcc, 19, v60
s_nop 1
v_cndmask_b32 v39, v39, v63, vcc
v_cmp_gt_i32 vcc, 32, v60
s_nop 1
v_cndmask_b32 v40, v40, v63, vcc
v_cmp_gt_i32 vcc, 33, v60
s_nop 1
v_cndmask_b32 v41, v41, v63, vcc
v_cmp_gt_i32 vcc, 34, v60
s_nop 1
v_cndmask_b32 v42, v42, v63, vcc
v_cmp_gt_i32 vcc, 35, v60
s_nop 1
v_cndmask_b32 v43, v43, v63, vcc
v_cmp_gt_i32 vcc, 48, v60
s_nop 1
v_cndmask_b32 v44, v44, v63, vcc
v_cmp_gt_i32 vcc, 49, v60
s_nop 1
v_cndmask_b32 v45, v45, v63, vcc
v_cmp_gt_i32 vcc, 50, v60
s_nop 1
v_cndmask_b32 v46, v46, v63, vcc
v_cmp_gt_i32 vcc, 51, v60
s_nop 1
v_cndmask_b32 v47, v47, v63, vcc
v_max3_f32 v61, v32, v33, v57
v_max3_f32 v61, v34, v35, v61
v_max3_f32 v61, v36, v37, v61
v_max3_f32 v61, v38, v39, v61
v_max3_f32 v61, v40, v41, v61
v_max3_f32 v61, v42, v43, v61
v_max3_f32 v61, v44, v45, v61
v_max3_f32 v61, v46, v47, v61
v_mov_b32 v62, v61
s_nop 1
v_permlane32_swap_b32 v62, v61
v_max_f32 v61, v61, v62
v_mov_b32 v62, v61
s_nop 1
v_permlane16_swap_b32 v62, v61
v_max_f32 v61, v61, v62
v_sub_f32 v62, v57, v61
v_exp_f32 v62, v62
v_mov_b32 v57, v61
v_sub_f32 v32, v32, v61
v_sub_f32 v33, v33, v61
v_sub_f32 v34, v34, v61
v_sub_f32 v35, v35, v61
v_sub_f32 v36, v36, v61
v_sub_f32 v37, v37, v61
v_sub_f32 v38, v38, v61
v_sub_f32 v39, v39, v61
v_sub_f32 v40, v40, v61
v_sub_f32 v41, v41, v61
v_sub_f32 v42, v42, v61
v_sub_f32 v43, v43, v61
v_sub_f32 v44, v44, v61
v_sub_f32 v45, v45, v61
v_sub_f32 v46, v46, v61
v_sub_f32 v47, v47, v61
v_exp_f32 v32, v32
v_exp_f32 v33, v33
v_exp_f32 v34, v34
v_exp_f32 v35, v35
v_exp_f32 v36, v36
v_exp_f32 v37, v37
v_exp_f32 v38, v38
v_exp_f32 v39, v39
v_exp_f32 v40, v40
v_exp_f32 v41, v41
v_exp_f32 v42, v42
v_exp_f32 v43, v43
v_exp_f32 v44, v44
v_exp_f32 v45, v45
v_exp_f32 v46, v46
v_exp_f32 v47, v47
v_mul_f32 v21, v21, v62
v_mul_f32 v160, v160, v62
v_mul_f32 v161, v161, v62
v_mul_f32 v162, v162, v62
v_mul_f32 v163, v163, v62
v_mul_f32 v164, v164, v62
v_mul_f32 v165, v165, v62
v_mul_f32 v166, v166, v62
v_mul_f32 v167, v167, v62
v_mul_f32 v168, v168, v62
v_mul_f32 v169, v169, v62
v_mul_f32 v170, v170, v62
v_mul_f32 v171, v171, v62
v_mul_f32 v172, v172, v62
v_mul_f32 v173, v173, v62
v_mul_f32 v174, v174, v62
v_mul_f32 v175, v175, v62
v_mul_f32 v176, v176, v62
v_mul_f32 v177, v177, v62
v_mul_f32 v178, v178, v62
v_mul_f32 v179, v179, v62
v_mul_f32 v180, v180, v62
v_mul_f32 v181, v181, v62
v_mul_f32 v182, v182, v62
v_mul_f32 v183, v183, v62
v_mul_f32 v184, v184, v62
v_mul_f32 v185, v185, v62
v_mul_f32 v186, v186, v62
v_mul_f32 v187, v187, v62
v_mul_f32 v188, v188, v62
v_mul_f32 v189, v189, v62
v_mul_f32 v190, v190, v62
v_mul_f32 v191, v191, v62
v_add_f32 v21, v21, v32
v_add_f32 v21, v21, v33
v_add_f32 v21, v21, v34
v_add_f32 v21, v21, v35
v_add_f32 v21, v21, v36
v_add_f32 v21, v21, v37
v_add_f32 v21, v21, v38
v_add_f32 v21, v21, v39
v_add_f32 v21, v21, v40
v_add_f32 v21, v21, v41
v_add_f32 v21, v21, v42
v_add_f32 v21, v21, v43
v_add_f32 v21, v21, v44
v_add_f32 v21, v21, v45
v_add_f32 v21, v21, v46
v_add_f32 v21, v21, v47
v_cvt_pk_bf16_f32 v48, v32, v33
v_cvt_pk_bf16_f32 v49, v34, v35
v_cvt_pk_bf16_f32 v50, v36, v37
v_cvt_pk_bf16_f32 v51, v38, v39
v_cvt_pk_bf16_f32 v52, v40, v41
v_cvt_pk_bf16_f32 v53, v42, v43
v_cvt_pk_bf16_f32 v54, v44, v45
v_cvt_pk_bf16_f32 v55, v46, v47
mav 160,64,48
s_nop 0
mav 160,68,52
mav 164,76,52
mav 164,72,48
mav 168,80,48
mav 168,84,52
mav 172,92,52
mav 172,88,48
mav 176,96,48
mav 176,100,52
mav 180,108,52
mav 180,104,48
mav 184,112,48
mav 184,116,52
mav 188,124,52
mav 188,120,48
mav0 32,0,72
mav 32,4,88
mav 32,8,104
mav 32,12,120
mav0 36,16,72
mav 36,20,88
mav 36,24,104
mav 36,28,120
mav0 40,32,72
mav 40,36,88
mav 40,40,104
mav 40,44,120
mav0 44,48,72
mav 44,52,88
mav 44,56,104
mav 44,60,120
s_sub_u32 s65, s60, s96
s_lshl_b32 s65, s65, 2
s_xor_b32 s66, s80, 2
s_add_u32 s65, s65, s66
s_lshl_b32 s65, s65, 4
v_lshrrev_b32 v60, 4, v0
v_lshlrev_b32 v60, 2, v60
v_and_or_b32 v61, v0, 15, s65
v_sub_u32 v60, v61, v60
v_cmp_gt_i32 vcc, 0, v60
s_nop 1
v_cndmask_b32 v32, v32, v63, vcc
v_cmp_gt_i32 vcc, 1, v60
s_nop 1
v_cndmask_b32 v33, v33, v63, vcc
v_cmp_gt_i32 vcc, 2, v60
s_nop 1
v_cndmask_b32 v34, v34, v63, vcc
v_cmp_gt_i32 vcc, 3, v60
s_nop 1
v_cndmask_b32 v35, v35, v63, vcc
v_cmp_gt_i32 vcc, 16, v60
s_nop 1
v_cndmask_b32 v36, v36, v63, vcc
v_cmp_gt_i32 vcc, 17, v60
s_nop 1
v_cndmask_b32 v37, v37, v63, vcc
v_cmp_gt_i32 vcc, 18, v60
s_nop 1
v_cndmask_b32 v38, v38, v63, vcc
v_cmp_gt_i32 vcc, 19, v60
s_nop 1
v_cndmask_b32 v39, v39, v63, vcc
v_cmp_gt_i32 vcc, 32, v60
s_nop 1
v_cndmask_b32 v40, v40, v63, vcc
v_cmp_gt_i32 vcc, 33, v60
s_nop 1
v_cndmask_b32 v41, v41, v63, vcc
v_cmp_gt_i32 vcc, 34, v60
s_nop 1
v_cndmask_b32 v42, v42, v63, vcc
v_cmp_gt_i32 vcc, 35, v60
s_nop 1
v_cndmask_b32 v43, v43, v63, vcc
v_cmp_gt_i32 vcc, 48, v60
s_nop 1
v_cndmask_b32 v44, v44, v63, vcc
v_cmp_gt_i32 vcc, 49, v60
s_nop 1
v_cndmask_b32 v45, v45, v63, vcc
v_cmp_gt_i32 vcc, 50, v60
s_nop 1
v_cndmask_b32 v46, v46, v63, vcc
v_cmp_gt_i32 vcc, 51, v60
s_nop 1
v_cndmask_b32 v47, v47, v63, vcc
v_max3_f32 v61, v32, v33, v58
v_max3_f32 v61, v34, v35, v61
v_max3_f32 v61, v36, v37, v61
v_max3_f32 v61, v38, v39, v61
v_max3_f32 v61, v40, v41, v61
v_max3_f32 v61, v42, v43, v61
v_max3_f32 v61, v44, v45, v61
v_max3_f32 v61, v46, v47, v61
v_mov_b32 v62, v61
s_nop 1
v_permlane32_swap_b32 v62, v61
v_max_f32 v61, v61, v62
v_mov_b32 v62, v61
s_nop 1
v_permlane16_swap_b32 v62, v61
v_max_f32 v61, v61, v62
v_sub_f32 v62, v58, v61
v_exp_f32 v62, v62
v_mov_b32 v58, v61
v_sub_f32 v32, v32, v61
v_sub_f32 v33, v33, v61
v_sub_f32 v34, v34, v61
v_sub_f32 v35, v35, v61
v_sub_f32 v36, v36, v61
v_sub_f32 v37, v37, v61
v_sub_f32 v38, v38, v61
v_sub_f32 v39, v39, v61
v_sub_f32 v40, v40, v61
v_sub_f32 v41, v41, v61
v_sub_f32 v42, v42, v61
v_sub_f32 v43, v43, v61
v_sub_f32 v44, v44, v61
v_sub_f32 v45, v45, v61
v_sub_f32 v46, v46, v61
v_sub_f32 v47, v47, v61
v_exp_f32 v32, v32
v_exp_f32 v33, v33
v_exp_f32 v34, v34
v_exp_f32 v35, v35
v_exp_f32 v36, v36
v_exp_f32 v37, v37
v_exp_f32 v38, v38
v_exp_f32 v39, v39
v_exp_f32 v40, v40
v_exp_f32 v41, v41
v_exp_f32 v42, v42
v_exp_f32 v43, v43
v_exp_f32 v44, v44
v_exp_f32 v45, v45
v_exp_f32 v46, v46
v_exp_f32 v47, v47
v_mul_f32 v22, v22, v62
v_mul_f32 v192, v192, v62
v_mul_f32 v193, v193, v62
v_mul_f32 v194, v194, v62
v_mul_f32 v195, v195, v62
v_mul_f32 v196, v196, v62
v_mul_f32 v197, v197, v62
v_mul_f32 v198, v198, v62
v_mul_f32 v199, v199, v62
v_mul_f32 v200, v200, v62
v_mul_f32 v201, v201, v62
v_mul_f32 v202, v202, v62
v_mul_f32 v203, v203, v62
v_mul_f32 v204, v204, v62
v_mul_f32 v205, v205, v62
v_mul_f32 v206, v206, v62
v_mul_f32 v207, v207, v62
v_mul_f32 v208, v208, v62
v_mul_f32 v209, v209, v62
v_mul_f32 v210, v210, v62
v_mul_f32 v211, v211, v62
v_mul_f32 v212, v212, v62
v_mul_f32 v213, v213, v62
v_mul_f32 v214, v214, v62
v_mul_f32 v215, v215, v62
v_mul_f32 v216, v216, v62
v_mul_f32 v217, v217, v62
v_mul_f32 v218, v218, v62
v_mul_f32 v219, v219, v62
v_mul_f32 v220, v220, v62
v_mul_f32 v221, v221, v62
v_mul_f32 v222, v222, v62
v_mul_f32 v223, v223, v62
v_add_f32 v22, v22, v32
v_add_f32 v22, v22, v33
v_add_f32 v22, v22, v34
v_add_f32 v22, v22, v35
v_add_f32 v22, v22, v36
v_add_f32 v22, v22, v37
v_add_f32 v22, v22, v38
v_add_f32 v22, v22, v39
v_add_f32 v22, v22, v40
v_add_f32 v22, v22, v41
v_add_f32 v22, v22, v42
v_add_f32 v22, v22, v43
v_add_f32 v22, v22, v44
v_add_f32 v22, v22, v45
v_add_f32 v22, v22, v46
v_add_f32 v22, v22, v47
v_cvt_pk_bf16_f32 v48, v32, v33
v_cvt_pk_bf16_f32 v49, v34, v35
v_cvt_pk_bf16_f32 v50, v36, v37
v_cvt_pk_bf16_f32 v51, v38, v39
v_cvt_pk_bf16_f32 v52, v40, v41
v_cvt_pk_bf16_f32 v53, v42, v43
v_cvt_pk_bf16_f32 v54, v44, v45
v_cvt_pk_bf16_f32 v55, v46, v47
mav 192,64,48
s_nop 0
mav 192,68,52
mav 196,76,52
mav 196,72,48
mav 200,80,48
mav 200,84,52
mav 204,92,52
mav 204,88,48
mav 208,96,48
mav 208,100,52
mav 212,108,52
mav 212,104,48
mav 216,112,48
mav 216,116,52
mav 220,124,52
mav 220,120,48
mav0 32,0,76
mav 32,4,92
mav 32,8,108
mav 32,12,124
mav0 36,16,76
mav 36,20,92
mav 36,24,108
mav 36,28,124
mav0 40,32,76
mav 40,36,92
mav 40,40,108
mav 40,44,124
mav0 44,48,76
mav 44,52,92
mav 44,56,108
mav 44,60,124
s_sub_u32 s65, s60, s96
s_lshl_b32 s65, s65, 2
s_xor_b32 s66, s80, 3
s_add_u32 s65, s65, s66
s_lshl_b32 s65, s65, 4
v_lshrrev_b32 v60, 4, v0
v_lshlrev_b32 v60, 2, v60
v_and_or_b32 v61, v0, 15, s65
v_sub_u32 v60, v61, v60
v_cmp_gt_i32 vcc, 0, v60
s_nop 1
v_cndmask_b32 v32, v32, v63, vcc
v_cmp_gt_i32 vcc, 1, v60
s_nop 1
v_cndmask_b32 v33, v33, v63, vcc
v_cmp_gt_i32 vcc, 2, v60
s_nop 1
v_cndmask_b32 v34, v34, v63, vcc
v_cmp_gt_i32 vcc, 3, v60
s_nop 1
v_cndmask_b32 v35, v35, v63, vcc
v_cmp_gt_i32 vcc, 16, v60
s_nop 1
v_cndmask_b32 v36, v36, v63, vcc
v_cmp_gt_i32 vcc, 17, v60
s_nop 1
v_cndmask_b32 v37, v37, v63, vcc
v_cmp_gt_i32 vcc, 18, v60
s_nop 1
v_cndmask_b32 v38, v38, v63, vcc
v_cmp_gt_i32 vcc, 19, v60
s_nop 1
v_cndmask_b32 v39, v39, v63, vcc
v_cmp_gt_i32 vcc, 32, v60
s_nop 1
v_cndmask_b32 v40, v40, v63, vcc
v_cmp_gt_i32 vcc, 33, v60
s_nop 1
v_cndmask_b32 v41, v41, v63, vcc
v_cmp_gt_i32 vcc, 34, v60
s_nop 1
v_cndmask_b32 v42, v42, v63, vcc
v_cmp_gt_i32 vcc, 35, v60
s_nop 1
v_cndmask_b32 v43, v43, v63, vcc
v_cmp_gt_i32 vcc, 48, v60
s_nop 1
v_cndmask_b32 v44, v44, v63, vcc
v_cmp_gt_i32 vcc, 49, v60
s_nop 1
v_cndmask_b32 v45, v45, v63, vcc
v_cmp_gt_i32 vcc, 50, v60
s_nop 1
v_cndmask_b32 v46, v46, v63, vcc
v_cmp_gt_i32 vcc, 51, v60
s_nop 1
v_cndmask_b32 v47, v47, v63, vcc
v_max3_f32 v61, v32, v33, v59
v_max3_f32 v61, v34, v35, v61
v_max3_f32 v61, v36, v37, v61
v_max3_f32 v61, v38, v39, v61
v_max3_f32 v61, v40, v41, v61
v_max3_f32 v61, v42, v43, v61
v_max3_f32 v61, v44, v45, v61
v_max3_f32 v61, v46, v47, v61
v_mov_b32 v62, v61
s_nop 1
v_permlane32_swap_b32 v62, v61
v_max_f32 v61, v61, v62
v_mov_b32 v62, v61
s_nop 1
v_permlane16_swap_b32 v62, v61
v_max_f32 v61, v61, v62
v_sub_f32 v62, v59, v61
v_exp_f32 v62, v62
v_mov_b32 v59, v61
v_sub_f32 v32, v32, v61
v_sub_f32 v33, v33, v61
v_sub_f32 v34, v34, v61
v_sub_f32 v35, v35, v61
v_sub_f32 v36, v36, v61
v_sub_f32 v37, v37, v61
v_sub_f32 v38, v38, v61
v_sub_f32 v39, v39, v61
v_sub_f32 v40, v40, v61
v_sub_f32 v41, v41, v61
v_sub_f32 v42, v42, v61
v_sub_f32 v43, v43, v61
v_sub_f32 v44, v44, v61
v_sub_f32 v45, v45, v61
v_sub_f32 v46, v46, v61
v_sub_f32 v47, v47, v61
v_exp_f32 v32, v32
v_exp_f32 v33, v33
v_exp_f32 v34, v34
v_exp_f32 v35, v35
v_exp_f32 v36, v36
v_exp_f32 v37, v37
v_exp_f32 v38, v38
v_exp_f32 v39, v39
v_exp_f32 v40, v40
v_exp_f32 v41, v41
v_exp_f32 v42, v42
v_exp_f32 v43, v43
v_exp_f32 v44, v44
v_exp_f32 v45, v45
v_exp_f32 v46, v46
v_exp_f32 v47, v47
v_mul_f32 v23, v23, v62
v_mul_f32 v224, v224, v62
v_mul_f32 v225, v225, v62
v_mul_f32 v226, v226, v62
v_mul_f32 v227, v227, v62
v_mul_f32 v228, v228, v62
v_mul_f32 v229, v229, v62
v_mul_f32 v230, v230, v62
v_mul_f32 v231, v231, v62
v_mul_f32 v232, v232, v62
v_mul_f32 v233, v233, v62
v_mul_f32 v234, v234, v62
v_mul_f32 v235, v235, v62
v_mul_f32 v236, v236, v62
v_mul_f32 v237, v237, v62
v_mul_f32 v238, v238, v62
v_mul_f32 v239, v239, v62
v_mul_f32 v240, v240, v62
v_mul_f32 v241, v241, v62
v_mul_f32 v242, v242, v62
v_mul_f32 v243, v243, v62
v_mul_f32 v244, v244, v62
v_mul_f32 v245, v245, v62
v_mul_f32 v246, v246, v62
v_mul_f32 v247, v247, v62
v_mul_f32 v248, v248, v62
v_mul_f32 v249, v249, v62
v_mul_f32 v250, v250, v62
v_mul_f32 v251, v251, v62
v_mul_f32 v252, v252, v62
v_mul_f32 v253, v253, v62
v_mul_f32 v254, v254, v62
v_mul_f32 v255, v255, v62
v_add_f32 v23, v23, v32
v_add_f32 v23, v23, v33
v_add_f32 v23, v23, v34
v_add_f32 v23, v23, v35
v_add_f32 v23, v23, v36
v_add_f32 v23, v23, v37
v_add_f32 v23, v23, v38
v_add_f32 v23, v23, v39
v_add_f32 v23, v23, v40
v_add_f32 v23, v23, v41
v_add_f32 v23, v23, v42
v_add_f32 v23, v23, v43
v_add_f32 v23, v23, v44
v_add_f32 v23, v23, v45
v_add_f32 v23, v23, v46
v_add_f32 v23, v23, v47
v_cvt_pk_bf16_f32 v48, v32, v33
v_cvt_pk_bf16_f32 v49, v34, v35
v_cvt_pk_bf16_f32 v50, v36, v37
v_cvt_pk_bf16_f32 v51, v38, v39
v_cvt_pk_bf16_f32 v52, v40, v41
v_cvt_pk_bf16_f32 v53, v42, v43
v_cvt_pk_bf16_f32 v54, v44, v45
v_cvt_pk_bf16_f32 v55, v46, v47
mav 224,64,48
s_nop 0
mav 224,68,52
mav 228,76,52
mav 228,72,48
mav 232,80,48
mav 232,84,52
mav 236,92,52
mav 236,88,48
mav 240,96,48
mav 240,100,52
mav 244,108,52
mav 244,104,48
mav 248,112,48
mav 248,116,52
mav 252,124,52
mav 252,120,48
s_add_u32 s97, s97, 32768
s_add_u32 s96, s96, 1
s_cmp_le_u32 s96, s60
s_cbranch_scc1 L_guard_loop
v_mov_b32 v38, v20
v_mov_b32 v39, v21
v_mov_b32 v40, v22
v_mov_b32 v41, v23
v_permlane32_swap_b32 v38, v20
v_permlane32_swap_b32 v39, v21
v_permlane32_swap_b32 v40, v22
v_permlane32_swap_b32 v41, v23
v_add_f32 v20, v20, v38
v_add_f32 v21, v21, v39
v_add_f32 v22, v22, v40
v_add_f32 v23, v23, v41
v_mov_b32 v38, v20
v_mov_b32 v39, v21
v_mov_b32 v40, v22
v_mov_b32 v41, v23
v_permlane16_swap_b32 v38, v20
v_permlane16_swap_b32 v39, v21
v_permlane16_swap_b32 v40, v22
v_permlane16_swap_b32 v41, v23
v_add_f32 v20, v20, v38
v_add_f32 v21, v21, v39
v_add_f32 v22, v22, v40
v_add_f32 v23, v23, v41
s_nop 15
s_setpc_b64 s[92:93]
L_tag_spin:
s_add_u32 s3, s3, 1
s_cmp_gt_u32 s3, 0x200000
s_cbranch_scc1 L_tag_back
buffer_load_dwordx2 v[16:17], off, s[52:55], 0 sc1
s_waitcnt vmcnt(0)
v_readfirstlane_b32 s94, v17
s_nop 3
s_cmp_lg_u32 s94, 0
s_cbranch_scc0 L_tag_spin
s_branch L_tag_back
L_kv1_spin:
s_add_u32 s3, s3, 1
s_cmp_gt_u32 s3, 0x200000
s_cbranch_scc1 L_kv1_back
buffer_load_dwordx2 v[18:19], v8, s[48:51], 0 offen offset:128 sc1
s_waitcnt vmcnt(0)
v_cmp_eq_u64 s[92:93], v[18:19], v[16:17]
s_nop 3
s_cmp_eq_u32 s92, 0xff
s_cbranch_scc0 L_kv1_spin
s_branch L_kv1_back
L_idle0_redo:
s_call_b64 s[92:93], L_guard
s_nop 1
s_branch L_idle0_ok
L_idle1_redo:
s_call_b64 s[92:93], L_guard
s_nop 1
s_branch L_idle1_ok
L_slot_spin:
s_add_u32 s3, s3, 1
s_cmp_gt_u32 s3, 0x200000
s_cbranch_scc1 L_slot_back
buffer_load_dwordx2 v[18:19], v8, s[48:51], 0 offen offset:256 sc1
s_waitcnt vmcnt(0)
v_cmp_eq_u64 s[92:93], v[18:19], v[16:17]
s_nop 3
s_cmp_eq_u32 s92, 0xffffffff
s_cbranch_scc0 L_slot_spin
s_branch L_slot_back
L_fin_redo:
s_call_b64 s[92:93], L_guard
v_mov_b64 v[128:129], 0
v_mov_b64 v[130:131], 0
v_mov_b64 v[132:133], 0
v_mov_b64 v[134:135], 0
v_mov_b64 v[136:137], 0
v_mov_b64 v[138:139], 0
v_mov_b64 v[140:141], 0
v_mov_b64 v[142:143], 0
v_mov_b64 v[144:145], 0
v_mov_b64 v[146:147], 0
v_mov_b64 v[148:149], 0
v_mov_b64 v[150:151], 0
v_mov_b64 v[152:153], 0
v_mov_b64 v[154:155], 0
v_mov_b64 v[156:157], 0
v_mov_b64 v[158:159], 0
v_mov_b64 v[160:161], 0
v_mov_b64 v[162:163], 0
v_mov_b64 v[164:165], 0
v_mov_b64 v[166:167], 0
v_mov_b64 v[168:169], 0
v_mov_b64 v[170:171], 0
v_mov_b64 v[172:173], 0
v_mov_b64 v[174:175], 0
v_mov_b64 v[176:177], 0
v_mov_b64 v[178:179], 0
v_mov_b64 v[180:181], 0
v_mov_b64 v[182:183], 0
v_mov_b64 v[184:185], 0
v_mov_b64 v[186:187], 0
v_mov_b64 v[188:189], 0
v_mov_b64 v[190:191], 0
s_nop 1
s_branch L_fin_ok
L_ctx_spin:
s_add_u32 s3, s3, 1
s_cmp_gt_u32 s3, 0x200000
s_cbranch_scc1 L_ctx_back
buffer_load_dwordx2 v[18:19], v8, s[48:51], 0 offen offset:0 sc1
s_waitcnt vmcnt(0)
v_cmp_eq_u64 s[92:93], v[18:19], v[16:17]
s_nop 3
s_cmp_eq_u32 s92, 0xff
s_cbranch_scc0 L_ctx_spin
s_branch L_ctx_back
L_end:
s_endpgm

.section .rodata,"a"
.p2align 6
.amdhsa_kernel gated_mix__compressed_kv_cla__glu_gated_glu__prompt_kernel
  .amdhsa_next_free_vgpr 512
  .amdhsa_next_free_sgpr 102
  .amdhsa_accum_offset 256
  .amdhsa_group_segment_fixed_size 0
  .amdhsa_kernarg_size 112
  .amdhsa_user_sgpr_count 2
  .amdhsa_user_sgpr_kernarg_segment_ptr 1
  .amdhsa_system_sgpr_workgroup_id_x 1
  .amdhsa_float_denorm_mode_32 3
.end_amdhsa_kernel
```
